```python
import torch

def _softmax(x, axis=-1):
    return torch.softmax(x, dim=axis)
def _gelu(x):
    return torch.nn.functional.gelu(x, approximate="tanh")
def _silu(x):
    return torch.nn.functional.silu(x)
def _sigmoid(x):
    return torch.sigmoid(x)
def _layernorm(x, axis=-1, eps=1e-5):
    m = x.mean(dim=axis, keepdim=True)
    v = x.var(dim=axis, keepdim=True, unbiased=False)
    return (x - m) / torch.sqrt(v + eps)
def _scatter_add(tgt, idx, src, axis=0):
    return tgt.clone().index_add_(axis, idx, src)
def _segment_sum(src, seg, n):
    out = torch.zeros((n,) + src.shape[1:], dtype=src.dtype)
    return out.index_add_(0, seg, src)
def _pad(x, pw):
    flat = tuple(v for pair in reversed(pw) for v in pair)
    return torch.nn.functional.pad(x, flat)

kernel_name = 'interleave_layers__linear_kernel_hedgehog__geglu_ffn__prompt'

def setup_inputs():

    _w = (lambda a: (lambda t: t.to(torch.bfloat16) if t.is_floating_point() else t)(torch.as_tensor(a)))
    def _A_setup():
        B, S, D, H = 1, 2048, 448, 16
        Dh = D // H
        return {
            "x": _w((lambda *s: torch.randn(*s, dtype=torch.bfloat16) * 0.05)(B, S, D)),
            "wqkv": _w((lambda *s: torch.randn(*s, dtype=torch.bfloat16) * 0.2)(D, 3 * D)),
            "w_phi": _w((lambda *s: torch.randn(*s, dtype=torch.bfloat16) * 0.2)(H, Dh, Dh) * (Dh ** -0.5)),
            "wo": _w((lambda *s: torch.randn(*s, dtype=torch.bfloat16) * 0.05)(D, D)),
        }
    _A_in = _A_setup()

    def _B_setup():
        B, S, D, F = 1, 2048, 448, 1792
        return {
            "x": _w((lambda *s: torch.randn(*s, dtype=torch.bfloat16) * 0.05)(B, S, D)),
            "w_gate": _w((lambda *s: torch.randn(*s, dtype=torch.bfloat16) * 0.05)(D, F)),
            "w_up": _w((lambda *s: torch.randn(*s, dtype=torch.bfloat16) * 0.05)(D, F)),
            "w_down": _w((lambda *s: torch.randn(*s, dtype=torch.bfloat16) * 0.05)(F, D)),
        }
    _B_in = _B_setup()

    return {
        "A_x": _A_in["x"],
        "A_wqkv": _A_in["wqkv"],
        "A_w_phi": _A_in["w_phi"],
        "A_wo": _A_in["wo"],
        "B_x": _B_in["x"],
        "B_w_gate": _B_in["w_gate"],
        "B_w_up": _B_in["w_up"],
        "B_w_down": _B_in["w_down"],
    }

def reference(A_x, A_wqkv, A_w_phi, A_wo, B_x, B_w_gate, B_w_up, B_w_down):
    def _A_ref(x, wqkv, w_phi, wo):
        B, S, D = x.shape
        H = 16; Dh = D // H
        qkv = (lambda x, *d: x.permute(*d))((x @ wqkv).reshape(B, S, 3, H, Dh), 2, 0, 3, 1, 4)
        q, k, v = qkv[0], qkv[1], qkv[2]
        pq = torch.einsum("bhsd,hdf->bhsf", q, w_phi)
        pk = torch.einsum("bhsd,hdf->bhsf", k, w_phi)
        phi_q = torch.concatenate([_softmax(pq, axis=-1), _softmax(-pq, axis=-1)], axis=-1)
        phi_k = torch.concatenate([_softmax(pk, axis=-1), _softmax(-pk, axis=-1)], axis=-1)
        kv = torch.einsum("bhsf,bhsd->bhfd", phi_k, v)
        z  = torch.einsum("bhsf->bhf", phi_k)
        num = torch.einsum("bhqf,bhfd->bhqd", phi_q, kv)
        den = torch.einsum("bhqf,bhf->bhq", phi_q, z)[..., None] + 1e-6
        o = num / den
        return (lambda x, *d: x.permute(*d))(o, 0, 2, 1, 3).reshape(B, S, D) @ wo

    def _B_ref(x, w_gate, w_up, w_down):
        return (_gelu(x @ w_gate) * (x @ w_up)) @ w_down

    x = A_x
    x = x + _A_ref(_layernorm(x, axis=-1), A_wqkv, A_w_phi, A_wo)
    x = x + _B_ref(_layernorm(x, axis=-1), B_w_gate, B_w_up, B_w_down)
    x = x + _A_ref(_layernorm(x, axis=-1), A_wqkv, A_w_phi, A_wo)
    x = x + _B_ref(_layernorm(x, axis=-1), B_w_gate, B_w_up, B_w_down)
    return x
```

```asm
; @launch grid=(256,1,1) block=(256,1,1) lds=163840
.amdgcn_target "amdgcn-amd-amdhsa--gfx950"
.text
.globl interleave_layers__linear_kernel_hedgehog__geglu_ffn__prompt_kernel
.p2align 8
.type interleave_layers__linear_kernel_hedgehog__geglu_ffn__prompt_kernel,@function
interleave_layers__linear_kernel_hedgehog__geglu_ffn__prompt_kernel:
	s_cmp_ge_u32 s2, 256
	s_cbranch_scc1 L_end
	s_load_dwordx4 s[32:35], s[0:1], 0
	s_load_dwordx2 s[40:41], s[0:1], 16
	s_load_dwordx2 s[8:9], s[0:1], 24
	s_load_dwordx2 s[12:13], s[0:1], 40
	s_load_dwordx2 s[16:17], s[0:1], 48
	s_load_dwordx2 s[20:21], s[0:1], 56
	s_load_dwordx2 s[24:25], s[0:1], 64
	s_load_dwordx2 s[28:29], s[0:1], 72
	s_load_dwordx2 s[4:5], s[0:1], 80
	s_getreg_b32 s62, hwreg(HW_REG_XCC_ID, 0, 4)
	s_and_b32 s44, s2, 7
	s_lshr_b32 s45, s2, 3
	v_lshrrev_b32 v10, 6, v0
	v_and_b32 v0, 63, v0
	v_readfirstlane_b32 s46, v10
	s_mov_b32 s47, 0
	s_mov_b32 s48, 0
	s_mov_b32 s50, 0
	s_mul_i32 s49, s44, 5242880
	s_add_u32 s49, s49, 1048576
	s_and_b32 s63, s45, 15
	s_lshr_b32 s64, s45, 4
	s_mul_i32 s65, s45, 37
	s_lshr_b32 s65, s65, 8
	s_mul_i32 s68, s65, 7
	s_sub_u32 s66, s45, s68
	s_mov_b32 s96, 0
	s_mov_b32 s97, -1
	s_getpc_b64 s[98:99]
L_pc:
	s_sub_u32 s98, s98, L_pc-interleave_layers__linear_kernel_hedgehog__geglu_ffn__prompt_kernel
	s_subb_u32 s99, s99, 0
	s_cmp_lg_u32 s46, 3
	s_cbranch_scc1 Lw_1
	s_mul_i32 s68, s45, (((L_code_p2b-interleave_layers__linear_kernel_hedgehog__geglu_ffn__prompt_kernel)+4095)/4096)*128
	s_add_u32 s68, s68, interleave_layers__linear_kernel_hedgehog__geglu_ffn__prompt_kernel-interleave_layers__linear_kernel_hedgehog__geglu_ffn__prompt_kernel
	v_lshlrev_b32 v10, 7, v0
	v_add_u32 v10, s68, v10
	v_min_u32 v10, CODE_BYTES-4, v10
	s_mov_b32 exec_lo, (1<<(((L_code_p2b-interleave_layers__linear_kernel_hedgehog__geglu_ffn__prompt_kernel)+4095)/4096))-1
	s_mov_b32 exec_hi, 0
	global_load_dword v255, v10, s[98:99]
	s_mov_b64 exec, -1
Lw_1:
	s_mov_b32 s6, 268435456
	s_mov_b32 s7, 0x20000
	s_mov_b32 s10, 401408
	s_mov_b32 s11, 0x20000
	s_mov_b32 s14, 1605632
	s_mov_b32 s15, 0x20000
	s_mov_b32 s18, 1605632
	s_mov_b32 s19, 0x20000
	s_mov_b32 s22, 1605632
	s_mov_b32 s23, 0x20000
	s_mov_b32 s26, 1835008
	s_mov_b32 s27, 0x20000
	s_mov_b32 s30, 256
	s_mov_b32 s31, 0x20000
	s_mov_b32 s42, 25088
	s_mov_b32 s43, 0x20000
	s_waitcnt lgkmcnt(0)
	s_mov_b32 s36, s34
	s_mov_b32 s37, s35
	s_mov_b32 s34, 1835008
	s_mov_b32 s35, 0x20000
	s_mov_b32 s38, 1204224
	s_mov_b32 s39, 0x20000
	s_cmp_lg_u32 s46, 0
	s_cbranch_scc1 Lw_2
	s_lshl_b32 s61, s44, 11
	v_lshlrev_b32 v11, 7, v0
	v_mov_b32 v12, 0
	v_mov_b32 v13, 0
	v_mov_b32 v14, 0
	v_mov_b32 v15, 0
	s_mov_b64 exec, 0xffff
	buffer_load_dword v254, v11, s[4:7], s61 offen
	s_lshl_b32 s68, s45, 2
	s_add_u32 s68, s68, s61
	buffer_store_dword v12, v11, s[4:7], s68 offen
	s_mov_b64 exec, -1
	v_lshlrev_b32 v16, 4, v0
	s_lshl_b32 s68, s2, 10
	s_add_u32 s68, s68, 32768
	buffer_store_dwordx4 v[12:15], v16, s[4:7], s68 offen sc1
	s_cmp_ge_u32 s2, 32
	s_nop 0
	s_cbranch_scc1 Lz_3
	s_lshl_b32 s68, s2, 7
	s_add_u32 s68, s68, 16384
	s_mov_b64 exec, 1
	buffer_store_dword v12, off, s[4:7], s68 sc1
	s_mov_b64 exec, -1
Lz_3:
Lw_2:
	s_cmp_lg_u32 s46, 2
	s_cbranch_scc1 Lw_4
	v_lshlrev_b32 v30, 7, v0
	s_lshl_b32 s68, s44, 8
	s_lshl_b32 s69, s45, 3
	s_add_u32 s68, s68, s69
	s_mul_i32 s68, s68, 896
	s_mov_b32 exec_hi, 0xffffff
	buffer_load_dword v254, v30, s[32:35], s68 offen
	s_mov_b64 exec, -1
Lw_4:
	v_lshrrev_b32 v10, 3, v0
	v_mul_u32_u24 v10, 896, v10
	v_and_b32 v11, 7, v0
	v_lshrrev_b32 v12, 4, v0
	v_xor_b32 v11, v11, v12
	v_lshl_add_u32 v40, v11, 4, v10
	v_xor_b32 v41, 64, v40
	s_lshl_b32 s68, s44, 8
	s_lshl_b32 s69, s64, 7
	s_add_u32 s68, s68, s69
	s_lshl_b32 s69, s46, 5
	s_add_u32 s68, s68, s69
	s_mul_i32 s82, s68, 896
	s_mul_i32 s83, s46, 28672
	s_add_u32 s83, s83, 47104
	s_add_u32 m0, s83, 0
	s_add_u32 s70, s82, 0
	buffer_load_dwordx4 v40, s[32:35], s70 offen lds
	s_add_u32 m0, s83, 1024
	s_add_u32 s70, s82, 7168
	buffer_load_dwordx4 v41, s[32:35], s70 offen lds
	s_add_u32 m0, s83, 2048
	s_add_u32 s70, s82, 14336
	buffer_load_dwordx4 v40, s[32:35], s70 offen lds
	s_add_u32 m0, s83, 3072
	s_add_u32 s70, s82, 21504
	buffer_load_dwordx4 v41, s[32:35], s70 offen lds
	s_add_u32 m0, s83, 4096
	s_add_u32 s70, s82, 128
	buffer_load_dwordx4 v40, s[32:35], s70 offen lds
	s_add_u32 m0, s83, 5120
	s_add_u32 s70, s82, 7296
	buffer_load_dwordx4 v41, s[32:35], s70 offen lds
	s_add_u32 m0, s83, 6144
	s_add_u32 s70, s82, 14464
	buffer_load_dwordx4 v40, s[32:35], s70 offen lds
	s_add_u32 m0, s83, 7168
	s_add_u32 s70, s82, 21632
	buffer_load_dwordx4 v41, s[32:35], s70 offen lds
	s_add_u32 m0, s83, 8192
	s_add_u32 s70, s82, 256
	buffer_load_dwordx4 v40, s[32:35], s70 offen lds
	s_add_u32 m0, s83, 9216
	s_add_u32 s70, s82, 7424
	buffer_load_dwordx4 v41, s[32:35], s70 offen lds
	s_add_u32 m0, s83, 10240
	s_add_u32 s70, s82, 14592
	buffer_load_dwordx4 v40, s[32:35], s70 offen lds
	s_add_u32 m0, s83, 11264
	s_add_u32 s70, s82, 21760
	buffer_load_dwordx4 v41, s[32:35], s70 offen lds
	s_add_u32 m0, s83, 12288
	s_add_u32 s70, s82, 384
	buffer_load_dwordx4 v40, s[32:35], s70 offen lds
	s_add_u32 m0, s83, 13312
	s_add_u32 s70, s82, 7552
	buffer_load_dwordx4 v41, s[32:35], s70 offen lds
	s_add_u32 m0, s83, 14336
	s_add_u32 s70, s82, 14720
	buffer_load_dwordx4 v40, s[32:35], s70 offen lds
	s_add_u32 m0, s83, 15360
	s_add_u32 s70, s82, 21888
	buffer_load_dwordx4 v41, s[32:35], s70 offen lds
	s_add_u32 m0, s83, 16384
	s_add_u32 s70, s82, 512
	buffer_load_dwordx4 v40, s[32:35], s70 offen lds
	s_add_u32 m0, s83, 17408
	s_add_u32 s70, s82, 7680
	buffer_load_dwordx4 v41, s[32:35], s70 offen lds
	s_add_u32 m0, s83, 18432
	s_add_u32 s70, s82, 14848
	buffer_load_dwordx4 v40, s[32:35], s70 offen lds
	s_add_u32 m0, s83, 19456
	s_add_u32 s70, s82, 22016
	buffer_load_dwordx4 v41, s[32:35], s70 offen lds
	s_add_u32 m0, s83, 20480
	s_add_u32 s70, s82, 640
	buffer_load_dwordx4 v40, s[32:35], s70 offen lds
	s_add_u32 m0, s83, 21504
	s_add_u32 s70, s82, 7808
	buffer_load_dwordx4 v41, s[32:35], s70 offen lds
	s_add_u32 m0, s83, 22528
	s_add_u32 s70, s82, 14976
	buffer_load_dwordx4 v40, s[32:35], s70 offen lds
	s_add_u32 m0, s83, 23552
	s_add_u32 s70, s82, 22144
	buffer_load_dwordx4 v41, s[32:35], s70 offen lds
	s_add_u32 m0, s83, 24576
	s_add_u32 s70, s82, 768
	buffer_load_dwordx4 v40, s[32:35], s70 offen lds
	s_add_u32 m0, s83, 25600
	s_add_u32 s70, s82, 7936
	buffer_load_dwordx4 v41, s[32:35], s70 offen lds
	s_add_u32 m0, s83, 26624
	s_add_u32 s70, s82, 15104
	buffer_load_dwordx4 v40, s[32:35], s70 offen lds
	s_add_u32 m0, s83, 27648
	s_add_u32 s70, s82, 22272
	buffer_load_dwordx4 v41, s[32:35], s70 offen lds
	s_cmp_lg_u32 s46, 0
	s_cbranch_scc1 Lw_5
	s_mul_i32 s69, s62, s62
	s_lshl_b32 s69, s69, 10
	s_add_u32 s69, s69, s62
	s_add_u32 s69, s69, 67108864
	v_mov_b32 v10, s69
	s_lshl_b32 s70, s44, 5
	s_waitcnt vmcnt(28)
	s_mov_b64 exec, 1
	buffer_atomic_add v10, off, s[28:31], s70 sc1
	s_mov_b64 exec, -1
Lw_5:
	v_lshrrev_b32 v10, 2, v0
	v_mul_u32_u24 v10, 2688, v10
	v_and_b32 v11, 3, v0
	v_lshl_add_u32 v42, v11, 4, v10
	s_mul_i32 s84, s63, 56
	s_mul_i32 s68, s46, 43008
	s_add_u32 s84, s84, s68
	s_lshl_b32 s85, s46, 10
	s_add_u32 m0, s85, 0
	s_add_u32 s70, s84, 896
	buffer_load_dwordx4 v42, s[36:39], s70 offen lds
	s_add_u32 m0, s85, 4096
	s_add_u32 s70, s84, 172928
	buffer_load_dwordx4 v42, s[36:39], s70 offen lds
	v_lshlrev_b32 v1, 4, v0
	v_lshrrev_b32 v10, 5, v0
	v_and_b32 v11, 15, v0
	v_lshrrev_b32 v12, 2, v11
	v_bfe_u32 v13, v0, 4, 1
	v_and_b32 v14, 3, v11
	v_lshl_add_u32 v15, v10, 2, v12
	v_lshlrev_b32 v16, 5, v13
	v_lshl_add_u32 v16, v14, 3, v16
	v_lshl_add_u32 v2, v15, 6, v16
	v_lshl_add_u32 v17, v15, 7, v16
	v_lshrrev_b32 v18, 1, v12
	v_lshl_add_u32 v3, v18, 6, v17
	v_xor_b32 v18, 1, v18
	v_lshl_add_u32 v4, v18, 6, v17
	v_lshrrev_b32 v19, 3, v0
	v_and_b32 v20, 7, v0
	v_lshlrev_b32 v21, 2, v13
	v_xor_b32 v20, v20, v21
	v_lshlrev_b32 v20, 4, v20
	v_mul_u32_u24 v5, 896, v19
	v_add_u32 v5, v5, v20
	v_mul_u32_u24 v6, 3584, v19
	v_add_u32 v6, v6, v20
	v_and_b32 v22, 31, v0
	v_lshlrev_b32 v22, 4, v22
	v_lshl_add_u32 v7, v10, 11, v22
	v_lshlrev_b32 v8, 4, v10
	v_and_b32 v13, 31, v0
	s_lshl_b32 s68, s46, 5
	v_add_u32 v14, s68, v13
	v_lshrrev_b32 v20, 5, v0
	v_bfe_u32 v21, v13, 1, 1
	v_lshlrev_b32 v21, 3, v21
	v_bfe_u32 v22, v13, 3, 1
	v_lshl_or_b32 v21, v22, 2, v21
	v_bfe_u32 v22, v13, 2, 1
	v_lshl_or_b32 v21, v22, 1, v21
	v_and_b32 v22, 1, v13
	v_or_b32 v21, v21, v22
	v_xor_b32 v21, v21, v20
	v_lshlrev_b32 v21, 3, v21
	v_lshl_add_u32 v21, v14, 7, v21
	v_add_u32 v240, 86016, v21
	v_bfe_u32 v21, v14, 1, 3
	v_xor_b32 v21, v21, v20
	v_lshlrev_b32 v21, 3, v21
	v_lshl_add_u32 v21, v14, 6, v21
	v_add_u32 v241, 102400, v21
	v_and_b32 v13, 15, v0
	v_lshrrev_b32 v14, 2, v13
	v_and_b32 v22, 3, v13
	v_bfe_u32 v23, v0, 4, 1
	v_lshl_add_u32 v24, v23, 2, v22
	v_lshl_add_u32 v25, v20, 2, v14
	v_lshrrev_b32 v26, 1, v14
	v_lshlrev_b32 v26, 3, v26
	v_lshl_or_b32 v26, v20, 1, v26
	v_and_b32 v27, 1, v14
	v_or_b32 v26, v26, v27
	s_and_b32 s68, s46, 1
	s_lshl_b32 s68, s68, 3
	v_add_u32 v27, s68, v24
	v_xor_b32 v27, v27, v26
	v_lshlrev_b32 v27, 3, v27
	v_lshl_add_u32 v27, v25, 7, v27
	v_add_u32 v242, 86016, v27
	v_xor_b32 v27, 32, v242
	v_add_u32 v243, 1024, v27
	v_lshrrev_b32 v26, 1, v14
	v_lshl_or_b32 v26, v20, 1, v26
	v_xor_b32 v26, v26, v24
	v_lshlrev_b32 v26, 3, v26
	v_lshl_add_u32 v26, v25, 6, v26
	v_add_u32 v244, 102400, v26
	v_xor_b32 v27, 32, v244
	v_add_u32 v245, 512, v27
	v_and_b32 v13, 31, v0
	v_lshlrev_b32 v13, 2, v13
	v_lshl_add_u32 v246, v20, 10, v13
	v_lshrrev_b32 v13, 3, v0
	v_and_b32 v14, 7, v0
	v_lshlrev_b32 v21, 8, v13
	v_lshl_add_u32 v248, v14, 4, v21
	v_and_b32 v21, 1, v14
	v_lshl_add_u32 v21, v21, 5, v13
	v_lshlrev_b32 v21, 4, v21
	v_bfe_u32 v22, v14, 1, 1
	v_lshl_add_u32 v21, v22, 3, v21
	v_lshrrev_b32 v22, 2, v14
	v_lshl_add_u32 v21, v22, 10, v21
	s_and_b32 s68, s46, 1
	s_lshl_b32 s68, s68, 11
	s_add_u32 s68, s68, 40960
	v_add_u32 v249, s68, v21
	v_lshlrev_b32 v247, 7, v0
	v_and_b32 v10, 31, v0
	v_bfe_u32 v11, v10, 1, 3
	v_lshlrev_b32 v11, 4, v11
	v_lshl_add_u32 v11, v10, 7, v11
	v_lshrrev_b32 v12, 5, v0
	v_lshl_add_u32 v11, v12, 3, v11
	v_add_u32 v11, s83, v11
	v_xor_b32 v44, 0, v11
	v_xor_b32 v45, 16, v11
	v_xor_b32 v46, 32, v11
	v_xor_b32 v47, 48, v11
	v_xor_b32 v48, 64, v11
	v_xor_b32 v49, 80, v11
	v_xor_b32 v50, 96, v11
	v_xor_b32 v51, 112, v11
	v_mov_b32 v54, 0
	v_mov_b32 v55, 0
	v_mov_b32 v60, 0x3f803f80
	v_mov_b32 v61, 0x3f803f80
	v_mov_b32 v62, 0x3f803f80
	v_mov_b32 v63, 0x3f803f80
	s_waitcnt vmcnt(2)
	ds_read_b64 a[0:1], v44 offset:0
	ds_read_b64 a[2:3], v45 offset:0
	ds_read_b64 a[4:5], v46 offset:0
	ds_read_b64 a[6:7], v47 offset:0
	ds_read_b64 a[8:9], v48 offset:0
	ds_read_b64 a[10:11], v49 offset:0
	ds_read_b64 a[12:13], v50 offset:0
	ds_read_b64 a[14:15], v51 offset:0
	ds_read_b64 v[128:129], v44 offset:0
	ds_read_b64 v[130:131], v45 offset:0
	ds_read_b64 v[132:133], v46 offset:0
	ds_read_b64 v[134:135], v47 offset:0
	ds_read_b64 v[136:137], v48 offset:0
	ds_read_b64 v[138:139], v49 offset:0
	ds_read_b64 v[140:141], v50 offset:0
	ds_read_b64 v[142:143], v51 offset:0
	ds_read_b64 a[16:17], v44 offset:4096
	ds_read_b64 a[18:19], v45 offset:4096
	ds_read_b64 a[20:21], v46 offset:4096
	ds_read_b64 a[22:23], v47 offset:4096
	ds_read_b64 a[24:25], v48 offset:4096
	ds_read_b64 a[26:27], v49 offset:4096
	ds_read_b64 a[28:29], v50 offset:4096
	ds_read_b64 a[30:31], v51 offset:4096
	ds_read_b64 v[144:145], v44 offset:4096
	ds_read_b64 v[146:147], v45 offset:4096
	ds_read_b64 v[148:149], v46 offset:4096
	ds_read_b64 v[150:151], v47 offset:4096
	ds_read_b64 v[152:153], v48 offset:4096
	ds_read_b64 v[154:155], v49 offset:4096
	ds_read_b64 v[156:157], v50 offset:4096
	ds_read_b64 v[158:159], v51 offset:4096
	s_waitcnt lgkmcnt(14)
	v_mfma_f32_32x32x16_bf16 v[64:79], v[60:63], a[0:3], 0
	v_dot2c_f32_bf16 v54, v128, v128
	v_dot2c_f32_bf16 v55, v129, v129
	v_dot2c_f32_bf16 v54, v130, v130
	v_dot2c_f32_bf16 v55, v131, v131
	v_mfma_f32_32x32x16_bf16 v[64:79], v[60:63], a[4:7], v[64:79]
	v_dot2c_f32_bf16 v54, v132, v132
	v_dot2c_f32_bf16 v55, v133, v133
	v_dot2c_f32_bf16 v54, v134, v134
	v_dot2c_f32_bf16 v55, v135, v135
	s_add_u32 m0, s85, 8192
	s_add_u32 s70, s84, 344960
	buffer_load_dwordx4 v42, s[36:39], s70 offen lds
	v_mfma_f32_32x32x16_bf16 v[64:79], v[60:63], a[8:11], v[64:79]
	v_dot2c_f32_bf16 v54, v136, v136
	v_dot2c_f32_bf16 v55, v137, v137
	v_dot2c_f32_bf16 v54, v138, v138
	v_dot2c_f32_bf16 v55, v139, v139
	v_mfma_f32_32x32x16_bf16 v[64:79], v[60:63], a[12:15], v[64:79]
	v_dot2c_f32_bf16 v54, v140, v140
	v_dot2c_f32_bf16 v55, v141, v141
	v_dot2c_f32_bf16 v54, v142, v142
	v_dot2c_f32_bf16 v55, v143, v143
	s_add_u32 m0, s85, 12288
	s_add_u32 s70, s84, 516992
	buffer_load_dwordx4 v42, s[36:39], s70 offen lds
	ds_read_b64 a[32:33], v44 offset:8192
	ds_read_b64 a[34:35], v45 offset:8192
	ds_read_b64 a[36:37], v46 offset:8192
	ds_read_b64 a[38:39], v47 offset:8192
	ds_read_b64 a[40:41], v48 offset:8192
	ds_read_b64 a[42:43], v49 offset:8192
	ds_read_b64 a[44:45], v50 offset:8192
	ds_read_b64 a[46:47], v51 offset:8192
	ds_read_b64 v[160:161], v44 offset:8192
	ds_read_b64 v[162:163], v45 offset:8192
	ds_read_b64 v[164:165], v46 offset:8192
	ds_read_b64 v[166:167], v47 offset:8192
	ds_read_b64 v[168:169], v48 offset:8192
	ds_read_b64 v[170:171], v49 offset:8192
	ds_read_b64 v[172:173], v50 offset:8192
	ds_read_b64 v[174:175], v51 offset:8192
	s_waitcnt lgkmcnt(14)
	v_mfma_f32_32x32x16_bf16 v[64:79], v[60:63], a[16:19], v[64:79]
	v_dot2c_f32_bf16 v54, v144, v144
	v_dot2c_f32_bf16 v55, v145, v145
	v_dot2c_f32_bf16 v54, v146, v146
	v_dot2c_f32_bf16 v55, v147, v147
	v_mfma_f32_32x32x16_bf16 v[64:79], v[60:63], a[20:23], v[64:79]
	v_dot2c_f32_bf16 v54, v148, v148
	v_dot2c_f32_bf16 v55, v149, v149
	v_dot2c_f32_bf16 v54, v150, v150
	v_dot2c_f32_bf16 v55, v151, v151
	s_add_u32 m0, s85, 16384
	s_add_u32 s70, s84, 689024
	buffer_load_dwordx4 v42, s[36:39], s70 offen lds
	v_mfma_f32_32x32x16_bf16 v[64:79], v[60:63], a[24:27], v[64:79]
	v_dot2c_f32_bf16 v54, v152, v152
	v_dot2c_f32_bf16 v55, v153, v153
	v_dot2c_f32_bf16 v54, v154, v154
	v_dot2c_f32_bf16 v55, v155, v155
	v_mfma_f32_32x32x16_bf16 v[64:79], v[60:63], a[28:31], v[64:79]
	v_dot2c_f32_bf16 v54, v156, v156
	v_dot2c_f32_bf16 v55, v157, v157
	v_dot2c_f32_bf16 v54, v158, v158
	v_dot2c_f32_bf16 v55, v159, v159
	s_add_u32 m0, s85, 20480
	s_add_u32 s70, s84, 861056
	buffer_load_dwordx4 v42, s[36:39], s70 offen lds
	ds_read_b64 a[48:49], v44 offset:12288
	ds_read_b64 a[50:51], v45 offset:12288
	ds_read_b64 a[52:53], v46 offset:12288
	ds_read_b64 a[54:55], v47 offset:12288
	ds_read_b64 a[56:57], v48 offset:12288
	ds_read_b64 a[58:59], v49 offset:12288
	ds_read_b64 a[60:61], v50 offset:12288
	ds_read_b64 a[62:63], v51 offset:12288
	ds_read_b64 v[128:129], v44 offset:12288
	ds_read_b64 v[130:131], v45 offset:12288
	ds_read_b64 v[132:133], v46 offset:12288
	ds_read_b64 v[134:135], v47 offset:12288
	ds_read_b64 v[136:137], v48 offset:12288
	ds_read_b64 v[138:139], v49 offset:12288
	ds_read_b64 v[140:141], v50 offset:12288
	ds_read_b64 v[142:143], v51 offset:12288
	s_waitcnt lgkmcnt(14)
	v_mfma_f32_32x32x16_bf16 v[64:79], v[60:63], a[32:35], v[64:79]
	v_dot2c_f32_bf16 v54, v160, v160
	v_dot2c_f32_bf16 v55, v161, v161
	v_dot2c_f32_bf16 v54, v162, v162
	v_dot2c_f32_bf16 v55, v163, v163
	v_mfma_f32_32x32x16_bf16 v[64:79], v[60:63], a[36:39], v[64:79]
	v_dot2c_f32_bf16 v54, v164, v164
	v_dot2c_f32_bf16 v55, v165, v165
	v_dot2c_f32_bf16 v54, v166, v166
	v_dot2c_f32_bf16 v55, v167, v167
	s_add_u32 m0, s85, 24576
	s_add_u32 s70, s84, 1033088
	buffer_load_dwordx4 v42, s[36:39], s70 offen lds
	v_mfma_f32_32x32x16_bf16 v[64:79], v[60:63], a[40:43], v[64:79]
	v_dot2c_f32_bf16 v54, v168, v168
	v_dot2c_f32_bf16 v55, v169, v169
	v_dot2c_f32_bf16 v54, v170, v170
	v_dot2c_f32_bf16 v55, v171, v171
	v_mfma_f32_32x32x16_bf16 v[64:79], v[60:63], a[44:47], v[64:79]
	v_dot2c_f32_bf16 v54, v172, v172
	v_dot2c_f32_bf16 v55, v173, v173
	v_dot2c_f32_bf16 v54, v174, v174
	v_dot2c_f32_bf16 v55, v175, v175
	s_add_u32 m0, s85, 28672
	s_add_u32 s70, s84, 1792
	buffer_load_dwordx4 v42, s[36:39], s70 offen lds
	ds_read_b64 a[64:65], v44 offset:16384
	ds_read_b64 a[66:67], v45 offset:16384
	ds_read_b64 a[68:69], v46 offset:16384
	ds_read_b64 a[70:71], v47 offset:16384
	ds_read_b64 a[72:73], v48 offset:16384
	ds_read_b64 a[74:75], v49 offset:16384
	ds_read_b64 a[76:77], v50 offset:16384
	ds_read_b64 a[78:79], v51 offset:16384
	ds_read_b64 v[144:145], v44 offset:16384
	ds_read_b64 v[146:147], v45 offset:16384
	ds_read_b64 v[148:149], v46 offset:16384
	ds_read_b64 v[150:151], v47 offset:16384
	ds_read_b64 v[152:153], v48 offset:16384
	ds_read_b64 v[154:155], v49 offset:16384
	ds_read_b64 v[156:157], v50 offset:16384
	ds_read_b64 v[158:159], v51 offset:16384
	s_waitcnt lgkmcnt(14)
	v_mfma_f32_32x32x16_bf16 v[64:79], v[60:63], a[48:51], v[64:79]
	v_dot2c_f32_bf16 v54, v128, v128
	v_dot2c_f32_bf16 v55, v129, v129
	v_dot2c_f32_bf16 v54, v130, v130
	v_dot2c_f32_bf16 v55, v131, v131
	v_mfma_f32_32x32x16_bf16 v[64:79], v[60:63], a[52:55], v[64:79]
	v_dot2c_f32_bf16 v54, v132, v132
	v_dot2c_f32_bf16 v55, v133, v133
	v_dot2c_f32_bf16 v54, v134, v134
	v_dot2c_f32_bf16 v55, v135, v135
	s_add_u32 m0, s85, 32768
	s_add_u32 s70, s84, 173824
	buffer_load_dwordx4 v42, s[36:39], s70 offen lds
	v_mfma_f32_32x32x16_bf16 v[64:79], v[60:63], a[56:59], v[64:79]
	v_dot2c_f32_bf16 v54, v136, v136
	v_dot2c_f32_bf16 v55, v137, v137
	v_dot2c_f32_bf16 v54, v138, v138
	v_dot2c_f32_bf16 v55, v139, v139
	v_mfma_f32_32x32x16_bf16 v[64:79], v[60:63], a[60:63], v[64:79]
	v_dot2c_f32_bf16 v54, v140, v140
	v_dot2c_f32_bf16 v55, v141, v141
	v_dot2c_f32_bf16 v54, v142, v142
	v_dot2c_f32_bf16 v55, v143, v143
	s_add_u32 m0, s85, 36864
	s_add_u32 s70, s84, 345856
	buffer_load_dwordx4 v42, s[36:39], s70 offen lds
	ds_read_b64 a[80:81], v44 offset:20480
	ds_read_b64 a[82:83], v45 offset:20480
	ds_read_b64 a[84:85], v46 offset:20480
	ds_read_b64 a[86:87], v47 offset:20480
	ds_read_b64 a[88:89], v48 offset:20480
	ds_read_b64 a[90:91], v49 offset:20480
	ds_read_b64 a[92:93], v50 offset:20480
	ds_read_b64 a[94:95], v51 offset:20480
	ds_read_b64 v[160:161], v44 offset:20480
	ds_read_b64 v[162:163], v45 offset:20480
	ds_read_b64 v[164:165], v46 offset:20480
	ds_read_b64 v[166:167], v47 offset:20480
	ds_read_b64 v[168:169], v48 offset:20480
	ds_read_b64 v[170:171], v49 offset:20480
	ds_read_b64 v[172:173], v50 offset:20480
	ds_read_b64 v[174:175], v51 offset:20480
	s_waitcnt lgkmcnt(14)
	v_mfma_f32_32x32x16_bf16 v[64:79], v[60:63], a[64:67], v[64:79]
	v_dot2c_f32_bf16 v54, v144, v144
	v_dot2c_f32_bf16 v55, v145, v145
	v_dot2c_f32_bf16 v54, v146, v146
	v_dot2c_f32_bf16 v55, v147, v147
	v_mfma_f32_32x32x16_bf16 v[64:79], v[60:63], a[68:71], v[64:79]
	v_dot2c_f32_bf16 v54, v148, v148
	v_dot2c_f32_bf16 v55, v149, v149
	v_dot2c_f32_bf16 v54, v150, v150
	v_dot2c_f32_bf16 v55, v151, v151
	s_add_u32 m0, s85, 40960
	s_add_u32 s70, s84, 517888
	buffer_load_dwordx4 v42, s[36:39], s70 offen lds
	v_mfma_f32_32x32x16_bf16 v[64:79], v[60:63], a[72:75], v[64:79]
	v_dot2c_f32_bf16 v54, v152, v152
	v_dot2c_f32_bf16 v55, v153, v153
	v_dot2c_f32_bf16 v54, v154, v154
	v_dot2c_f32_bf16 v55, v155, v155
	v_mfma_f32_32x32x16_bf16 v[64:79], v[60:63], a[76:79], v[64:79]
	v_dot2c_f32_bf16 v54, v156, v156
	v_dot2c_f32_bf16 v55, v157, v157
	v_dot2c_f32_bf16 v54, v158, v158
	v_dot2c_f32_bf16 v55, v159, v159
	ds_read_b64 a[96:97], v44 offset:24576
	ds_read_b64 a[98:99], v45 offset:24576
	ds_read_b64 a[100:101], v46 offset:24576
	ds_read_b64 a[102:103], v47 offset:24576
	ds_read_b64 a[104:105], v48 offset:24576
	ds_read_b64 a[106:107], v49 offset:24576
	ds_read_b64 a[108:109], v50 offset:24576
	ds_read_b64 a[110:111], v51 offset:24576
	ds_read_b64 v[128:129], v44 offset:24576
	ds_read_b64 v[130:131], v45 offset:24576
	ds_read_b64 v[132:133], v46 offset:24576
	ds_read_b64 v[134:135], v47 offset:24576
	ds_read_b64 v[136:137], v48 offset:24576
	ds_read_b64 v[138:139], v49 offset:24576
	ds_read_b64 v[140:141], v50 offset:24576
	ds_read_b64 v[142:143], v51 offset:24576
	s_waitcnt lgkmcnt(14)
	v_mfma_f32_32x32x16_bf16 v[64:79], v[60:63], a[80:83], v[64:79]
	v_dot2c_f32_bf16 v54, v160, v160
	v_dot2c_f32_bf16 v55, v161, v161
	v_dot2c_f32_bf16 v54, v162, v162
	v_dot2c_f32_bf16 v55, v163, v163
	v_mfma_f32_32x32x16_bf16 v[64:79], v[60:63], a[84:87], v[64:79]
	v_dot2c_f32_bf16 v54, v164, v164
	v_dot2c_f32_bf16 v55, v165, v165
	v_dot2c_f32_bf16 v54, v166, v166
	v_dot2c_f32_bf16 v55, v167, v167
	v_mfma_f32_32x32x16_bf16 v[64:79], v[60:63], a[88:91], v[64:79]
	v_dot2c_f32_bf16 v54, v168, v168
	v_dot2c_f32_bf16 v55, v169, v169
	v_dot2c_f32_bf16 v54, v170, v170
	v_dot2c_f32_bf16 v55, v171, v171
	v_mfma_f32_32x32x16_bf16 v[64:79], v[60:63], a[92:95], v[64:79]
	v_dot2c_f32_bf16 v54, v172, v172
	v_dot2c_f32_bf16 v55, v173, v173
	v_dot2c_f32_bf16 v54, v174, v174
	v_dot2c_f32_bf16 v55, v175, v175
	s_waitcnt lgkmcnt(0)
	v_mfma_f32_32x32x16_bf16 v[64:79], v[60:63], a[96:99], v[64:79]
	v_dot2c_f32_bf16 v54, v128, v128
	v_dot2c_f32_bf16 v55, v129, v129
	v_dot2c_f32_bf16 v54, v130, v130
	v_dot2c_f32_bf16 v55, v131, v131
	v_mfma_f32_32x32x16_bf16 v[64:79], v[60:63], a[100:103], v[64:79]
	v_dot2c_f32_bf16 v54, v132, v132
	v_dot2c_f32_bf16 v55, v133, v133
	v_dot2c_f32_bf16 v54, v134, v134
	v_dot2c_f32_bf16 v55, v135, v135
	v_mfma_f32_32x32x16_bf16 v[64:79], v[60:63], a[104:107], v[64:79]
	v_dot2c_f32_bf16 v54, v136, v136
	v_dot2c_f32_bf16 v55, v137, v137
	v_dot2c_f32_bf16 v54, v138, v138
	v_dot2c_f32_bf16 v55, v139, v139
	v_mfma_f32_32x32x16_bf16 v[64:79], v[60:63], a[108:111], v[64:79]
	v_dot2c_f32_bf16 v54, v140, v140
	v_dot2c_f32_bf16 v55, v141, v141
	v_dot2c_f32_bf16 v54, v142, v142
	v_dot2c_f32_bf16 v55, v143, v143
	s_waitcnt lgkmcnt(0)
	s_barrier
	s_add_u32 m0, s85, 45056
	s_add_u32 s70, s84, 689920
	buffer_load_dwordx4 v42, s[36:39], s70 offen lds
	s_add_u32 m0, s85, 49152
	s_add_u32 s70, s84, 861952
	buffer_load_dwordx4 v42, s[36:39], s70 offen lds
	s_add_u32 m0, s85, 53248
	s_add_u32 s70, s84, 1033984
	buffer_load_dwordx4 v42, s[36:39], s70 offen lds
	s_cmp_lg_u32 s46, 0
	s_cbranch_scc1 Lw_6
	s_mul_i32 s68, s63, 1568
	s_mov_b32 m0, 86016
	s_nop 0
	buffer_load_dwordx4 v1, s[40:43], s68 offen lds
	s_add_u32 s68, s68, 1024
	s_mov_b32 m0, 87040
	s_nop 0
	buffer_load_dwordx4 v1, s[40:43], s68 offen lds
Lw_6:
	s_add_u32 m0, s85, 57344
	s_add_u32 s70, s84, 0
	buffer_load_dwordx4 v42, s[36:39], s70 offen lds
	s_add_u32 m0, s85, 61440
	s_add_u32 s70, s84, 172032
	buffer_load_dwordx4 v42, s[36:39], s70 offen lds
	s_add_u32 m0, s85, 65536
	s_add_u32 s70, s84, 344064
	buffer_load_dwordx4 v42, s[36:39], s70 offen lds
	s_add_u32 m0, s85, 69632
	s_add_u32 s70, s84, 516096
	buffer_load_dwordx4 v42, s[36:39], s70 offen lds
	s_add_u32 m0, s85, 73728
	s_add_u32 s70, s84, 688128
	buffer_load_dwordx4 v42, s[36:39], s70 offen lds
	s_add_u32 m0, s85, 77824
	s_add_u32 s70, s84, 860160
	buffer_load_dwordx4 v42, s[36:39], s70 offen lds
	s_add_u32 m0, s85, 81920
	s_add_u32 s70, s84, 1032192
	buffer_load_dwordx4 v42, s[36:39], s70 offen lds
	v_add_f32 v54, v54, v55
	v_mov_b32 v55, v54
	s_nop 1
	v_permlane32_swap_b32 v54, v55
	v_add_f32 v54, v54, v55
	v_mul_f32 v234, 0xbb124925, v64
	v_mul_f32 v54, 0x3b124925, v54
	v_fma_f32 v54, -v234, v234, v54
	v_max_f32 v54, 0, v54
	v_add_f32 v54, 0x3727c5ac, v54
	v_rsq_f32 v235, v54
	s_waitcnt vmcnt(7)
	s_cmp_lg_u32 s46, 0
	s_cbranch_scc1 Lw_7
	s_waitcnt vmcnt(7)
Lw_7:
	s_barrier
	v_and_b32 v10, 31, v0
	v_lshrrev_b32 v11, 5, v0
	v_lshrrev_b32 v12, 3, v10
	v_sub_u32 v12, v10, v12
	v_lshlrev_b32 v12, 1, v12
	v_mul_u32_u24 v13, 224, v11
	v_add_u32 v12, v12, v13
	v_add_u32 v12, 86016, v12
	v_and_b32 v10, 7, v10
	ds_read_u16 v96, v12 offset:0
	ds_read_u16 v97, v12 offset:56
	ds_read_u16 v98, v12 offset:112
	ds_read_u16 v99, v12 offset:168
	ds_read_u16 v100, v12 offset:448
	ds_read_u16 v101, v12 offset:504
	ds_read_u16 v102, v12 offset:560
	ds_read_u16 v103, v12 offset:616
	ds_read_u16 v104, v12 offset:896
	ds_read_u16 v105, v12 offset:952
	ds_read_u16 v106, v12 offset:1008
	ds_read_u16 v107, v12 offset:1064
	ds_read_u16 v108, v12 offset:1344
	ds_read_u16 v109, v12 offset:1400
	ds_read_u16 v110, v12 offset:1456
	ds_read_u16 v111, v12 offset:1512
	s_cmp_lg_u32 s46, 3
	s_cbranch_scc1 Lw_8
	v_lshlrev_b32 v15, 7, v0
	s_mul_i32 s69, s2, 6272
	s_mov_b32 exec_lo, -1
	s_mov_b32 exec_hi, 0x1ffff
	buffer_load_dword v254, v15, s[12:15], s69 offen
	buffer_load_dword v254, v15, s[16:19], s69 offen
	buffer_load_dword v254, v15, s[20:23], s69 offen
	s_mul_i32 s69, s2, 1664
	s_mov_b64 exec, 0x1fff
	buffer_load_dword v254, v15, s[8:11], s69 offen
	s_mov_b64 exec, -1
Lw_8:
	v_cmp_gt_u32 vcc, 7, v10
	s_waitcnt lgkmcnt(0)
	v_lshl_or_b32 v96, v97, 16, v96
	v_lshl_or_b32 v98, v99, 16, v98
	v_lshl_or_b32 v100, v101, 16, v100
	v_lshl_or_b32 v102, v103, 16, v102
	v_lshl_or_b32 v104, v105, 16, v104
	v_lshl_or_b32 v106, v107, 16, v106
	v_lshl_or_b32 v108, v109, 16, v108
	v_lshl_or_b32 v110, v111, 16, v110
	v_cndmask_b32 v96, 0, v96, vcc
	v_cndmask_b32 v98, 0, v98, vcc
	v_cndmask_b32 v100, 0, v100, vcc
	v_cndmask_b32 v102, 0, v102, vcc
	v_cndmask_b32 v104, 0, v104, vcc
	v_cndmask_b32 v106, 0, v106, vcc
	v_cndmask_b32 v108, 0, v108, vcc
	v_cndmask_b32 v110, 0, v110, vcc
	v_cndmask_b32 v108, v108, 0, s[96:97]
	v_cndmask_b32 v110, v110, 0, s[96:97]
	v_accvgpr_write_b32 a248, v96
	v_accvgpr_write_b32 a249, v98
	v_accvgpr_write_b32 a250, v100
	v_accvgpr_write_b32 a251, v102
	v_accvgpr_write_b32 a252, v104
	v_accvgpr_write_b32 a253, v106
	v_accvgpr_write_b32 a254, v108
	v_accvgpr_write_b32 a255, v110
	s_nop 1
L_layer:
	s_cmp_lg_u32 s47, 0
	s_cbranch_scc1 Ll0_9
	s_add_u32 s51, s49, 1376256
	s_add_u32 s52, s49, 2293760
	s_add_u32 s53, s49, 1605632
	s_add_u32 s54, s49, 2326528
	s_add_u32 s55, s49, 1835008
	s_add_u32 s56, s49, 2359296
	s_add_u32 s57, s49, 2424832
	s_add_u32 s58, s49, 2949120
	s_branch Lle_10
Ll0_9:
	s_add_u32 s51, s49, 1835008
	s_add_u32 s52, s49, 2359296
	s_add_u32 s53, s49, 1605632
	s_add_u32 s54, s49, 2326528
	s_add_u32 s55, s49, 1835008
	s_add_u32 s56, s49, 2359296
	s_add_u32 s57, s49, 2424832
	s_add_u32 s58, s49, 2949120
Lle_10:
	s_lshl_b32 s68, s47, 4
	s_add_u32 s68, s68, s63
	s_lshl_b32 s59, s68, 13
	s_add_u32 s59, s59, 32768
	s_lshl_b32 s60, s68, 7
	s_add_u32 s60, s60, 16384
	s_lshl_b32 s61, s44, 11
	s_lshl_b32 s68, s47, 9
	s_add_u32 s61, s61, s68
	s_lshl_b32 s71, s64, 2
	s_add_u32 s71, s71, s46
	s_mul_i32 s82, s71, 3584
	s_add_u32 s82, s82, s52
	s_mul_i32 s83, s71, 28672
	s_add_u32 s83, s83, s51
	s_lshl_b32 s72, s71, 15
	s_add_u32 s72, s72, s57
	s_lshl_b32 s73, s63, 11
	s_add_u32 s85, s72, s73
	s_cmp_lg_u32 s47, 0
	s_cbranch_scc1 Lp1l1_11
	v_and_b32 v13, 7, v0
	v_lshlrev_b32 v233, 5, v13
	buffer_load_dword v232, v233, s[28:31], 0 offen sc1
	s_and_b32 s68, s46, 1
	s_mul_i32 s68, s68, 28672
	v_add_u32 v210, s68, v2
	v_mov_b32 v128, 0x3f803f80
	v_mov_b32 v129, 0x3f803f80
	v_mov_b32 v130, 0x3f803f80
	v_mov_b32 v131, 0x3f803f80
	ds_read_b64_tr_b16 v[64:65], v2 offset:0
	ds_read_b64_tr_b16 v[66:67], v2 offset:512
	ds_read_b64_tr_b16 v[68:69], v2 offset:28672
	ds_read_b64_tr_b16 v[70:71], v2 offset:29184
	ds_read_b64_tr_b16 v[132:133], v210 offset:0
	ds_read_b64_tr_b16 v[134:135], v210 offset:512
	ds_read_b64_tr_b16 v[72:73], v2 offset:1024
	ds_read_b64_tr_b16 v[74:75], v2 offset:1536
	ds_read_b64_tr_b16 v[76:77], v2 offset:29696
	ds_read_b64_tr_b16 v[78:79], v2 offset:30208
	ds_read_b64_tr_b16 v[136:137], v210 offset:1024
	ds_read_b64_tr_b16 v[138:139], v210 offset:1536
	s_waitcnt lgkmcnt(10)
	v_mfma_f32_32x32x16_bf16 v[16:31], v[64:67], a[0:3], 0
	ds_read_b64_tr_b16 v[216:217], v2 offset:2048
	ds_read_b64_tr_b16 v[218:219], v2 offset:2560
	s_waitcnt lgkmcnt(10)
	v_mfma_f32_32x32x16_bf16 v[32:47], v[68:71], a[0:3], 0
	ds_read_b64_tr_b16 v[220:221], v2 offset:30720
	ds_read_b64_tr_b16 v[222:223], v2 offset:31232
	s_waitcnt lgkmcnt(10)
	v_mfma_f32_32x32x16_bf16 v[112:127], v[132:135], v[128:131], 0
	ds_read_b64_tr_b16 v[140:141], v210 offset:2048
	ds_read_b64_tr_b16 v[142:143], v210 offset:2560
	s_waitcnt lgkmcnt(10)
	v_mfma_f32_32x32x16_bf16 v[16:31], v[72:75], a[4:7], v[16:31]
	ds_read_b64_tr_b16 v[64:65], v2 offset:3072
	ds_read_b64_tr_b16 v[66:67], v2 offset:3584
	s_waitcnt lgkmcnt(10)
	v_mfma_f32_32x32x16_bf16 v[32:47], v[76:79], a[4:7], v[32:47]
	ds_read_b64_tr_b16 v[68:69], v2 offset:31744
	ds_read_b64_tr_b16 v[70:71], v2 offset:32256
	s_waitcnt lgkmcnt(10)
	v_mfma_f32_32x32x16_bf16 v[112:127], v[136:139], v[128:131], v[112:127]
	ds_read_b64_tr_b16 v[132:133], v210 offset:3072
	ds_read_b64_tr_b16 v[134:135], v210 offset:3584
	s_waitcnt lgkmcnt(10)
	v_mfma_f32_32x32x16_bf16 v[16:31], v[216:219], a[8:11], v[16:31]
	ds_read_b64_tr_b16 v[72:73], v2 offset:4096
	ds_read_b64_tr_b16 v[74:75], v2 offset:4608
	s_waitcnt lgkmcnt(10)
	v_mfma_f32_32x32x16_bf16 v[32:47], v[220:223], a[8:11], v[32:47]
	ds_read_b64_tr_b16 v[76:77], v2 offset:32768
	ds_read_b64_tr_b16 v[78:79], v2 offset:33280
	s_waitcnt lgkmcnt(10)
	v_mfma_f32_32x32x16_bf16 v[112:127], v[140:143], v[128:131], v[112:127]
	ds_read_b64_tr_b16 v[136:137], v210 offset:4096
	ds_read_b64_tr_b16 v[138:139], v210 offset:4608
	s_waitcnt lgkmcnt(10)
	v_mfma_f32_32x32x16_bf16 v[16:31], v[64:67], a[12:15], v[16:31]
	ds_read_b64_tr_b16 v[216:217], v2 offset:5120
	ds_read_b64_tr_b16 v[218:219], v2 offset:5632
	s_waitcnt lgkmcnt(10)
	v_mfma_f32_32x32x16_bf16 v[32:47], v[68:71], a[12:15], v[32:47]
	ds_read_b64_tr_b16 v[220:221], v2 offset:33792
	ds_read_b64_tr_b16 v[222:223], v2 offset:34304
	s_waitcnt lgkmcnt(10)
	v_mfma_f32_32x32x16_bf16 v[112:127], v[132:135], v[128:131], v[112:127]
	ds_read_b64_tr_b16 v[140:141], v210 offset:5120
	ds_read_b64_tr_b16 v[142:143], v210 offset:5632
	s_waitcnt lgkmcnt(10)
	v_mfma_f32_32x32x16_bf16 v[16:31], v[72:75], a[16:19], v[16:31]
	ds_read_b64_tr_b16 v[64:65], v2 offset:6144
	ds_read_b64_tr_b16 v[66:67], v2 offset:6656
	s_waitcnt lgkmcnt(10)
	v_mfma_f32_32x32x16_bf16 v[32:47], v[76:79], a[16:19], v[32:47]
	ds_read_b64_tr_b16 v[68:69], v2 offset:34816
	ds_read_b64_tr_b16 v[70:71], v2 offset:35328
	s_waitcnt lgkmcnt(10)
	v_mfma_f32_32x32x16_bf16 v[112:127], v[136:139], v[128:131], v[112:127]
	ds_read_b64_tr_b16 v[132:133], v210 offset:6144
	ds_read_b64_tr_b16 v[134:135], v210 offset:6656
	s_waitcnt lgkmcnt(10)
	v_mfma_f32_32x32x16_bf16 v[16:31], v[216:219], a[20:23], v[16:31]
	ds_read_b64_tr_b16 v[72:73], v2 offset:7168
	ds_read_b64_tr_b16 v[74:75], v2 offset:7680
	s_waitcnt lgkmcnt(10)
	v_mfma_f32_32x32x16_bf16 v[32:47], v[220:223], a[20:23], v[32:47]
	ds_read_b64_tr_b16 v[76:77], v2 offset:35840
	ds_read_b64_tr_b16 v[78:79], v2 offset:36352
	s_waitcnt lgkmcnt(10)
	v_mfma_f32_32x32x16_bf16 v[112:127], v[140:143], v[128:131], v[112:127]
	ds_read_b64_tr_b16 v[136:137], v210 offset:7168
	ds_read_b64_tr_b16 v[138:139], v210 offset:7680
	s_waitcnt lgkmcnt(10)
	v_mfma_f32_32x32x16_bf16 v[16:31], v[64:67], a[24:27], v[16:31]
	ds_read_b64_tr_b16 v[216:217], v2 offset:8192
	ds_read_b64_tr_b16 v[218:219], v2 offset:8704
	s_waitcnt lgkmcnt(10)
	v_mfma_f32_32x32x16_bf16 v[32:47], v[68:71], a[24:27], v[32:47]
	ds_read_b64_tr_b16 v[220:221], v2 offset:36864
	ds_read_b64_tr_b16 v[222:223], v2 offset:37376
	s_waitcnt lgkmcnt(10)
	v_mfma_f32_32x32x16_bf16 v[112:127], v[132:135], v[128:131], v[112:127]
	ds_read_b64_tr_b16 v[140:141], v210 offset:8192
	ds_read_b64_tr_b16 v[142:143], v210 offset:8704
	s_waitcnt lgkmcnt(10)
	v_mfma_f32_32x32x16_bf16 v[16:31], v[72:75], a[28:31], v[16:31]
	ds_read_b64_tr_b16 v[64:65], v2 offset:9216
	ds_read_b64_tr_b16 v[66:67], v2 offset:9728
	s_waitcnt lgkmcnt(10)
	v_mfma_f32_32x32x16_bf16 v[32:47], v[76:79], a[28:31], v[32:47]
	ds_read_b64_tr_b16 v[68:69], v2 offset:37888
	ds_read_b64_tr_b16 v[70:71], v2 offset:38400
	s_waitcnt lgkmcnt(10)
	v_mfma_f32_32x32x16_bf16 v[112:127], v[136:139], v[128:131], v[112:127]
	ds_read_b64_tr_b16 v[132:133], v210 offset:9216
	ds_read_b64_tr_b16 v[134:135], v210 offset:9728
	s_waitcnt lgkmcnt(10)
	v_mfma_f32_32x32x16_bf16 v[16:31], v[216:219], a[32:35], v[16:31]
	ds_read_b64_tr_b16 v[72:73], v2 offset:10240
	ds_read_b64_tr_b16 v[74:75], v2 offset:10752
	s_waitcnt lgkmcnt(10)
	v_mfma_f32_32x32x16_bf16 v[32:47], v[220:223], a[32:35], v[32:47]
	ds_read_b64_tr_b16 v[76:77], v2 offset:38912
	ds_read_b64_tr_b16 v[78:79], v2 offset:39424
	s_waitcnt lgkmcnt(10)
	v_mfma_f32_32x32x16_bf16 v[112:127], v[140:143], v[128:131], v[112:127]
	ds_read_b64_tr_b16 v[136:137], v210 offset:10240
	ds_read_b64_tr_b16 v[138:139], v210 offset:10752
	s_waitcnt lgkmcnt(10)
	v_mfma_f32_32x32x16_bf16 v[16:31], v[64:67], a[36:39], v[16:31]
	ds_read_b64_tr_b16 v[216:217], v2 offset:11264
	ds_read_b64_tr_b16 v[218:219], v2 offset:11776
	s_waitcnt lgkmcnt(10)
	v_mfma_f32_32x32x16_bf16 v[32:47], v[68:71], a[36:39], v[32:47]
	ds_read_b64_tr_b16 v[220:221], v2 offset:39936
	ds_read_b64_tr_b16 v[222:223], v2 offset:40448
	s_waitcnt lgkmcnt(10)
	v_mfma_f32_32x32x16_bf16 v[112:127], v[132:135], v[128:131], v[112:127]
	ds_read_b64_tr_b16 v[140:141], v210 offset:11264
	ds_read_b64_tr_b16 v[142:143], v210 offset:11776
	s_waitcnt lgkmcnt(10)
	v_mfma_f32_32x32x16_bf16 v[16:31], v[72:75], a[40:43], v[16:31]
	ds_read_b64_tr_b16 v[64:65], v2 offset:12288
	ds_read_b64_tr_b16 v[66:67], v2 offset:12800
	s_waitcnt lgkmcnt(10)
	v_mfma_f32_32x32x16_bf16 v[32:47], v[76:79], a[40:43], v[32:47]
	ds_read_b64_tr_b16 v[68:69], v2 offset:40960
	ds_read_b64_tr_b16 v[70:71], v2 offset:41472
	s_waitcnt lgkmcnt(10)
	v_mfma_f32_32x32x16_bf16 v[112:127], v[136:139], v[128:131], v[112:127]
	ds_read_b64_tr_b16 v[132:133], v210 offset:12288
	ds_read_b64_tr_b16 v[134:135], v210 offset:12800
	s_waitcnt lgkmcnt(10)
	v_mfma_f32_32x32x16_bf16 v[16:31], v[216:219], a[44:47], v[16:31]
	ds_read_b64_tr_b16 v[72:73], v2 offset:13312
	ds_read_b64_tr_b16 v[74:75], v2 offset:13824
	s_waitcnt lgkmcnt(10)
	v_mfma_f32_32x32x16_bf16 v[32:47], v[220:223], a[44:47], v[32:47]
	ds_read_b64_tr_b16 v[76:77], v2 offset:41984
	ds_read_b64_tr_b16 v[78:79], v2 offset:42496
	s_waitcnt lgkmcnt(10)
	v_mfma_f32_32x32x16_bf16 v[112:127], v[140:143], v[128:131], v[112:127]
	ds_read_b64_tr_b16 v[136:137], v210 offset:13312
	ds_read_b64_tr_b16 v[138:139], v210 offset:13824
	s_waitcnt lgkmcnt(10)
	v_mfma_f32_32x32x16_bf16 v[16:31], v[64:67], a[48:51], v[16:31]
	ds_read_b64_tr_b16 v[216:217], v2 offset:14336
	ds_read_b64_tr_b16 v[218:219], v2 offset:14848
	s_waitcnt lgkmcnt(10)
	v_mfma_f32_32x32x16_bf16 v[32:47], v[68:71], a[48:51], v[32:47]
	ds_read_b64_tr_b16 v[220:221], v2 offset:43008
	ds_read_b64_tr_b16 v[222:223], v2 offset:43520
	s_waitcnt lgkmcnt(10)
	v_mfma_f32_32x32x16_bf16 v[112:127], v[132:135], v[128:131], v[112:127]
	ds_read_b64_tr_b16 v[140:141], v210 offset:14336
	ds_read_b64_tr_b16 v[142:143], v210 offset:14848
	s_waitcnt lgkmcnt(10)
	v_mfma_f32_32x32x16_bf16 v[16:31], v[72:75], a[52:55], v[16:31]
	ds_read_b64_tr_b16 v[64:65], v2 offset:15360
	ds_read_b64_tr_b16 v[66:67], v2 offset:15872
	s_waitcnt lgkmcnt(10)
	v_mfma_f32_32x32x16_bf16 v[32:47], v[76:79], a[52:55], v[32:47]
	ds_read_b64_tr_b16 v[68:69], v2 offset:44032
	ds_read_b64_tr_b16 v[70:71], v2 offset:44544
	s_waitcnt lgkmcnt(10)
	v_mfma_f32_32x32x16_bf16 v[112:127], v[136:139], v[128:131], v[112:127]
	ds_read_b64_tr_b16 v[132:133], v210 offset:15360
	ds_read_b64_tr_b16 v[134:135], v210 offset:15872
	s_waitcnt lgkmcnt(10)
	v_mfma_f32_32x32x16_bf16 v[16:31], v[216:219], a[56:59], v[16:31]
	ds_read_b64_tr_b16 v[72:73], v2 offset:16384
	ds_read_b64_tr_b16 v[74:75], v2 offset:16896
	s_waitcnt lgkmcnt(10)
	v_mfma_f32_32x32x16_bf16 v[32:47], v[220:223], a[56:59], v[32:47]
	ds_read_b64_tr_b16 v[76:77], v2 offset:45056
	ds_read_b64_tr_b16 v[78:79], v2 offset:45568
	s_waitcnt lgkmcnt(10)
	v_mfma_f32_32x32x16_bf16 v[112:127], v[140:143], v[128:131], v[112:127]
	ds_read_b64_tr_b16 v[136:137], v210 offset:16384
	ds_read_b64_tr_b16 v[138:139], v210 offset:16896
	s_waitcnt lgkmcnt(10)
	v_mfma_f32_32x32x16_bf16 v[16:31], v[64:67], a[60:63], v[16:31]
	ds_read_b64_tr_b16 v[216:217], v2 offset:17408
	ds_read_b64_tr_b16 v[218:219], v2 offset:17920
	s_waitcnt lgkmcnt(10)
	v_mfma_f32_32x32x16_bf16 v[32:47], v[68:71], a[60:63], v[32:47]
	ds_read_b64_tr_b16 v[220:221], v2 offset:46080
	ds_read_b64_tr_b16 v[222:223], v2 offset:46592
	s_waitcnt lgkmcnt(10)
	v_mfma_f32_32x32x16_bf16 v[112:127], v[132:135], v[128:131], v[112:127]
	ds_read_b64_tr_b16 v[140:141], v210 offset:17408
	ds_read_b64_tr_b16 v[142:143], v210 offset:17920
	s_waitcnt lgkmcnt(10)
	v_mfma_f32_32x32x16_bf16 v[16:31], v[72:75], a[64:67], v[16:31]
	ds_read_b64_tr_b16 v[64:65], v2 offset:18432
	ds_read_b64_tr_b16 v[66:67], v2 offset:18944
	s_waitcnt lgkmcnt(10)
	v_mfma_f32_32x32x16_bf16 v[32:47], v[76:79], a[64:67], v[32:47]
	ds_read_b64_tr_b16 v[68:69], v2 offset:47104
	ds_read_b64_tr_b16 v[70:71], v2 offset:47616
	s_waitcnt lgkmcnt(10)
	v_mfma_f32_32x32x16_bf16 v[112:127], v[136:139], v[128:131], v[112:127]
	ds_read_b64_tr_b16 v[132:133], v210 offset:18432
	ds_read_b64_tr_b16 v[134:135], v210 offset:18944
	s_waitcnt lgkmcnt(10)
	v_mfma_f32_32x32x16_bf16 v[16:31], v[216:219], a[68:71], v[16:31]
	ds_read_b64_tr_b16 v[72:73], v2 offset:19456
	ds_read_b64_tr_b16 v[74:75], v2 offset:19968
	s_waitcnt lgkmcnt(10)
	v_mfma_f32_32x32x16_bf16 v[32:47], v[220:223], a[68:71], v[32:47]
	ds_read_b64_tr_b16 v[76:77], v2 offset:48128
	ds_read_b64_tr_b16 v[78:79], v2 offset:48640
	s_waitcnt lgkmcnt(10)
	v_mfma_f32_32x32x16_bf16 v[112:127], v[140:143], v[128:131], v[112:127]
	ds_read_b64_tr_b16 v[136:137], v210 offset:19456
	ds_read_b64_tr_b16 v[138:139], v210 offset:19968
	s_waitcnt lgkmcnt(10)
	v_mfma_f32_32x32x16_bf16 v[16:31], v[64:67], a[72:75], v[16:31]
	ds_read_b64_tr_b16 v[216:217], v2 offset:20480
	ds_read_b64_tr_b16 v[218:219], v2 offset:20992
	s_waitcnt lgkmcnt(10)
	v_mfma_f32_32x32x16_bf16 v[32:47], v[68:71], a[72:75], v[32:47]
	ds_read_b64_tr_b16 v[220:221], v2 offset:49152
	ds_read_b64_tr_b16 v[222:223], v2 offset:49664
	s_waitcnt lgkmcnt(10)
	v_mfma_f32_32x32x16_bf16 v[112:127], v[132:135], v[128:131], v[112:127]
	ds_read_b64_tr_b16 v[140:141], v210 offset:20480
	ds_read_b64_tr_b16 v[142:143], v210 offset:20992
	s_waitcnt lgkmcnt(10)
	v_mfma_f32_32x32x16_bf16 v[16:31], v[72:75], a[76:79], v[16:31]
	ds_read_b64_tr_b16 v[64:65], v2 offset:21504
	ds_read_b64_tr_b16 v[66:67], v2 offset:22016
	s_waitcnt lgkmcnt(10)
	v_mfma_f32_32x32x16_bf16 v[32:47], v[76:79], a[76:79], v[32:47]
	ds_read_b64_tr_b16 v[68:69], v2 offset:50176
	ds_read_b64_tr_b16 v[70:71], v2 offset:50688
	s_waitcnt lgkmcnt(10)
	v_mfma_f32_32x32x16_bf16 v[112:127], v[136:139], v[128:131], v[112:127]
	ds_read_b64_tr_b16 v[132:133], v210 offset:21504
	ds_read_b64_tr_b16 v[134:135], v210 offset:22016
	s_waitcnt lgkmcnt(10)
	v_mfma_f32_32x32x16_bf16 v[16:31], v[216:219], a[80:83], v[16:31]
	ds_read_b64_tr_b16 v[72:73], v2 offset:22528
	ds_read_b64_tr_b16 v[74:75], v2 offset:23040
	s_waitcnt lgkmcnt(10)
	v_mfma_f32_32x32x16_bf16 v[32:47], v[220:223], a[80:83], v[32:47]
	ds_read_b64_tr_b16 v[76:77], v2 offset:51200
	ds_read_b64_tr_b16 v[78:79], v2 offset:51712
	s_waitcnt lgkmcnt(10)
	v_mfma_f32_32x32x16_bf16 v[112:127], v[140:143], v[128:131], v[112:127]
	ds_read_b64_tr_b16 v[136:137], v210 offset:22528
	ds_read_b64_tr_b16 v[138:139], v210 offset:23040
	s_waitcnt lgkmcnt(10)
	v_mfma_f32_32x32x16_bf16 v[16:31], v[64:67], a[84:87], v[16:31]
	ds_read_b64_tr_b16 v[216:217], v2 offset:23552
	ds_read_b64_tr_b16 v[218:219], v2 offset:24064
	s_waitcnt lgkmcnt(10)
	v_mfma_f32_32x32x16_bf16 v[32:47], v[68:71], a[84:87], v[32:47]
	ds_read_b64_tr_b16 v[220:221], v2 offset:52224
	ds_read_b64_tr_b16 v[222:223], v2 offset:52736
	s_waitcnt lgkmcnt(10)
	v_mfma_f32_32x32x16_bf16 v[112:127], v[132:135], v[128:131], v[112:127]
	ds_read_b64_tr_b16 v[140:141], v210 offset:23552
	ds_read_b64_tr_b16 v[142:143], v210 offset:24064
	s_waitcnt lgkmcnt(10)
	v_mfma_f32_32x32x16_bf16 v[16:31], v[72:75], a[88:91], v[16:31]
	ds_read_b64_tr_b16 v[64:65], v2 offset:24576
	ds_read_b64_tr_b16 v[66:67], v2 offset:25088
	s_waitcnt lgkmcnt(10)
	v_mfma_f32_32x32x16_bf16 v[32:47], v[76:79], a[88:91], v[32:47]
	ds_read_b64_tr_b16 v[68:69], v2 offset:53248
	ds_read_b64_tr_b16 v[70:71], v2 offset:53760
	s_waitcnt lgkmcnt(10)
	v_mfma_f32_32x32x16_bf16 v[112:127], v[136:139], v[128:131], v[112:127]
	ds_read_b64_tr_b16 v[132:133], v210 offset:24576
	ds_read_b64_tr_b16 v[134:135], v210 offset:25088
	s_waitcnt lgkmcnt(10)
	v_mfma_f32_32x32x16_bf16 v[16:31], v[216:219], a[92:95], v[16:31]
	ds_read_b64_tr_b16 v[72:73], v2 offset:25600
	ds_read_b64_tr_b16 v[74:75], v2 offset:26112
	s_waitcnt lgkmcnt(10)
	v_mfma_f32_32x32x16_bf16 v[32:47], v[220:223], a[92:95], v[32:47]
	ds_read_b64_tr_b16 v[76:77], v2 offset:54272
	ds_read_b64_tr_b16 v[78:79], v2 offset:54784
	s_waitcnt lgkmcnt(10)
	v_mfma_f32_32x32x16_bf16 v[112:127], v[140:143], v[128:131], v[112:127]
	ds_read_b64_tr_b16 v[136:137], v210 offset:25600
	ds_read_b64_tr_b16 v[138:139], v210 offset:26112
	s_waitcnt lgkmcnt(10)
	v_mfma_f32_32x32x16_bf16 v[16:31], v[64:67], a[96:99], v[16:31]
	ds_read_b64_tr_b16 v[216:217], v2 offset:26624
	ds_read_b64_tr_b16 v[218:219], v2 offset:27136
	s_waitcnt lgkmcnt(10)
	v_mfma_f32_32x32x16_bf16 v[32:47], v[68:71], a[96:99], v[32:47]
	ds_read_b64_tr_b16 v[220:221], v2 offset:55296
	ds_read_b64_tr_b16 v[222:223], v2 offset:55808
	s_waitcnt lgkmcnt(10)
	v_mfma_f32_32x32x16_bf16 v[112:127], v[132:135], v[128:131], v[112:127]
	ds_read_b64_tr_b16 v[140:141], v210 offset:26624
	ds_read_b64_tr_b16 v[142:143], v210 offset:27136
	s_waitcnt lgkmcnt(10)
	v_mfma_f32_32x32x16_bf16 v[16:31], v[72:75], a[100:103], v[16:31]
	ds_read_b64_tr_b16 v[64:65], v2 offset:27648
	ds_read_b64_tr_b16 v[66:67], v2 offset:28160
	s_waitcnt lgkmcnt(10)
	v_mfma_f32_32x32x16_bf16 v[32:47], v[76:79], a[100:103], v[32:47]
	ds_read_b64_tr_b16 v[68:69], v2 offset:56320
	ds_read_b64_tr_b16 v[70:71], v2 offset:56832
	s_waitcnt lgkmcnt(10)
	v_mfma_f32_32x32x16_bf16 v[112:127], v[136:139], v[128:131], v[112:127]
	ds_read_b64_tr_b16 v[132:133], v210 offset:27648
	ds_read_b64_tr_b16 v[134:135], v210 offset:28160
	s_waitcnt lgkmcnt(10)
	v_mfma_f32_32x32x16_bf16 v[16:31], v[216:219], a[104:107], v[16:31]
	s_waitcnt lgkmcnt(8)
	v_mfma_f32_32x32x16_bf16 v[32:47], v[220:223], a[104:107], v[32:47]
	s_waitcnt lgkmcnt(6)
	v_mfma_f32_32x32x16_bf16 v[112:127], v[140:143], v[128:131], v[112:127]
	s_waitcnt lgkmcnt(4)
	v_mfma_f32_32x32x16_bf16 v[16:31], v[64:67], a[108:111], v[16:31]
	s_waitcnt lgkmcnt(2)
	v_mfma_f32_32x32x16_bf16 v[32:47], v[68:71], a[108:111], v[32:47]
	s_waitcnt lgkmcnt(0)
	v_mfma_f32_32x32x16_bf16 v[112:127], v[132:135], v[128:131], v[112:127]
	s_cmp_ge_u32 s46, 2
	s_nop 10
	s_cbranch_scc1 Lw_13
	s_lshl_b32 s69, s46, 7
	s_add_u32 s69, s69, 161920
	v_add_u32 v211, s69, v8
	s_mov_b32 exec_lo, 1
	s_mov_b32 exec_hi, 1
	ds_write_b128 v211, v[112:115] offset:0
	ds_write_b128 v211, v[116:119] offset:32
	ds_write_b128 v211, v[120:123] offset:64
	ds_write_b128 v211, v[124:127] offset:96
	s_mov_b64 exec, -1
	s_waitcnt lgkmcnt(0)
Lw_13:
	s_waitcnt vmcnt(0)
	s_cmp_ge_u32 s46, 2
	s_cbranch_scc1 Lw_14
	s_mov_b32 s75, 0
	s_branch Lregc_17
Lreg_15:
	buffer_load_dword v232, v233, s[28:31], 0 offen sc1
Lregc_17:
	s_waitcnt vmcnt(0)
	v_lshrrev_b32 v13, 26, v232
	v_cmp_ne_u32 vcc, 32, v13
	s_add_u32 s75, s75, 1
	s_cmp_eq_u64 vcc, 0
	s_nop 2
	s_cbranch_scc1 Lregd_16
	s_cmp_lt_u32 s75, 100000
	s_cbranch_scc1 Lreg_15
	s_mov_b32 s50, 1
Lregd_16:
	s_cmp_lg_u32 s46, 0
	s_cbranch_scc1 Lw_18
	v_readlane_b32 s71, v232, s44
	s_mul_i32 s69, s62, s62
	s_lshl_b32 s69, s69, 10
	s_add_u32 s69, s69, s62
	s_lshl_b32 s69, s69, 5
	s_and_b32 s71, s71, 67108863
	s_cmp_lg_u32 s71, s69
	s_cselect_b32 s48, 1, 0
	s_cmp_eq_u32 s48, 0
	s_cbranch_scc1 Le_19
	s_lshl_b32 s68, s44, 11
	s_lshl_b32 s69, s45, 2
	s_add_u32 s68, s68, s69
	v_mov_b32 v14, 0
	v_lshlrev_b32 v13, 7, v0
	s_mov_b64 exec, 0xffff
	buffer_store_dword v14, v13, s[4:7], s68 offen sc1
	s_waitcnt vmcnt(0)
	s_mov_b64 exec, 1
	v_mov_b32 v14, 1
	s_lshl_b32 s69, s44, 5
	s_add_u32 s69, s69, 8
	buffer_atomic_add v14, off, s[28:31], s69 sc1
	s_mov_b64 exec, -1
	s_cmp_lg_u32 s50, 0
	s_cbranch_scc1 Ldone_21
	s_mov_b32 s75, 0
Lpoll_20:
	buffer_load_dword v14, off, s[28:31], s69 sc1
	s_waitcnt vmcnt(0)
	v_cmp_ne_u32 vcc, 32, v14
	s_add_u32 s75, s75, 1
	s_cmp_eq_u64 vcc, 0
	s_nop 2
	s_cbranch_scc1 Ldone_21
	s_cmp_lt_u32 s75, 100000
	s_cbranch_scc1 Lpoll_20
	s_mov_b32 s50, 1
Ldone_21:
Le_19:
Lw_18:
Lw_14:
	s_barrier
	s_lshl_b32 s68, s44, 1
	s_add_u32 s68, s68, s64
	s_lshl_b32 s69, s46, 4
	s_add_u32 s68, s68, s69
	s_add_u32 s69, s68, 64
	s_cmp_lt_u32 s69, 84
	s_cselect_b32 s70, s69, s68
	s_lshl_b32 s68, s68, 10
	s_lshl_b32 s70, s70, 10
	v_add_u32 v13, s68, v1
	v_add_u32 v14, s70, v1
	ds_read_b128 v[128:131], v13
	ds_read_b128 v[132:135], v14
	s_mul_i32 s69, s63, 86016
	s_add_u32 s69, s69, 1048576
	s_add_u32 s68, s68, s69
	s_add_u32 s70, s70, s69
	s_waitcnt lgkmcnt(0)
	buffer_store_dwordx4 v[128:131], v1, s[4:7], s68 offen sc1
	buffer_store_dwordx4 v[132:135], v1, s[4:7], s70 offen sc1
	s_barrier
	v_add_u32 v15, 161920, v8
	ds_read_b128 v[112:115], v15 offset:0
	ds_read_b128 v[116:119], v15 offset:32
	ds_read_b128 v[120:123], v15 offset:64
	ds_read_b128 v[124:127], v15 offset:96
	ds_read_b128 v[128:131], v15 offset:128
	ds_read_b128 v[132:135], v15 offset:160
	ds_read_b128 v[136:139], v15 offset:192
	ds_read_b128 v[140:143], v15 offset:224
	v_mov_b32 v10, v234
	v_mov_b32 v11, v235
	s_nop 1
	s_branch Lp1j_12
Lp1l1_11:
	buffer_load_dwordx4 v[96:99], v7, s[4:7], s82 offen offset:0 sc1
	buffer_load_dwordx4 v[100:103], v7, s[4:7], s82 offen offset:512 sc1
	buffer_load_dwordx4 v[104:107], v7, s[4:7], s82 offen offset:1024 sc1
	v_mov_b32 v14, 0x40000000
	v_cndmask_b32 v14, v7, v14, s[96:97]
	buffer_load_dwordx4 v[108:111], v14, s[4:7], s82 offen offset:1536 sc1
	s_add_u32 s84, s83, 0
	buffer_load_dwordx4 a[0:3], v1, s[4:7], s84 offen offset:0 sc1
	buffer_load_dwordx4 a[4:7], v1, s[4:7], s84 offen offset:1024 sc1
	buffer_load_dwordx4 a[8:11], v1, s[4:7], s84 offen offset:2048 sc1
	buffer_load_dwordx4 a[12:15], v1, s[4:7], s84 offen offset:3072 sc1
	s_add_u32 s84, s83, 4096
	buffer_load_dwordx4 a[16:19], v1, s[4:7], s84 offen offset:0 sc1
	buffer_load_dwordx4 a[20:23], v1, s[4:7], s84 offen offset:1024 sc1
	buffer_load_dwordx4 a[24:27], v1, s[4:7], s84 offen offset:2048 sc1
	buffer_load_dwordx4 a[28:31], v1, s[4:7], s84 offen offset:3072 sc1
	s_add_u32 s84, s83, 8192
	buffer_load_dwordx4 a[32:35], v1, s[4:7], s84 offen offset:0 sc1
	buffer_load_dwordx4 a[36:39], v1, s[4:7], s84 offen offset:1024 sc1
	buffer_load_dwordx4 a[40:43], v1, s[4:7], s84 offen offset:2048 sc1
	buffer_load_dwordx4 a[44:47], v1, s[4:7], s84 offen offset:3072 sc1
	v_add_u32 v15, 161920, v8
	ds_read_b64_tr_b16 v[64:65], v2 offset:0
	ds_read_b64_tr_b16 v[66:67], v2 offset:512
	ds_read_b64_tr_b16 v[68:69], v2 offset:28672
	ds_read_b64_tr_b16 v[70:71], v2 offset:29184
	ds_read_b64_tr_b16 v[72:73], v2 offset:1024
	ds_read_b64_tr_b16 v[74:75], v2 offset:1536
	ds_read_b64_tr_b16 v[76:77], v2 offset:29696
	ds_read_b64_tr_b16 v[78:79], v2 offset:30208
	s_waitcnt vmcnt(11)
	s_waitcnt lgkmcnt(6)
	v_mfma_f32_32x32x16_bf16 v[16:31], v[64:67], a[0:3], 0
	ds_read_b64_tr_b16 v[216:217], v2 offset:2048
	ds_read_b64_tr_b16 v[218:219], v2 offset:2560
	s_add_u32 s84, s83, 12288
	buffer_load_dwordx4 a[48:51], v1, s[4:7], s84 offen offset:0 sc1
	s_waitcnt lgkmcnt(6)
	v_mfma_f32_32x32x16_bf16 v[32:47], v[68:71], a[0:3], 0
	ds_read_b64_tr_b16 v[220:221], v2 offset:30720
	ds_read_b64_tr_b16 v[222:223], v2 offset:31232
	s_waitcnt vmcnt(11)
	s_waitcnt lgkmcnt(6)
	v_mfma_f32_32x32x16_bf16 v[16:31], v[72:75], a[4:7], v[16:31]
	ds_read_b64_tr_b16 v[64:65], v2 offset:3072
	ds_read_b64_tr_b16 v[66:67], v2 offset:3584
	buffer_load_dwordx4 a[52:55], v1, s[4:7], s84 offen offset:1024 sc1
	s_waitcnt lgkmcnt(6)
	v_mfma_f32_32x32x16_bf16 v[32:47], v[76:79], a[4:7], v[32:47]
	ds_read_b64_tr_b16 v[68:69], v2 offset:31744
	ds_read_b64_tr_b16 v[70:71], v2 offset:32256
	s_waitcnt vmcnt(11)
	s_waitcnt lgkmcnt(6)
	v_mfma_f32_32x32x16_bf16 v[16:31], v[216:219], a[8:11], v[16:31]
	ds_read_b64_tr_b16 v[72:73], v2 offset:4096
	ds_read_b64_tr_b16 v[74:75], v2 offset:4608
	buffer_load_dwordx4 a[56:59], v1, s[4:7], s84 offen offset:2048 sc1
	s_waitcnt lgkmcnt(6)
	v_mfma_f32_32x32x16_bf16 v[32:47], v[220:223], a[8:11], v[32:47]
	ds_read_b64_tr_b16 v[76:77], v2 offset:32768
	ds_read_b64_tr_b16 v[78:79], v2 offset:33280
	ds_read_b128 v[112:115], v15 offset:0
	ds_read_b128 v[116:119], v15 offset:32
	s_waitcnt vmcnt(11)
	s_waitcnt lgkmcnt(8)
	v_mfma_f32_32x32x16_bf16 v[16:31], v[64:67], a[12:15], v[16:31]
	ds_read_b64_tr_b16 v[216:217], v2 offset:5120
	ds_read_b64_tr_b16 v[218:219], v2 offset:5632
	buffer_load_dwordx4 a[60:63], v1, s[4:7], s84 offen offset:3072 sc1
	s_waitcnt lgkmcnt(8)
	v_mfma_f32_32x32x16_bf16 v[32:47], v[68:71], a[12:15], v[32:47]
	ds_read_b64_tr_b16 v[220:221], v2 offset:33792
	ds_read_b64_tr_b16 v[222:223], v2 offset:34304
	ds_read_b128 v[120:123], v15 offset:64
	ds_read_b128 v[124:127], v15 offset:96
	s_waitcnt vmcnt(11)
	s_waitcnt lgkmcnt(10)
	v_mfma_f32_32x32x16_bf16 v[16:31], v[72:75], a[16:19], v[16:31]
	ds_read_b64_tr_b16 v[64:65], v2 offset:6144
	ds_read_b64_tr_b16 v[66:67], v2 offset:6656
	s_add_u32 s84, s83, 16384
	buffer_load_dwordx4 a[64:67], v1, s[4:7], s84 offen offset:0 sc1
	s_waitcnt lgkmcnt(10)
	v_mfma_f32_32x32x16_bf16 v[32:47], v[76:79], a[16:19], v[32:47]
	ds_read_b64_tr_b16 v[68:69], v2 offset:34816
	ds_read_b64_tr_b16 v[70:71], v2 offset:35328
	ds_read_b128 v[128:131], v15 offset:128
	ds_read_b128 v[132:135], v15 offset:160
	s_waitcnt vmcnt(11)
	s_waitcnt lgkmcnt(10)
	v_mfma_f32_32x32x16_bf16 v[16:31], v[216:219], a[20:23], v[16:31]
	ds_read_b64_tr_b16 v[72:73], v2 offset:7168
	ds_read_b64_tr_b16 v[74:75], v2 offset:7680
	buffer_load_dwordx4 a[68:71], v1, s[4:7], s84 offen offset:1024 sc1
	s_waitcnt lgkmcnt(10)
	v_mfma_f32_32x32x16_bf16 v[32:47], v[220:223], a[20:23], v[32:47]
	ds_read_b64_tr_b16 v[76:77], v2 offset:35840
	ds_read_b64_tr_b16 v[78:79], v2 offset:36352
	ds_read_b128 v[136:139], v15 offset:192
	ds_read_b128 v[140:143], v15 offset:224
	s_waitcnt vmcnt(11)
	s_waitcnt lgkmcnt(10)
	v_mfma_f32_32x32x16_bf16 v[16:31], v[64:67], a[24:27], v[16:31]
	ds_read_b64_tr_b16 v[216:217], v2 offset:8192
	ds_read_b64_tr_b16 v[218:219], v2 offset:8704
	buffer_load_dwordx4 a[72:75], v1, s[4:7], s84 offen offset:2048 sc1
	s_waitcnt lgkmcnt(10)
	v_mfma_f32_32x32x16_bf16 v[32:47], v[68:71], a[24:27], v[32:47]
	ds_read_b64_tr_b16 v[220:221], v2 offset:36864
	ds_read_b64_tr_b16 v[222:223], v2 offset:37376
	v_add_f32 v98, v98, v102
	s_waitcnt vmcnt(11)
	s_waitcnt lgkmcnt(8)
	v_mfma_f32_32x32x16_bf16 v[16:31], v[72:75], a[28:31], v[16:31]
	ds_read_b64_tr_b16 v[64:65], v2 offset:9216
	ds_read_b64_tr_b16 v[66:67], v2 offset:9728
	buffer_load_dwordx4 a[76:79], v1, s[4:7], s84 offen offset:3072 sc1
	s_waitcnt lgkmcnt(8)
	v_mfma_f32_32x32x16_bf16 v[32:47], v[76:79], a[28:31], v[32:47]
	ds_read_b64_tr_b16 v[68:69], v2 offset:37888
	ds_read_b64_tr_b16 v[70:71], v2 offset:38400
	v_add_f32 v99, v99, v103
	v_add_f32 v96, v96, v100
	s_waitcnt vmcnt(11)
	s_waitcnt lgkmcnt(6)
	v_mfma_f32_32x32x16_bf16 v[16:31], v[216:219], a[32:35], v[16:31]
	ds_read_b64_tr_b16 v[72:73], v2 offset:10240
	ds_read_b64_tr_b16 v[74:75], v2 offset:10752
	s_add_u32 s84, s83, 20480
	buffer_load_dwordx4 a[80:83], v1, s[4:7], s84 offen offset:0 sc1
	s_waitcnt lgkmcnt(6)
	v_mfma_f32_32x32x16_bf16 v[32:47], v[220:223], a[32:35], v[32:47]
	ds_read_b64_tr_b16 v[76:77], v2 offset:38912
	ds_read_b64_tr_b16 v[78:79], v2 offset:39424
	v_add_f32 v97, v97, v101
	v_add_f32 v98, v98, v106
	s_waitcnt vmcnt(11)
	s_waitcnt lgkmcnt(6)
	v_mfma_f32_32x32x16_bf16 v[16:31], v[64:67], a[36:39], v[16:31]
	ds_read_b64_tr_b16 v[216:217], v2 offset:11264
	ds_read_b64_tr_b16 v[218:219], v2 offset:11776
	buffer_load_dwordx4 a[84:87], v1, s[4:7], s84 offen offset:1024 sc1
	s_waitcnt lgkmcnt(6)
	v_mfma_f32_32x32x16_bf16 v[32:47], v[68:71], a[36:39], v[32:47]
	ds_read_b64_tr_b16 v[220:221], v2 offset:39936
	ds_read_b64_tr_b16 v[222:223], v2 offset:40448
	v_add_f32 v99, v99, v107
	v_add_f32 v96, v96, v104
	s_waitcnt vmcnt(11)
	s_waitcnt lgkmcnt(6)
	v_mfma_f32_32x32x16_bf16 v[16:31], v[72:75], a[40:43], v[16:31]
	ds_read_b64_tr_b16 v[64:65], v2 offset:12288
	ds_read_b64_tr_b16 v[66:67], v2 offset:12800
	buffer_load_dwordx4 a[88:91], v1, s[4:7], s84 offen offset:2048 sc1
	s_waitcnt lgkmcnt(6)
	v_mfma_f32_32x32x16_bf16 v[32:47], v[76:79], a[40:43], v[32:47]
	ds_read_b64_tr_b16 v[68:69], v2 offset:40960
	ds_read_b64_tr_b16 v[70:71], v2 offset:41472
	v_add_f32 v97, v97, v105
	v_add_f32 v98, v98, v110
	s_waitcnt vmcnt(11)
	s_waitcnt lgkmcnt(6)
	v_mfma_f32_32x32x16_bf16 v[16:31], v[216:219], a[44:47], v[16:31]
	ds_read_b64_tr_b16 v[72:73], v2 offset:13312
	ds_read_b64_tr_b16 v[74:75], v2 offset:13824
	buffer_load_dwordx4 a[92:95], v1, s[4:7], s84 offen offset:3072 sc1
	s_waitcnt lgkmcnt(6)
	v_mfma_f32_32x32x16_bf16 v[32:47], v[220:223], a[44:47], v[32:47]
	ds_read_b64_tr_b16 v[76:77], v2 offset:41984
	ds_read_b64_tr_b16 v[78:79], v2 offset:42496
	v_add_f32 v99, v99, v111
	v_add_f32 v96, v96, v108
	s_waitcnt vmcnt(11)
	s_waitcnt lgkmcnt(6)
	v_mfma_f32_32x32x16_bf16 v[16:31], v[64:67], a[48:51], v[16:31]
	ds_read_b64_tr_b16 v[216:217], v2 offset:14336
	ds_read_b64_tr_b16 v[218:219], v2 offset:14848
	s_add_u32 s84, s83, 24576
	buffer_load_dwordx4 a[96:99], v1, s[4:7], s84 offen offset:0 sc1
	s_waitcnt lgkmcnt(6)
	v_mfma_f32_32x32x16_bf16 v[32:47], v[68:71], a[48:51], v[32:47]
	ds_read_b64_tr_b16 v[220:221], v2 offset:43008
	ds_read_b64_tr_b16 v[222:223], v2 offset:43520
	v_add_f32 v97, v97, v109
	v_add_f32 v96, v96, v98
	s_waitcnt vmcnt(11)
	s_waitcnt lgkmcnt(6)
	v_mfma_f32_32x32x16_bf16 v[16:31], v[72:75], a[52:55], v[16:31]
	ds_read_b64_tr_b16 v[64:65], v2 offset:15360
	ds_read_b64_tr_b16 v[66:67], v2 offset:15872
	buffer_load_dwordx4 a[100:103], v1, s[4:7], s84 offen offset:1024 sc1
	s_waitcnt lgkmcnt(6)
	v_mfma_f32_32x32x16_bf16 v[32:47], v[76:79], a[52:55], v[32:47]
	ds_read_b64_tr_b16 v[68:69], v2 offset:44032
	ds_read_b64_tr_b16 v[70:71], v2 offset:44544
	v_add_f32 v97, v97, v99
	v_mov_b32 v13, v96
	s_waitcnt vmcnt(11)
	s_waitcnt lgkmcnt(6)
	v_mfma_f32_32x32x16_bf16 v[16:31], v[216:219], a[56:59], v[16:31]
	ds_read_b64_tr_b16 v[72:73], v2 offset:16384
	ds_read_b64_tr_b16 v[74:75], v2 offset:16896
	buffer_load_dwordx4 a[104:107], v1, s[4:7], s84 offen offset:2048 sc1
	s_waitcnt lgkmcnt(6)
	v_mfma_f32_32x32x16_bf16 v[32:47], v[220:223], a[56:59], v[32:47]
	ds_read_b64_tr_b16 v[76:77], v2 offset:45056
	ds_read_b64_tr_b16 v[78:79], v2 offset:45568
	v_mov_b32 v14, v97
	v_permlane32_swap_b32 v96, v13
	s_waitcnt vmcnt(11)
	s_waitcnt lgkmcnt(6)
	v_mfma_f32_32x32x16_bf16 v[16:31], v[64:67], a[60:63], v[16:31]
	ds_read_b64_tr_b16 v[216:217], v2 offset:17408
	ds_read_b64_tr_b16 v[218:219], v2 offset:17920
	buffer_load_dwordx4 a[108:111], v1, s[4:7], s84 offen offset:3072 sc1
	s_waitcnt lgkmcnt(6)
	v_mfma_f32_32x32x16_bf16 v[32:47], v[68:71], a[60:63], v[32:47]
	ds_read_b64_tr_b16 v[220:221], v2 offset:46080
	ds_read_b64_tr_b16 v[222:223], v2 offset:46592
	v_permlane32_swap_b32 v97, v14
	v_add_f32 v96, v96, v13
	s_waitcnt vmcnt(11)
	s_waitcnt lgkmcnt(6)
	v_mfma_f32_32x32x16_bf16 v[16:31], v[72:75], a[64:67], v[16:31]
	ds_read_b64_tr_b16 v[64:65], v2 offset:18432
	ds_read_b64_tr_b16 v[66:67], v2 offset:18944
	s_waitcnt lgkmcnt(6)
	v_mfma_f32_32x32x16_bf16 v[32:47], v[76:79], a[64:67], v[32:47]
	ds_read_b64_tr_b16 v[68:69], v2 offset:47104
	ds_read_b64_tr_b16 v[70:71], v2 offset:47616
	v_add_f32 v97, v97, v14
	v_mul_f32 v10, 0xbb124925, v96
	s_waitcnt vmcnt(10)
	s_waitcnt lgkmcnt(6)
	v_mfma_f32_32x32x16_bf16 v[16:31], v[216:219], a[68:71], v[16:31]
	ds_read_b64_tr_b16 v[72:73], v2 offset:19456
	ds_read_b64_tr_b16 v[74:75], v2 offset:19968
	s_waitcnt lgkmcnt(6)
	v_mfma_f32_32x32x16_bf16 v[32:47], v[220:223], a[68:71], v[32:47]
	ds_read_b64_tr_b16 v[76:77], v2 offset:48128
	ds_read_b64_tr_b16 v[78:79], v2 offset:48640
	v_mul_f32 v97, 0x3b124925, v97
	v_fma_f32 v97, -v10, v10, v97
	s_waitcnt vmcnt(9)
	s_waitcnt lgkmcnt(6)
	v_mfma_f32_32x32x16_bf16 v[16:31], v[64:67], a[72:75], v[16:31]
	ds_read_b64_tr_b16 v[216:217], v2 offset:20480
	ds_read_b64_tr_b16 v[218:219], v2 offset:20992
	s_waitcnt lgkmcnt(6)
	v_mfma_f32_32x32x16_bf16 v[32:47], v[68:71], a[72:75], v[32:47]
	ds_read_b64_tr_b16 v[220:221], v2 offset:49152
	ds_read_b64_tr_b16 v[222:223], v2 offset:49664
	v_max_f32 v97, 0, v97
	v_add_f32 v97, 0x3727c5ac, v97
	s_waitcnt vmcnt(8)
	s_waitcnt lgkmcnt(6)
	v_mfma_f32_32x32x16_bf16 v[16:31], v[72:75], a[76:79], v[16:31]
	ds_read_b64_tr_b16 v[64:65], v2 offset:21504
	ds_read_b64_tr_b16 v[66:67], v2 offset:22016
	s_waitcnt lgkmcnt(6)
	v_mfma_f32_32x32x16_bf16 v[32:47], v[76:79], a[76:79], v[32:47]
	ds_read_b64_tr_b16 v[68:69], v2 offset:50176
	ds_read_b64_tr_b16 v[70:71], v2 offset:50688
	v_rsq_f32 v11, v97
	s_waitcnt vmcnt(7)
	s_waitcnt lgkmcnt(6)
	v_mfma_f32_32x32x16_bf16 v[16:31], v[216:219], a[80:83], v[16:31]
	ds_read_b64_tr_b16 v[72:73], v2 offset:22528
	ds_read_b64_tr_b16 v[74:75], v2 offset:23040
	s_waitcnt lgkmcnt(6)
	v_mfma_f32_32x32x16_bf16 v[32:47], v[220:223], a[80:83], v[32:47]
	ds_read_b64_tr_b16 v[76:77], v2 offset:51200
	ds_read_b64_tr_b16 v[78:79], v2 offset:51712
	s_waitcnt vmcnt(6)
	s_waitcnt lgkmcnt(6)
	v_mfma_f32_32x32x16_bf16 v[16:31], v[64:67], a[84:87], v[16:31]
	ds_read_b64_tr_b16 v[216:217], v2 offset:23552
	ds_read_b64_tr_b16 v[218:219], v2 offset:24064
	s_waitcnt lgkmcnt(6)
	v_mfma_f32_32x32x16_bf16 v[32:47], v[68:71], a[84:87], v[32:47]
	ds_read_b64_tr_b16 v[220:221], v2 offset:52224
	ds_read_b64_tr_b16 v[222:223], v2 offset:52736
	s_waitcnt vmcnt(5)
	s_waitcnt lgkmcnt(6)
	v_mfma_f32_32x32x16_bf16 v[16:31], v[72:75], a[88:91], v[16:31]
	ds_read_b64_tr_b16 v[64:65], v2 offset:24576
	ds_read_b64_tr_b16 v[66:67], v2 offset:25088
	s_waitcnt lgkmcnt(6)
	v_mfma_f32_32x32x16_bf16 v[32:47], v[76:79], a[88:91], v[32:47]
	ds_read_b64_tr_b16 v[68:69], v2 offset:53248
	ds_read_b64_tr_b16 v[70:71], v2 offset:53760
	s_waitcnt vmcnt(4)
	s_waitcnt lgkmcnt(6)
	v_mfma_f32_32x32x16_bf16 v[16:31], v[216:219], a[92:95], v[16:31]
	ds_read_b64_tr_b16 v[72:73], v2 offset:25600
	ds_read_b64_tr_b16 v[74:75], v2 offset:26112
	s_waitcnt lgkmcnt(6)
	v_mfma_f32_32x32x16_bf16 v[32:47], v[220:223], a[92:95], v[32:47]
	ds_read_b64_tr_b16 v[76:77], v2 offset:54272
	ds_read_b64_tr_b16 v[78:79], v2 offset:54784
	s_waitcnt vmcnt(3)
	s_waitcnt lgkmcnt(6)
	v_mfma_f32_32x32x16_bf16 v[16:31], v[64:67], a[96:99], v[16:31]
	ds_read_b64_tr_b16 v[216:217], v2 offset:26624
	ds_read_b64_tr_b16 v[218:219], v2 offset:27136
	s_waitcnt lgkmcnt(6)
	v_mfma_f32_32x32x16_bf16 v[32:47], v[68:71], a[96:99], v[32:47]
	ds_read_b64_tr_b16 v[220:221], v2 offset:55296
	ds_read_b64_tr_b16 v[222:223], v2 offset:55808
	s_waitcnt vmcnt(2)
	s_waitcnt lgkmcnt(6)
	v_mfma_f32_32x32x16_bf16 v[16:31], v[72:75], a[100:103], v[16:31]
	ds_read_b64_tr_b16 v[64:65], v2 offset:27648
	ds_read_b64_tr_b16 v[66:67], v2 offset:28160
	s_waitcnt lgkmcnt(6)
	v_mfma_f32_32x32x16_bf16 v[32:47], v[76:79], a[100:103], v[32:47]
	ds_read_b64_tr_b16 v[68:69], v2 offset:56320
	ds_read_b64_tr_b16 v[70:71], v2 offset:56832
	s_waitcnt vmcnt(1)
	s_waitcnt lgkmcnt(6)
	v_mfma_f32_32x32x16_bf16 v[16:31], v[216:219], a[104:107], v[16:31]
	s_waitcnt lgkmcnt(4)
	v_mfma_f32_32x32x16_bf16 v[32:47], v[220:223], a[104:107], v[32:47]
	s_waitcnt vmcnt(0)
	s_waitcnt lgkmcnt(2)
	v_mfma_f32_32x32x16_bf16 v[16:31], v[64:67], a[108:111], v[16:31]
	s_waitcnt lgkmcnt(0)
	v_mfma_f32_32x32x16_bf16 v[32:47], v[68:71], a[108:111], v[32:47]
	s_barrier
	s_nop 10
Lp1j_12:
	v_mul_f32 v12, 0x3fb8aa3b, v11
	s_waitcnt lgkmcnt(0)
	s_lshl_b32 s90, s45, 7
	s_mul_i32 s91, s46, 28672
	s_add_u32 s90, s90, s91
	s_lshl_b32 s91, s46, 10
	v_pk_fma_f32 v[16:17], v[112:113], v[10:11], v[16:17] op_sel_hi:[1,0,1]
	v_pk_fma_f32 v[18:19], v[114:115], v[10:11], v[18:19] op_sel_hi:[1,0,1]
	v_pk_fma_f32 v[20:21], v[116:117], v[10:11], v[20:21] op_sel_hi:[1,0,1]
	v_pk_fma_f32 v[22:23], v[118:119], v[10:11], v[22:23] op_sel_hi:[1,0,1]
	v_pk_fma_f32 v[24:25], v[120:121], v[10:11], v[24:25] op_sel_hi:[1,0,1]
	v_pk_fma_f32 v[26:27], v[122:123], v[10:11], v[26:27] op_sel_hi:[1,0,1]
	v_pk_fma_f32 v[28:29], v[124:125], v[10:11], v[28:29] op_sel_hi:[1,0,1]
	v_pk_fma_f32 v[30:31], v[126:127], v[10:11], v[30:31] op_sel_hi:[1,0,1]
	v_cvt_pk_bf16_f32 v144, v16, v17
	v_cvt_pk_bf16_f32 v145, v18, v19
	v_cvt_pk_bf16_f32 v146, v20, v21
	v_cvt_pk_bf16_f32 v147, v22, v23
	v_cvt_pk_bf16_f32 v148, v24, v25
	v_cvt_pk_bf16_f32 v149, v26, v27
	v_cvt_pk_bf16_f32 v150, v28, v29
	v_cvt_pk_bf16_f32 v151, v30, v31
	v_mfma_f32_32x32x16_bf16 v[80:95], a[248:251], v[144:147], 0
	s_nop 0
	v_mfma_f32_32x32x16_bf16 v[80:95], a[252:255], v[148:151], v[80:95]
	v_pk_fma_f32 v[32:33], v[128:129], v[10:11], v[32:33] op_sel_hi:[1,0,1]
	v_pk_fma_f32 v[34:35], v[130:131], v[10:11], v[34:35] op_sel_hi:[1,0,1]
	v_pk_fma_f32 v[36:37], v[132:133], v[10:11], v[36:37] op_sel_hi:[1,0,1]
	v_pk_fma_f32 v[38:39], v[134:135], v[10:11], v[38:39] op_sel_hi:[1,0,1]
	s_add_u32 m0, s91, 0
	s_add_u32 s92, s90, 0
	buffer_load_dwordx4 v6, s[12:15], s92 offen lds
	v_pk_fma_f32 v[40:41], v[136:137], v[10:11], v[40:41] op_sel_hi:[1,0,1]
	v_pk_fma_f32 v[42:43], v[138:139], v[10:11], v[42:43] op_sel_hi:[1,0,1]
	v_pk_fma_f32 v[44:45], v[140:141], v[10:11], v[44:45] op_sel_hi:[1,0,1]
	v_pk_fma_f32 v[46:47], v[142:143], v[10:11], v[46:47] op_sel_hi:[1,0,1]
	v_pk_mul_f32 v[32:33], v[32:33], v[10:11] op_sel:[0,1] op_sel_hi:[1,1]
	v_pk_mul_f32 v[34:35], v[34:35], v[10:11] op_sel:[0,1] op_sel_hi:[1,1]
	v_pk_mul_f32 v[36:37], v[36:37], v[10:11] op_sel:[0,1] op_sel_hi:[1,1]
	v_pk_mul_f32 v[38:39], v[38:39], v[10:11] op_sel:[0,1] op_sel_hi:[1,1]
	v_pk_mul_f32 v[40:41], v[40:41], v[10:11] op_sel:[0,1] op_sel_hi:[1,1]
	v_pk_mul_f32 v[42:43], v[42:43], v[10:11] op_sel:[0,1] op_sel_hi:[1,1]
	v_pk_mul_f32 v[44:45], v[44:45], v[10:11] op_sel:[0,1] op_sel_hi:[1,1]
	v_pk_mul_f32 v[46:47], v[46:47], v[10:11] op_sel:[0,1] op_sel_hi:[1,1]
	v_cndmask_b32 v44, v44, 1.0, s[96:97]
	v_cvt_pk_bf16_f32 v128, v32, v33
	v_cvt_pk_bf16_f32 v129, v34, v35
	v_cvt_pk_bf16_f32 v130, v36, v37
	v_cvt_pk_bf16_f32 v131, v38, v39
	v_cvt_pk_bf16_f32 v132, v40, v41
	v_cvt_pk_bf16_f32 v133, v42, v43
	v_cvt_pk_bf16_f32 v134, v44, v45
	v_cvt_pk_bf16_f32 v135, v46, v47
	v_xor_b32 v136, 0, v241
	s_add_u32 m0, s91, 4096
	s_add_u32 s92, s90, 114688
	buffer_load_dwordx4 v6, s[12:15], s92 offen lds
	ds_write_b64 v136, v[128:129]
	v_xor_b32 v137, 16, v241
	ds_write_b64 v137, v[130:131]
	v_xor_b32 v136, 32, v241
	ds_write_b64 v136, v[132:133]
	v_xor_b32 v137, 48, v241
	ds_write_b64 v137, v[134:135]
	v_cndmask_b32 v83, v83, v80, s[96:97]
	v_cndmask_b32 v87, v87, v80, s[96:97]
	v_cndmask_b32 v91, v91, v80, s[96:97]
	v_cndmask_b32 v95, v95, v80, s[96:97]
	v_max3_f32 v152, v80, v81, v82
	v_min3_f32 v153, v80, v81, v82
	v_max3_f32 v154, v83, v84, v85
	v_min3_f32 v155, v83, v84, v85
	v_max3_f32 v152, v152, v86, v87
	v_min3_f32 v153, v153, v86, v87
	v_max3_f32 v154, v154, v88, v89
	v_min3_f32 v155, v155, v88, v89
	v_max3_f32 v152, v152, v90, v91
	v_min3_f32 v153, v153, v90, v91
	v_max3_f32 v154, v154, v92, v93
	s_add_u32 m0, s91, 8192
	s_add_u32 s92, s90, 229376
	buffer_load_dwordx4 v6, s[12:15], s92 offen lds
	v_min3_f32 v155, v155, v92, v93
	v_max3_f32 v152, v152, v94, v95
	v_min3_f32 v153, v153, v94, v95
	v_max_f32 v152, v152, v154
	v_min_f32 v153, v153, v155
	v_mov_b32 v154, v152
	v_mov_b32 v155, v153
	s_nop 0
	v_permlane32_swap_b32 v152, v154
	v_permlane32_swap_b32 v153, v155
	v_max_f32 v152, v152, v154
	v_min_f32 v153, v153, v155
	v_mul_f32 v152, v152, v12
	v_mul_f32 v153, v153, v12
	v_pk_fma_f32 v[96:97], v[80:81], v[12:13], v[152:153] op_sel:[0,0,0] op_sel_hi:[1,0,0] neg_lo:[0,0,1] neg_hi:[0,0,1]
	v_pk_fma_f32 v[192:193], v[80:81], v[12:13], v[152:153] op_sel:[0,0,1] op_sel_hi:[1,0,1] neg_lo:[1,0,0] neg_hi:[1,0,0]
	v_pk_fma_f32 v[98:99], v[82:83], v[12:13], v[152:153] op_sel:[0,0,0] op_sel_hi:[1,0,0] neg_lo:[0,0,1] neg_hi:[0,0,1]
	v_pk_fma_f32 v[194:195], v[82:83], v[12:13], v[152:153] op_sel:[0,0,1] op_sel_hi:[1,0,1] neg_lo:[1,0,0] neg_hi:[1,0,0]
	v_pk_fma_f32 v[100:101], v[84:85], v[12:13], v[152:153] op_sel:[0,0,0] op_sel_hi:[1,0,0] neg_lo:[0,0,1] neg_hi:[0,0,1]
	v_pk_fma_f32 v[196:197], v[84:85], v[12:13], v[152:153] op_sel:[0,0,1] op_sel_hi:[1,0,1] neg_lo:[1,0,0] neg_hi:[1,0,0]
	v_pk_fma_f32 v[102:103], v[86:87], v[12:13], v[152:153] op_sel:[0,0,0] op_sel_hi:[1,0,0] neg_lo:[0,0,1] neg_hi:[0,0,1]
	v_pk_fma_f32 v[198:199], v[86:87], v[12:13], v[152:153] op_sel:[0,0,1] op_sel_hi:[1,0,1] neg_lo:[1,0,0] neg_hi:[1,0,0]
	v_pk_fma_f32 v[104:105], v[88:89], v[12:13], v[152:153] op_sel:[0,0,0] op_sel_hi:[1,0,0] neg_lo:[0,0,1] neg_hi:[0,0,1]
	s_add_u32 m0, s91, 12288
	s_add_u32 s92, s90, 344064
	buffer_load_dwordx4 v6, s[12:15], s92 offen lds
	v_pk_fma_f32 v[200:201], v[88:89], v[12:13], v[152:153] op_sel:[0,0,1] op_sel_hi:[1,0,1] neg_lo:[1,0,0] neg_hi:[1,0,0]
	v_pk_fma_f32 v[106:107], v[90:91], v[12:13], v[152:153] op_sel:[0,0,0] op_sel_hi:[1,0,0] neg_lo:[0,0,1] neg_hi:[0,0,1]
	v_pk_fma_f32 v[202:203], v[90:91], v[12:13], v[152:153] op_sel:[0,0,1] op_sel_hi:[1,0,1] neg_lo:[1,0,0] neg_hi:[1,0,0]
	v_pk_fma_f32 v[108:109], v[92:93], v[12:13], v[152:153] op_sel:[0,0,0] op_sel_hi:[1,0,0] neg_lo:[0,0,1] neg_hi:[0,0,1]
	v_pk_fma_f32 v[204:205], v[92:93], v[12:13], v[152:153] op_sel:[0,0,1] op_sel_hi:[1,0,1] neg_lo:[1,0,0] neg_hi:[1,0,0]
	v_pk_fma_f32 v[110:111], v[94:95], v[12:13], v[152:153] op_sel:[0,0,0] op_sel_hi:[1,0,0] neg_lo:[0,0,1] neg_hi:[0,0,1]
	v_pk_fma_f32 v[206:207], v[94:95], v[12:13], v[152:153] op_sel:[0,0,1] op_sel_hi:[1,0,1] neg_lo:[1,0,0] neg_hi:[1,0,0]
	v_exp_f32 v96, v96
	v_exp_f32 v192, v192
	v_exp_f32 v97, v97
	v_exp_f32 v193, v193
	v_exp_f32 v98, v98
	v_exp_f32 v194, v194
	v_exp_f32 v99, v99
	v_exp_f32 v195, v195
	v_exp_f32 v100, v100
	v_exp_f32 v196, v196
	v_exp_f32 v101, v101
	v_exp_f32 v197, v197
	v_exp_f32 v102, v102
	v_exp_f32 v198, v198
	v_exp_f32 v103, v103
	s_add_u32 m0, s91, 16384
	s_add_u32 s92, s90, 458752
	buffer_load_dwordx4 v6, s[12:15], s92 offen lds
	v_exp_f32 v199, v199
	v_exp_f32 v104, v104
	v_exp_f32 v200, v200
	v_exp_f32 v105, v105
	v_exp_f32 v201, v201
	v_exp_f32 v106, v106
	v_exp_f32 v202, v202
	v_exp_f32 v107, v107
	v_exp_f32 v203, v203
	v_exp_f32 v108, v108
	v_exp_f32 v204, v204
	v_exp_f32 v109, v109
	v_exp_f32 v205, v205
	v_exp_f32 v110, v110
	v_exp_f32 v206, v206
	v_exp_f32 v111, v111
	v_exp_f32 v207, v207
	v_cndmask_b32 v99, v99, 0, s[96:97]
	v_cndmask_b32 v195, v195, 0, s[96:97]
	v_cndmask_b32 v103, v103, 0, s[96:97]
	v_cndmask_b32 v199, v199, 0, s[96:97]
	v_cndmask_b32 v107, v107, 0, s[96:97]
	s_add_u32 m0, s91, 20480
	s_add_u32 s92, s90, 573440
	buffer_load_dwordx4 v6, s[12:15], s92 offen lds
	v_cndmask_b32 v203, v203, 0, s[96:97]
	v_cndmask_b32 v111, v111, 0, s[96:97]
	v_cndmask_b32 v207, v207, 0, s[96:97]
	v_pk_add_f32 v[152:153], v[96:97], v[98:99]
	v_pk_add_f32 v[154:155], v[192:193], v[194:195]
	v_pk_add_f32 v[156:157], v[100:101], v[102:103]
	v_pk_add_f32 v[158:159], v[196:197], v[198:199]
	v_pk_add_f32 v[152:153], v[152:153], v[104:105]
	v_pk_add_f32 v[154:155], v[154:155], v[200:201]
	v_pk_add_f32 v[156:157], v[156:157], v[106:107]
	v_pk_add_f32 v[158:159], v[158:159], v[202:203]
	v_pk_add_f32 v[152:153], v[152:153], v[108:109]
	v_pk_add_f32 v[154:155], v[154:155], v[204:205]
	v_pk_add_f32 v[156:157], v[156:157], v[110:111]
	v_pk_add_f32 v[158:159], v[158:159], v[206:207]
	v_pk_add_f32 v[152:153], v[152:153], v[156:157]
	v_pk_add_f32 v[154:155], v[154:155], v[158:159]
	v_add_f32 v152, v152, v153
	v_add_f32 v154, v154, v155
	v_mov_b32 v153, v152
	v_mov_b32 v155, v154
	s_nop 0
	v_permlane32_swap_b32 v152, v153
	s_add_u32 m0, s91, 24576
	s_add_u32 s92, s90, 688128
	buffer_load_dwordx4 v6, s[12:15], s92 offen lds
	v_permlane32_swap_b32 v154, v155
	v_add_f32 v152, v152, v153
	v_add_f32 v154, v154, v155
	v_rcp_f32 v152, v152
	v_rcp_f32 v154, v154
	v_pk_mul_f32 v[96:97], v[96:97], v[152:153] op_sel_hi:[1,0]
	v_pk_mul_f32 v[192:193], v[192:193], v[154:155] op_sel_hi:[1,0]
	v_pk_mul_f32 v[98:99], v[98:99], v[152:153] op_sel_hi:[1,0]
	v_pk_mul_f32 v[194:195], v[194:195], v[154:155] op_sel_hi:[1,0]
	v_pk_mul_f32 v[100:101], v[100:101], v[152:153] op_sel_hi:[1,0]
	v_pk_mul_f32 v[196:197], v[196:197], v[154:155] op_sel_hi:[1,0]
	v_pk_mul_f32 v[102:103], v[102:103], v[152:153] op_sel_hi:[1,0]
	v_pk_mul_f32 v[198:199], v[198:199], v[154:155] op_sel_hi:[1,0]
	v_pk_mul_f32 v[104:105], v[104:105], v[152:153] op_sel_hi:[1,0]
	v_pk_mul_f32 v[200:201], v[200:201], v[154:155] op_sel_hi:[1,0]
	v_pk_mul_f32 v[106:107], v[106:107], v[152:153] op_sel_hi:[1,0]
	v_pk_mul_f32 v[202:203], v[202:203], v[154:155] op_sel_hi:[1,0]
	v_pk_mul_f32 v[108:109], v[108:109], v[152:153] op_sel_hi:[1,0]
	v_pk_mul_f32 v[204:205], v[204:205], v[154:155] op_sel_hi:[1,0]
	v_pk_mul_f32 v[110:111], v[110:111], v[152:153] op_sel_hi:[1,0]
	v_pk_mul_f32 v[206:207], v[206:207], v[154:155] op_sel_hi:[1,0]
	v_cvt_pk_bf16_f32 v176, v96, v97
	s_add_u32 m0, s91, 28672
	s_add_u32 s92, s90, 802816
	buffer_load_dwordx4 v6, s[12:15], s92 offen lds
	v_cvt_pk_bf16_f32 v184, v192, v193
	v_cvt_pk_bf16_f32 v177, v98, v99
	v_cvt_pk_bf16_f32 v185, v194, v195
	v_cvt_pk_bf16_f32 v178, v100, v101
	v_cvt_pk_bf16_f32 v186, v196, v197
	v_cvt_pk_bf16_f32 v179, v102, v103
	v_cvt_pk_bf16_f32 v187, v198, v199
	v_cvt_pk_bf16_f32 v180, v104, v105
	v_cvt_pk_bf16_f32 v188, v200, v201
	v_cvt_pk_bf16_f32 v181, v106, v107
	v_cvt_pk_bf16_f32 v189, v202, v203
	v_cvt_pk_bf16_f32 v182, v108, v109
	v_cvt_pk_bf16_f32 v190, v204, v205
	v_cvt_pk_bf16_f32 v183, v110, v111
	v_cvt_pk_bf16_f32 v191, v206, v207
	v_xor_b32 v156, 0, v240
	ds_write_b64 v156, v[176:177]
	v_xor_b32 v157, 16, v240
	ds_write_b64 v157, v[178:179]
	v_xor_b32 v156, 32, v240
	ds_write_b64 v156, v[180:181]
	v_xor_b32 v157, 48, v240
	s_add_u32 m0, s91, 32768
	s_add_u32 s92, s90, 917504
	buffer_load_dwordx4 v6, s[12:15], s92 offen lds
	ds_write_b64 v157, v[182:183]
	v_xor_b32 v156, 64, v240
	ds_write_b64 v156, v[184:185]
	v_xor_b32 v157, 80, v240
	ds_write_b64 v157, v[186:187]
	v_xor_b32 v156, 96, v240
	ds_write_b64 v156, v[188:189]
	v_xor_b32 v157, 112, v240
	ds_write_b64 v157, v[190:191]
	s_add_u32 m0, s91, 36864
	s_add_u32 s92, s90, 1032192
	buffer_load_dwordx4 v6, s[12:15], s92 offen lds
	s_waitcnt vmcnt(10) lgkmcnt(0)
	s_barrier
	s_mov_b64 exec, 0xffff
	buffer_load_dword v255, v247, s[4:7], s85 offen
	s_mov_b64 exec, -1
	s_cmp_ge_u32 s46, 2
	s_cbranch_scc1 Lw_23
	ds_read_b64_tr_b16 v[64:65], v242 offset:0
	ds_read_b64_tr_b16 v[66:67], v243 offset:0
	ds_read_b64_tr_b16 v[68:69], v244 offset:0
	ds_read_b64_tr_b16 v[70:71], v245 offset:0
	ds_read_b64_tr_b16 v[72:73], v242 offset:2048
	ds_read_b64_tr_b16 v[74:75], v243 offset:2048
	ds_read_b64_tr_b16 v[76:77], v244 offset:1024
	ds_read_b64_tr_b16 v[78:79], v245 offset:1024
	ds_read_b64_tr_b16 v[216:217], v242 offset:4096
	ds_read_b64_tr_b16 v[218:219], v243 offset:4096
	ds_read_b64_tr_b16 v[220:221], v244 offset:2048
	ds_read_b64_tr_b16 v[222:223], v245 offset:2048
	s_waitcnt lgkmcnt(8)
	v_mfma_f32_32x32x16_bf16 v[80:95], v[68:71], v[64:67], 0
	ds_read_b64_tr_b16 v[64:65], v242 offset:6144
	ds_read_b64_tr_b16 v[66:67], v243 offset:6144
	ds_read_b64_tr_b16 v[68:69], v244 offset:3072
	ds_read_b64_tr_b16 v[70:71], v245 offset:3072
	s_waitcnt lgkmcnt(8)
	v_mfma_f32_32x32x16_bf16 v[80:95], v[76:79], v[72:75], v[80:95]
	ds_read_b64_tr_b16 v[72:73], v242 offset:8192
	ds_read_b64_tr_b16 v[74:75], v243 offset:8192
	ds_read_b64_tr_b16 v[76:77], v244 offset:4096
	ds_read_b64_tr_b16 v[78:79], v245 offset:4096
	s_waitcnt lgkmcnt(8)
	v_mfma_f32_32x32x16_bf16 v[80:95], v[220:223], v[216:219], v[80:95]
	ds_read_b64_tr_b16 v[216:217], v242 offset:10240
	ds_read_b64_tr_b16 v[218:219], v243 offset:10240
	ds_read_b64_tr_b16 v[220:221], v244 offset:5120
	ds_read_b64_tr_b16 v[222:223], v245 offset:5120
	s_waitcnt lgkmcnt(8)
	v_mfma_f32_32x32x16_bf16 v[80:95], v[68:71], v[64:67], v[80:95]
	ds_read_b64_tr_b16 v[64:65], v242 offset:12288
	ds_read_b64_tr_b16 v[66:67], v243 offset:12288
	ds_read_b64_tr_b16 v[68:69], v244 offset:6144
	ds_read_b64_tr_b16 v[70:71], v245 offset:6144
	s_waitcnt lgkmcnt(8)
	v_mfma_f32_32x32x16_bf16 v[80:95], v[76:79], v[72:75], v[80:95]
	ds_read_b64_tr_b16 v[72:73], v242 offset:14336
	ds_read_b64_tr_b16 v[74:75], v243 offset:14336
	ds_read_b64_tr_b16 v[76:77], v244 offset:7168
	ds_read_b64_tr_b16 v[78:79], v245 offset:7168
	s_waitcnt lgkmcnt(8)
	v_mfma_f32_32x32x16_bf16 v[80:95], v[220:223], v[216:219], v[80:95]
	s_waitcnt lgkmcnt(4)
	v_mfma_f32_32x32x16_bf16 v[80:95], v[68:71], v[64:67], v[80:95]
	s_waitcnt lgkmcnt(0)
	v_mfma_f32_32x32x16_bf16 v[80:95], v[76:79], v[72:75], v[80:95]
	s_lshl_b32 s68, s46, 7
	s_add_u32 s68, s68, s59
	s_add_u32 s69, s68, 4096
	s_mov_b32 s78, 0x80808080
	s_mov_b32 s79, 0x80808080
	s_nop 6
	v_cndmask_b32 v80, v80, 1.0, s[78:79]
	v_cndmask_b32 v81, v81, 1.0, s[78:79]
	v_cndmask_b32 v82, v82, 1.0, s[78:79]
	v_cndmask_b32 v83, v83, 1.0, s[78:79]
	v_cndmask_b32 v84, v84, 1.0, s[78:79]
	v_cndmask_b32 v85, v85, 1.0, s[78:79]
	v_cndmask_b32 v86, v86, 1.0, s[78:79]
	v_cndmask_b32 v87, v87, 1.0, s[78:79]
	v_cndmask_b32 v88, v88, 1.0, s[78:79]
	v_cndmask_b32 v89, v89, 1.0, s[78:79]
	v_cndmask_b32 v90, v90, 1.0, s[78:79]
	v_cndmask_b32 v91, v91, 1.0, s[78:79]
	v_cndmask_b32 v92, v92, 1.0, s[78:79]
	v_cndmask_b32 v93, v93, 1.0, s[78:79]
	v_cndmask_b32 v94, v94, 1.0, s[78:79]
	v_cndmask_b32 v95, v95, 1.0, s[78:79]
	buffer_atomic_add_f32 v80, v246, s[4:7], s68 offen offset:0 sc1
	buffer_atomic_add_f32 v81, v246, s[4:7], s68 offen offset:256 sc1
	buffer_atomic_add_f32 v82, v246, s[4:7], s68 offen offset:512 sc1
	buffer_atomic_add_f32 v83, v246, s[4:7], s68 offen offset:768 sc1
	buffer_atomic_add_f32 v84, v246, s[4:7], s68 offen offset:2048 sc1
	buffer_atomic_add_f32 v85, v246, s[4:7], s68 offen offset:2304 sc1
	buffer_atomic_add_f32 v86, v246, s[4:7], s68 offen offset:2560 sc1
	buffer_atomic_add_f32 v87, v246, s[4:7], s68 offen offset:2816 sc1
	buffer_atomic_add_f32 v88, v246, s[4:7], s69 offen offset:0 sc1
	buffer_atomic_add_f32 v89, v246, s[4:7], s69 offen offset:256 sc1
	buffer_atomic_add_f32 v90, v246, s[4:7], s69 offen offset:512 sc1
	buffer_atomic_add_f32 v91, v246, s[4:7], s69 offen offset:768 sc1
	buffer_atomic_add_f32 v92, v246, s[4:7], s69 offen offset:2048 sc1
	buffer_atomic_add_f32 v93, v246, s[4:7], s69 offen offset:2304 sc1
	buffer_atomic_add_f32 v94, v246, s[4:7], s69 offen offset:2560 sc1
	buffer_atomic_add_f32 v95, v246, s[4:7], s69 offen offset:2816 sc1
Lw_23:
	s_cmp_lg_u32 s46, 2
	s_cbranch_scc1 Lw_24
	s_cmp_lg_u32 s47, 0
	s_cbranch_scc1 Lq0_25
	v_add_u32 v209, 57344, v2
	s_mov_b32 s69, 162176
	v_mov_b32 v128, 0x3f803f80
	v_mov_b32 v129, 0x3f803f80
	v_mov_b32 v130, 0x3f803f80
	v_mov_b32 v131, 0x3f803f80
	ds_read_b64_tr_b16 v[132:133], v209 offset:0
	ds_read_b64_tr_b16 v[134:135], v209 offset:512
	ds_read_b64_tr_b16 v[136:137], v209 offset:1024
	ds_read_b64_tr_b16 v[138:139], v209 offset:1536
	ds_read_b64_tr_b16 v[140:141], v209 offset:2048
	ds_read_b64_tr_b16 v[142:143], v209 offset:2560
	s_waitcnt lgkmcnt(4)
	v_mfma_f32_32x32x16_bf16 v[112:127], v[132:135], v[128:131], 0
	ds_read_b64_tr_b16 v[132:133], v209 offset:3072
	ds_read_b64_tr_b16 v[134:135], v209 offset:3584
	s_waitcnt lgkmcnt(4)
	v_mfma_f32_32x32x16_bf16 v[112:127], v[136:139], v[128:131], v[112:127]
	ds_read_b64_tr_b16 v[136:137], v209 offset:4096
	ds_read_b64_tr_b16 v[138:139], v209 offset:4608
	s_waitcnt lgkmcnt(4)
	v_mfma_f32_32x32x16_bf16 v[112:127], v[140:143], v[128:131], v[112:127]
	ds_read_b64_tr_b16 v[140:141], v209 offset:5120
	ds_read_b64_tr_b16 v[142:143], v209 offset:5632
	s_waitcnt lgkmcnt(4)
	v_mfma_f32_32x32x16_bf16 v[112:127], v[132:135], v[128:131], v[112:127]
	ds_read_b64_tr_b16 v[132:133], v209 offset:6144
	ds_read_b64_tr_b16 v[134:135], v209 offset:6656
	s_waitcnt lgkmcnt(4)
	v_mfma_f32_32x32x16_bf16 v[112:127], v[136:139], v[128:131], v[112:127]
	ds_read_b64_tr_b16 v[136:137], v209 offset:7168
	ds_read_b64_tr_b16 v[138:139], v209 offset:7680
	s_waitcnt lgkmcnt(4)
	v_mfma_f32_32x32x16_bf16 v[112:127], v[140:143], v[128:131], v[112:127]
	ds_read_b64_tr_b16 v[140:141], v209 offset:8192
	ds_read_b64_tr_b16 v[142:143], v209 offset:8704
	s_waitcnt lgkmcnt(4)
	v_mfma_f32_32x32x16_bf16 v[112:127], v[132:135], v[128:131], v[112:127]
	ds_read_b64_tr_b16 v[132:133], v209 offset:9216
	ds_read_b64_tr_b16 v[134:135], v209 offset:9728
	s_waitcnt lgkmcnt(4)
	v_mfma_f32_32x32x16_bf16 v[112:127], v[136:139], v[128:131], v[112:127]
	ds_read_b64_tr_b16 v[136:137], v209 offset:10240
	ds_read_b64_tr_b16 v[138:139], v209 offset:10752
	s_waitcnt lgkmcnt(4)
	v_mfma_f32_32x32x16_bf16 v[112:127], v[140:143], v[128:131], v[112:127]
	ds_read_b64_tr_b16 v[140:141], v209 offset:11264
	ds_read_b64_tr_b16 v[142:143], v209 offset:11776
	s_waitcnt lgkmcnt(4)
	v_mfma_f32_32x32x16_bf16 v[112:127], v[132:135], v[128:131], v[112:127]
	ds_read_b64_tr_b16 v[132:133], v209 offset:12288
	ds_read_b64_tr_b16 v[134:135], v209 offset:12800
	s_waitcnt lgkmcnt(4)
	v_mfma_f32_32x32x16_bf16 v[112:127], v[136:139], v[128:131], v[112:127]
	ds_read_b64_tr_b16 v[136:137], v209 offset:13312
	ds_read_b64_tr_b16 v[138:139], v209 offset:13824
	s_waitcnt lgkmcnt(4)
	v_mfma_f32_32x32x16_bf16 v[112:127], v[140:143], v[128:131], v[112:127]
	ds_read_b64_tr_b16 v[140:141], v209 offset:14336
	ds_read_b64_tr_b16 v[142:143], v209 offset:14848
	s_waitcnt lgkmcnt(4)
	v_mfma_f32_32x32x16_bf16 v[112:127], v[132:135], v[128:131], v[112:127]
	ds_read_b64_tr_b16 v[132:133], v209 offset:15360
	ds_read_b64_tr_b16 v[134:135], v209 offset:15872
	s_waitcnt lgkmcnt(4)
	v_mfma_f32_32x32x16_bf16 v[112:127], v[136:139], v[128:131], v[112:127]
	ds_read_b64_tr_b16 v[136:137], v209 offset:16384
	ds_read_b64_tr_b16 v[138:139], v209 offset:16896
	s_waitcnt lgkmcnt(4)
	v_mfma_f32_32x32x16_bf16 v[112:127], v[140:143], v[128:131], v[112:127]
	ds_read_b64_tr_b16 v[140:141], v209 offset:17408
	ds_read_b64_tr_b16 v[142:143], v209 offset:17920
	s_waitcnt lgkmcnt(4)
	v_mfma_f32_32x32x16_bf16 v[112:127], v[132:135], v[128:131], v[112:127]
	ds_read_b64_tr_b16 v[132:133], v209 offset:18432
	ds_read_b64_tr_b16 v[134:135], v209 offset:18944
	s_waitcnt lgkmcnt(4)
	v_mfma_f32_32x32x16_bf16 v[112:127], v[136:139], v[128:131], v[112:127]
	ds_read_b64_tr_b16 v[136:137], v209 offset:19456
	ds_read_b64_tr_b16 v[138:139], v209 offset:19968
	s_waitcnt lgkmcnt(4)
	v_mfma_f32_32x32x16_bf16 v[112:127], v[140:143], v[128:131], v[112:127]
	ds_read_b64_tr_b16 v[140:141], v209 offset:20480
	ds_read_b64_tr_b16 v[142:143], v209 offset:20992
	s_waitcnt lgkmcnt(4)
	v_mfma_f32_32x32x16_bf16 v[112:127], v[132:135], v[128:131], v[112:127]
	ds_read_b64_tr_b16 v[132:133], v209 offset:21504
	ds_read_b64_tr_b16 v[134:135], v209 offset:22016
	s_waitcnt lgkmcnt(4)
	v_mfma_f32_32x32x16_bf16 v[112:127], v[136:139], v[128:131], v[112:127]
	ds_read_b64_tr_b16 v[136:137], v209 offset:22528
	ds_read_b64_tr_b16 v[138:139], v209 offset:23040
	s_waitcnt lgkmcnt(4)
	v_mfma_f32_32x32x16_bf16 v[112:127], v[140:143], v[128:131], v[112:127]
	ds_read_b64_tr_b16 v[140:141], v209 offset:23552
	ds_read_b64_tr_b16 v[142:143], v209 offset:24064
	s_waitcnt lgkmcnt(4)
	v_mfma_f32_32x32x16_bf16 v[112:127], v[132:135], v[128:131], v[112:127]
	ds_read_b64_tr_b16 v[132:133], v209 offset:24576
	ds_read_b64_tr_b16 v[134:135], v209 offset:25088
	s_waitcnt lgkmcnt(4)
	v_mfma_f32_32x32x16_bf16 v[112:127], v[136:139], v[128:131], v[112:127]
	ds_read_b64_tr_b16 v[136:137], v209 offset:25600
	ds_read_b64_tr_b16 v[138:139], v209 offset:26112
	s_waitcnt lgkmcnt(4)
	v_mfma_f32_32x32x16_bf16 v[112:127], v[140:143], v[128:131], v[112:127]
	ds_read_b64_tr_b16 v[140:141], v209 offset:26624
	ds_read_b64_tr_b16 v[142:143], v209 offset:27136
	s_waitcnt lgkmcnt(4)
	v_mfma_f32_32x32x16_bf16 v[112:127], v[132:135], v[128:131], v[112:127]
	ds_read_b64_tr_b16 v[132:133], v209 offset:27648
	ds_read_b64_tr_b16 v[134:135], v209 offset:28160
	s_waitcnt lgkmcnt(4)
	v_mfma_f32_32x32x16_bf16 v[112:127], v[136:139], v[128:131], v[112:127]
	s_waitcnt lgkmcnt(2)
	v_mfma_f32_32x32x16_bf16 v[112:127], v[140:143], v[128:131], v[112:127]
	s_waitcnt lgkmcnt(0)
	v_mfma_f32_32x32x16_bf16 v[112:127], v[132:135], v[128:131], v[112:127]
	v_add_u32 v152, s69, v8
	s_mov_b32 exec_lo, 1
	s_mov_b32 exec_hi, 1
	s_nop 8
	ds_write_b128 v152, v[112:115] offset:0
	ds_write_b128 v152, v[116:119] offset:32
	ds_write_b128 v152, v[120:123] offset:64
	ds_write_b128 v152, v[124:127] offset:96
	s_mov_b64 exec, -1
	s_waitcnt lgkmcnt(0)
Lq0_25:
Lw_24:
	s_cmp_eq_u32 s47, 0
	s_cbranch_scc1 Lcq_26
	ds_read_b128 v[112:115], v15 offset:256
	ds_read_b128 v[116:119], v15 offset:288
	ds_read_b128 v[120:123], v15 offset:320
	ds_read_b128 v[124:127], v15 offset:352
Lcq_26:
	v_add_u32 v208, 57344, v2
	ds_read_b64_tr_b16 v[64:65], v208 offset:0
	ds_read_b64_tr_b16 v[66:67], v208 offset:512
	ds_read_b64_tr_b16 v[68:69], v208 offset:1024
	ds_read_b64_tr_b16 v[70:71], v208 offset:1536
	ds_read_b64_tr_b16 v[72:73], v208 offset:2048
	ds_read_b64_tr_b16 v[74:75], v208 offset:2560
	s_waitcnt lgkmcnt(4)
	v_mfma_f32_32x32x16_bf16 v[48:63], v[64:67], a[0:3], 0
	ds_read_b64_tr_b16 v[64:65], v208 offset:3072
	ds_read_b64_tr_b16 v[66:67], v208 offset:3584
	s_waitcnt lgkmcnt(4)
	v_mfma_f32_32x32x16_bf16 v[48:63], v[68:71], a[4:7], v[48:63]
	ds_read_b64_tr_b16 v[68:69], v208 offset:4096
	ds_read_b64_tr_b16 v[70:71], v208 offset:4608
	s_waitcnt lgkmcnt(4)
	v_mfma_f32_32x32x16_bf16 v[48:63], v[72:75], a[8:11], v[48:63]
	ds_read_b64_tr_b16 v[72:73], v208 offset:5120
	ds_read_b64_tr_b16 v[74:75], v208 offset:5632
	s_waitcnt lgkmcnt(4)
	v_mfma_f32_32x32x16_bf16 v[48:63], v[64:67], a[12:15], v[48:63]
	ds_read_b64_tr_b16 v[64:65], v208 offset:6144
	ds_read_b64_tr_b16 v[66:67], v208 offset:6656
	s_waitcnt lgkmcnt(4)
	v_mfma_f32_32x32x16_bf16 v[48:63], v[68:71], a[16:19], v[48:63]
	ds_read_b64_tr_b16 v[68:69], v208 offset:7168
	ds_read_b64_tr_b16 v[70:71], v208 offset:7680
	s_waitcnt lgkmcnt(4)
	v_mfma_f32_32x32x16_bf16 v[48:63], v[72:75], a[20:23], v[48:63]
	ds_read_b64_tr_b16 v[72:73], v208 offset:8192
	ds_read_b64_tr_b16 v[74:75], v208 offset:8704
	s_waitcnt lgkmcnt(4)
	v_mfma_f32_32x32x16_bf16 v[48:63], v[64:67], a[24:27], v[48:63]
	ds_read_b64_tr_b16 v[64:65], v208 offset:9216
	ds_read_b64_tr_b16 v[66:67], v208 offset:9728
	s_waitcnt lgkmcnt(4)
	v_mfma_f32_32x32x16_bf16 v[48:63], v[68:71], a[28:31], v[48:63]
	ds_read_b64_tr_b16 v[68:69], v208 offset:10240
	ds_read_b64_tr_b16 v[70:71], v208 offset:10752
	s_waitcnt lgkmcnt(4)
	v_mfma_f32_32x32x16_bf16 v[48:63], v[72:75], a[32:35], v[48:63]
	ds_read_b64_tr_b16 v[72:73], v208 offset:11264
	ds_read_b64_tr_b16 v[74:75], v208 offset:11776
	s_waitcnt lgkmcnt(4)
	v_mfma_f32_32x32x16_bf16 v[48:63], v[64:67], a[36:39], v[48:63]
	ds_read_b64_tr_b16 v[64:65], v208 offset:12288
	ds_read_b64_tr_b16 v[66:67], v208 offset:12800
	s_waitcnt lgkmcnt(4)
	v_mfma_f32_32x32x16_bf16 v[48:63], v[68:71], a[40:43], v[48:63]
	ds_read_b64_tr_b16 v[68:69], v208 offset:13312
	ds_read_b64_tr_b16 v[70:71], v208 offset:13824
	s_waitcnt lgkmcnt(4)
	v_mfma_f32_32x32x16_bf16 v[48:63], v[72:75], a[44:47], v[48:63]
	ds_read_b64_tr_b16 v[72:73], v208 offset:14336
	ds_read_b64_tr_b16 v[74:75], v208 offset:14848
	s_waitcnt lgkmcnt(4)
	v_mfma_f32_32x32x16_bf16 v[48:63], v[64:67], a[48:51], v[48:63]
	ds_read_b64_tr_b16 v[64:65], v208 offset:15360
	ds_read_b64_tr_b16 v[66:67], v208 offset:15872
	s_waitcnt lgkmcnt(4)
	v_mfma_f32_32x32x16_bf16 v[48:63], v[68:71], a[52:55], v[48:63]
	ds_read_b64_tr_b16 v[68:69], v208 offset:16384
	ds_read_b64_tr_b16 v[70:71], v208 offset:16896
	s_waitcnt lgkmcnt(4)
	v_mfma_f32_32x32x16_bf16 v[48:63], v[72:75], a[56:59], v[48:63]
	ds_read_b64_tr_b16 v[72:73], v208 offset:17408
	ds_read_b64_tr_b16 v[74:75], v208 offset:17920
	s_waitcnt lgkmcnt(4)
	v_mfma_f32_32x32x16_bf16 v[48:63], v[64:67], a[60:63], v[48:63]
	ds_read_b64_tr_b16 v[64:65], v208 offset:18432
	ds_read_b64_tr_b16 v[66:67], v208 offset:18944
	s_waitcnt lgkmcnt(4)
	v_mfma_f32_32x32x16_bf16 v[48:63], v[68:71], a[64:67], v[48:63]
	ds_read_b64_tr_b16 v[68:69], v208 offset:19456
	ds_read_b64_tr_b16 v[70:71], v208 offset:19968
	s_waitcnt lgkmcnt(4)
	v_mfma_f32_32x32x16_bf16 v[48:63], v[72:75], a[68:71], v[48:63]
	ds_read_b64_tr_b16 v[72:73], v208 offset:20480
	ds_read_b64_tr_b16 v[74:75], v208 offset:20992
	s_waitcnt lgkmcnt(4)
	v_mfma_f32_32x32x16_bf16 v[48:63], v[64:67], a[72:75], v[48:63]
	ds_read_b64_tr_b16 v[64:65], v208 offset:21504
	ds_read_b64_tr_b16 v[66:67], v208 offset:22016
	s_waitcnt lgkmcnt(4)
	v_mfma_f32_32x32x16_bf16 v[48:63], v[68:71], a[76:79], v[48:63]
	ds_read_b64_tr_b16 v[68:69], v208 offset:22528
	ds_read_b64_tr_b16 v[70:71], v208 offset:23040
	s_waitcnt lgkmcnt(4)
	v_mfma_f32_32x32x16_bf16 v[48:63], v[72:75], a[80:83], v[48:63]
	ds_read_b64_tr_b16 v[72:73], v208 offset:23552
	ds_read_b64_tr_b16 v[74:75], v208 offset:24064
	s_waitcnt lgkmcnt(4)
	v_mfma_f32_32x32x16_bf16 v[48:63], v[64:67], a[84:87], v[48:63]
	ds_read_b64_tr_b16 v[64:65], v208 offset:24576
	ds_read_b64_tr_b16 v[66:67], v208 offset:25088
	s_waitcnt lgkmcnt(4)
	v_mfma_f32_32x32x16_bf16 v[48:63], v[68:71], a[88:91], v[48:63]
	ds_read_b64_tr_b16 v[68:69], v208 offset:25600
	ds_read_b64_tr_b16 v[70:71], v208 offset:26112
	s_waitcnt lgkmcnt(4)
	v_mfma_f32_32x32x16_bf16 v[48:63], v[72:75], a[92:95], v[48:63]
	ds_read_b64_tr_b16 v[72:73], v208 offset:26624
	ds_read_b64_tr_b16 v[74:75], v208 offset:27136
	s_waitcnt lgkmcnt(4)
	v_mfma_f32_32x32x16_bf16 v[48:63], v[64:67], a[96:99], v[48:63]
	ds_read_b64_tr_b16 v[64:65], v208 offset:27648
	ds_read_b64_tr_b16 v[66:67], v208 offset:28160
	s_waitcnt lgkmcnt(4)
	v_mfma_f32_32x32x16_bf16 v[48:63], v[68:71], a[100:103], v[48:63]
	s_waitcnt lgkmcnt(2)
	v_mfma_f32_32x32x16_bf16 v[48:63], v[72:75], a[104:107], v[48:63]
	s_waitcnt lgkmcnt(0)
	v_mfma_f32_32x32x16_bf16 v[48:63], v[64:67], a[108:111], v[48:63]
	s_waitcnt lgkmcnt(0)
	s_barrier
	s_cmp_lg_u32 s47, 0
	s_nop 8
	s_cbranch_scc1 Lcr_27
	ds_read_b128 v[112:115], v15 offset:256
	ds_read_b128 v[116:119], v15 offset:288
	ds_read_b128 v[120:123], v15 offset:320
	ds_read_b128 v[124:127], v15 offset:352
	s_waitcnt lgkmcnt(0)
Lcr_27:
	s_cmp_ge_u32 s46, 2
	s_cbranch_scc1 Lq23_28
	s_and_b32 s69, s46, 1
	s_lshl_b32 s70, s65, 1
	s_add_u32 s69, s69, s70
	s_lshr_b32 s70, s46, 1
	s_lshl_b32 s71, s66, 1
	s_add_u32 s70, s70, s71
	s_cmp_eq_u32 s47, 0
	s_cbranch_scc1 Lrr_30
	s_mul_i32 s72, s69, 28672
	s_lshl_b32 s70, s70, 11
	s_add_u32 s72, s72, s70
	s_add_u32 s72, s72, s51
	buffer_load_dwordx4 v[224:227], v1, s[4:7], s72 offen sc1
	buffer_load_dwordx4 v[228:231], v1, s[4:7], s72 offen offset:1024 sc1
	s_branch Lre_31
Lrr_30:
	s_lshl_b32 s72, s44, 8
	s_lshl_b32 s73, s69, 5
	s_add_u32 s72, s72, s73
	s_mul_i32 s72, s72, 896
	s_lshl_b32 s73, s70, 6
	s_add_u32 s72, s72, s73
	v_and_b32 v13, 31, v0
	v_mul_u32_u24 v13, 896, v13
	v_lshrrev_b32 v14, 5, v0
	v_lshl_add_u32 v13, v14, 3, v13
	buffer_load_dwordx2 v[224:225], v13, s[32:35], s72 offen offset:0
	buffer_load_dwordx2 v[226:227], v13, s[32:35], s72 offen offset:16
	buffer_load_dwordx2 v[228:229], v13, s[32:35], s72 offen offset:32
	buffer_load_dwordx2 v[230:231], v13, s[32:35], s72 offen offset:48
Lre_31:
	s_and_b32 s69, s46, 1
	s_lshl_b32 s70, s65, 1
	s_add_u32 s69, s69, s70
	s_lshr_b32 s70, s46, 1
	s_lshl_b32 s71, s66, 1
	s_add_u32 s70, s70, s71
	s_mul_i32 s72, s69, 28672
	s_lshl_b32 s73, s70, 11
	s_add_u32 s72, s72, s73
	s_add_u32 s72, s72, s53
	s_mov_b64 exec, 0xffff
	buffer_load_dword v255, v247, s[4:7], s72 offen
	s_mov_b64 exec, -1
	s_mul_i32 s72, s69, 3584
	s_lshl_b32 s73, s66, 9
	s_add_u32 s72, s72, s73
	s_add_u32 s72, s72, s54
	s_mov_b64 exec, 0xf
	buffer_load_dword v255, v247, s[4:7], s72 offen
	s_mov_b64 exec, -1
	s_cmp_lg_u32 s46, 1
	s_cbranch_scc1 Lw_32
	s_mul_i32 s68, s45, (((L_code_p4-L_code_p2b)+4095)/4096)*128
	s_add_u32 s68, s68, L_code_p2b-interleave_layers__linear_kernel_hedgehog__geglu_ffn__prompt_kernel
	v_lshlrev_b32 v14, 7, v0
	v_add_u32 v14, s68, v14
	v_min_u32 v14, CODE_BYTES-4, v14
	s_mov_b32 exec_lo, (1<<(((L_code_p4-L_code_p2b)+4095)/4096))-1
	s_mov_b32 exec_hi, 0
	global_load_dword v255, v14, s[98:99]
	s_mov_b64 exec, -1
Lw_32:
	s_lshl_b32 s68, s46, 7
	s_add_u32 s68, s68, s59
	s_add_u32 s69, s68, 4096
	s_mov_b32 s78, 0xaaaaaaaa
	s_mov_b32 s79, 0xaaaaaaaa
	s_mov_b32 s75, 0
	v_pk_fma_f32 v[48:49], v[112:113], v[10:11], v[48:49] op_sel_hi:[1,0,1]
	v_pk_fma_f32 v[50:51], v[114:115], v[10:11], v[50:51] op_sel_hi:[1,0,1]
	v_pk_fma_f32 v[52:53], v[116:117], v[10:11], v[52:53] op_sel_hi:[1,0,1]
	v_pk_fma_f32 v[54:55], v[118:119], v[10:11], v[54:55] op_sel_hi:[1,0,1]
	v_pk_fma_f32 v[56:57], v[120:121], v[10:11], v[56:57] op_sel_hi:[1,0,1]
	v_pk_fma_f32 v[58:59], v[122:123], v[10:11], v[58:59] op_sel_hi:[1,0,1]
	v_pk_fma_f32 v[60:61], v[124:125], v[10:11], v[60:61] op_sel_hi:[1,0,1]
	v_pk_fma_f32 v[62:63], v[126:127], v[10:11], v[62:63] op_sel_hi:[1,0,1]
	v_cvt_pk_bf16_f32 v144, v48, v49
	v_cvt_pk_bf16_f32 v145, v50, v51
	v_cvt_pk_bf16_f32 v146, v52, v53
	v_cvt_pk_bf16_f32 v147, v54, v55
	v_cvt_pk_bf16_f32 v148, v56, v57
	v_cvt_pk_bf16_f32 v149, v58, v59
	v_cvt_pk_bf16_f32 v150, v60, v61
	v_cvt_pk_bf16_f32 v151, v62, v63
	v_mfma_f32_32x32x16_bf16 v[80:95], a[248:251], v[144:147], 0
	s_nop 0
	v_mfma_f32_32x32x16_bf16 v[80:95], a[252:255], v[148:151], v[80:95]
	s_nop 11
	v_cndmask_b32 v83, v83, v80, s[96:97]
	v_cndmask_b32 v87, v87, v80, s[96:97]
	v_cndmask_b32 v91, v91, v80, s[96:97]
	v_cndmask_b32 v95, v95, v80, s[96:97]
	v_max3_f32 v152, v80, v81, v82
	v_min3_f32 v153, v80, v81, v82
	v_max3_f32 v154, v83, v84, v85
	v_min3_f32 v155, v83, v84, v85
	v_max3_f32 v152, v152, v86, v87
	v_min3_f32 v153, v153, v86, v87
	v_max3_f32 v154, v154, v88, v89
	v_min3_f32 v155, v155, v88, v89
	v_max3_f32 v152, v152, v90, v91
	v_min3_f32 v153, v153, v90, v91
	v_max3_f32 v154, v154, v92, v93
	v_min3_f32 v155, v155, v92, v93
	v_max3_f32 v152, v152, v94, v95
	v_min3_f32 v153, v153, v94, v95
	v_max_f32 v152, v152, v154
	v_min_f32 v153, v153, v155
	v_mov_b32 v154, v152
	v_mov_b32 v155, v153
	s_nop 0
	v_permlane32_swap_b32 v152, v154
	v_permlane32_swap_b32 v153, v155
	v_max_f32 v152, v152, v154
	v_min_f32 v153, v153, v155
	v_mul_f32 v152, v152, v12
	v_mul_f32 v153, v153, v12
	v_pk_fma_f32 v[96:97], v[80:81], v[12:13], v[152:153] op_sel:[0,0,0] op_sel_hi:[1,0,0] neg_lo:[0,0,1] neg_hi:[0,0,1]
	v_pk_fma_f32 v[192:193], v[80:81], v[12:13], v[152:153] op_sel:[0,0,1] op_sel_hi:[1,0,1] neg_lo:[1,0,0] neg_hi:[1,0,0]
	v_pk_fma_f32 v[98:99], v[82:83], v[12:13], v[152:153] op_sel:[0,0,0] op_sel_hi:[1,0,0] neg_lo:[0,0,1] neg_hi:[0,0,1]
	v_pk_fma_f32 v[194:195], v[82:83], v[12:13], v[152:153] op_sel:[0,0,1] op_sel_hi:[1,0,1] neg_lo:[1,0,0] neg_hi:[1,0,0]
	v_pk_fma_f32 v[100:101], v[84:85], v[12:13], v[152:153] op_sel:[0,0,0] op_sel_hi:[1,0,0] neg_lo:[0,0,1] neg_hi:[0,0,1]
	v_pk_fma_f32 v[196:197], v[84:85], v[12:13], v[152:153] op_sel:[0,0,1] op_sel_hi:[1,0,1] neg_lo:[1,0,0] neg_hi:[1,0,0]
	v_pk_fma_f32 v[102:103], v[86:87], v[12:13], v[152:153] op_sel:[0,0,0] op_sel_hi:[1,0,0] neg_lo:[0,0,1] neg_hi:[0,0,1]
	v_pk_fma_f32 v[198:199], v[86:87], v[12:13], v[152:153] op_sel:[0,0,1] op_sel_hi:[1,0,1] neg_lo:[1,0,0] neg_hi:[1,0,0]
	v_pk_fma_f32 v[104:105], v[88:89], v[12:13], v[152:153] op_sel:[0,0,0] op_sel_hi:[1,0,0] neg_lo:[0,0,1] neg_hi:[0,0,1]
	v_pk_fma_f32 v[200:201], v[88:89], v[12:13], v[152:153] op_sel:[0,0,1] op_sel_hi:[1,0,1] neg_lo:[1,0,0] neg_hi:[1,0,0]
	v_pk_fma_f32 v[106:107], v[90:91], v[12:13], v[152:153] op_sel:[0,0,0] op_sel_hi:[1,0,0] neg_lo:[0,0,1] neg_hi:[0,0,1]
	v_pk_fma_f32 v[202:203], v[90:91], v[12:13], v[152:153] op_sel:[0,0,1] op_sel_hi:[1,0,1] neg_lo:[1,0,0] neg_hi:[1,0,0]
	v_pk_fma_f32 v[108:109], v[92:93], v[12:13], v[152:153] op_sel:[0,0,0] op_sel_hi:[1,0,0] neg_lo:[0,0,1] neg_hi:[0,0,1]
	v_pk_fma_f32 v[204:205], v[92:93], v[12:13], v[152:153] op_sel:[0,0,1] op_sel_hi:[1,0,1] neg_lo:[1,0,0] neg_hi:[1,0,0]
	v_pk_fma_f32 v[110:111], v[94:95], v[12:13], v[152:153] op_sel:[0,0,0] op_sel_hi:[1,0,0] neg_lo:[0,0,1] neg_hi:[0,0,1]
	v_pk_fma_f32 v[206:207], v[94:95], v[12:13], v[152:153] op_sel:[0,0,1] op_sel_hi:[1,0,1] neg_lo:[1,0,0] neg_hi:[1,0,0]
	v_exp_f32 v96, v96
	v_exp_f32 v192, v192
	v_exp_f32 v97, v97
	v_exp_f32 v193, v193
	v_exp_f32 v98, v98
	v_exp_f32 v194, v194
	v_exp_f32 v99, v99
	v_exp_f32 v195, v195
	v_exp_f32 v100, v100
	v_exp_f32 v196, v196
	v_exp_f32 v101, v101
	v_exp_f32 v197, v197
	v_exp_f32 v102, v102
	v_exp_f32 v198, v198
	v_exp_f32 v103, v103
	v_exp_f32 v199, v199
	v_exp_f32 v104, v104
	buffer_load_dwordx4 v[64:67], v248, s[4:7], s68 offen offset:0 sc1
	buffer_load_dwordx4 v[68:71], v248, s[4:7], s68 offen offset:2048 sc1
	buffer_load_dwordx4 v[72:75], v248, s[4:7], s69 offen offset:0 sc1
	buffer_load_dwordx4 v[76:79], v248, s[4:7], s69 offen offset:2048 sc1
	v_exp_f32 v200, v200
	v_exp_f32 v105, v105
	v_exp_f32 v201, v201
	v_exp_f32 v106, v106
	v_exp_f32 v202, v202
	v_exp_f32 v107, v107
	v_exp_f32 v203, v203
	v_exp_f32 v108, v108
	v_exp_f32 v204, v204
	v_exp_f32 v109, v109
	v_exp_f32 v205, v205
	v_exp_f32 v110, v110
	v_exp_f32 v206, v206
	v_exp_f32 v111, v111
	v_exp_f32 v207, v207
	v_cndmask_b32 v99, v99, 0, s[96:97]
	v_cndmask_b32 v195, v195, 0, s[96:97]
	v_cndmask_b32 v103, v103, 0, s[96:97]
	v_cndmask_b32 v199, v199, 0, s[96:97]
	v_cndmask_b32 v107, v107, 0, s[96:97]
	v_cndmask_b32 v203, v203, 0, s[96:97]
	v_cndmask_b32 v111, v111, 0, s[96:97]
	v_cndmask_b32 v207, v207, 0, s[96:97]
	v_pk_add_f32 v[152:153], v[96:97], v[98:99]
	v_pk_add_f32 v[154:155], v[192:193], v[194:195]
	v_pk_add_f32 v[156:157], v[100:101], v[102:103]
	v_pk_add_f32 v[158:159], v[196:197], v[198:199]
	v_pk_add_f32 v[152:153], v[152:153], v[104:105]
	v_pk_add_f32 v[154:155], v[154:155], v[200:201]
	v_pk_add_f32 v[156:157], v[156:157], v[106:107]
	v_pk_add_f32 v[158:159], v[158:159], v[202:203]
	v_pk_add_f32 v[152:153], v[152:153], v[108:109]
	v_pk_add_f32 v[154:155], v[154:155], v[204:205]
	v_pk_add_f32 v[156:157], v[156:157], v[110:111]
	v_pk_add_f32 v[158:159], v[158:159], v[206:207]
	v_pk_add_f32 v[152:153], v[152:153], v[156:157]
	v_pk_add_f32 v[154:155], v[154:155], v[158:159]
	v_add_f32 v152, v152, v153
	v_add_f32 v154, v154, v155
	v_mov_b32 v153, v152
	v_mov_b32 v155, v154
	s_nop 0
	v_permlane32_swap_b32 v152, v153
	v_permlane32_swap_b32 v154, v155
	v_add_f32 v152, v152, v153
	v_add_f32 v154, v154, v155
	v_rcp_f32 v152, v152
	v_rcp_f32 v154, v154
	v_pk_mul_f32 v[96:97], v[96:97], v[152:153] op_sel_hi:[1,0]
	v_pk_mul_f32 v[192:193], v[192:193], v[154:155] op_sel_hi:[1,0]
	v_pk_mul_f32 v[98:99], v[98:99], v[152:153] op_sel_hi:[1,0]
	v_pk_mul_f32 v[194:195], v[194:195], v[154:155] op_sel_hi:[1,0]
	v_pk_mul_f32 v[100:101], v[100:101], v[152:153] op_sel_hi:[1,0]
	v_pk_mul_f32 v[196:197], v[196:197], v[154:155] op_sel_hi:[1,0]
	v_pk_mul_f32 v[102:103], v[102:103], v[152:153] op_sel_hi:[1,0]
	v_pk_mul_f32 v[198:199], v[198:199], v[154:155] op_sel_hi:[1,0]
	v_pk_mul_f32 v[104:105], v[104:105], v[152:153] op_sel_hi:[1,0]
	v_pk_mul_f32 v[200:201], v[200:201], v[154:155] op_sel_hi:[1,0]
	v_pk_mul_f32 v[106:107], v[106:107], v[152:153] op_sel_hi:[1,0]
	v_pk_mul_f32 v[202:203], v[202:203], v[154:155] op_sel_hi:[1,0]
	v_pk_mul_f32 v[108:109], v[108:109], v[152:153] op_sel_hi:[1,0]
	v_pk_mul_f32 v[204:205], v[204:205], v[154:155] op_sel_hi:[1,0]
	v_pk_mul_f32 v[110:111], v[110:111], v[152:153] op_sel_hi:[1,0]
	v_pk_mul_f32 v[206:207], v[206:207], v[154:155] op_sel_hi:[1,0]
	v_cvt_pk_bf16_f32 v160, v96, v97
	v_cvt_pk_bf16_f32 v168, v192, v193
	v_cvt_pk_bf16_f32 v161, v98, v99
	v_cvt_pk_bf16_f32 v169, v194, v195
	v_cvt_pk_bf16_f32 v162, v100, v101
	v_cvt_pk_bf16_f32 v170, v196, v197
	v_cvt_pk_bf16_f32 v163, v102, v103
	v_cvt_pk_bf16_f32 v171, v198, v199
	v_cvt_pk_bf16_f32 v164, v104, v105
	v_cvt_pk_bf16_f32 v172, v200, v201
	v_cvt_pk_bf16_f32 v165, v106, v107
	v_cvt_pk_bf16_f32 v173, v202, v203
	v_cvt_pk_bf16_f32 v166, v108, v109
	v_cvt_pk_bf16_f32 v174, v204, v205
	v_cvt_pk_bf16_f32 v167, v110, v111
	v_cvt_pk_bf16_f32 v175, v206, v207
	s_nop 1
	s_branch Lkvc_35
Lkvp_33:
	buffer_load_dwordx4 v[64:67], v248, s[4:7], s68 offen offset:0 sc1
	buffer_load_dwordx4 v[68:71], v248, s[4:7], s68 offen offset:2048 sc1
	buffer_load_dwordx4 v[72:75], v248, s[4:7], s69 offen offset:0 sc1
	buffer_load_dwordx4 v[76:79], v248, s[4:7], s69 offen offset:2048 sc1
Lkvc_35:
	s_waitcnt vmcnt(0)
	v_sub_f32 v97, 0x41800000, v71
	v_sub_f32 v98, 0x41800000, v75
	v_sub_f32 v99, 0x41800000, v79
	v_sub_f32 v96, 0x41800000, v67
	v_or_b32 v96, v96, v97
	v_or_b32 v98, v98, v99
	v_or_b32 v96, v96, v98
	v_lshlrev_b32 v96, 1, v96
	v_cmp_ne_u32 vcc, 0, v96
	s_add_u32 s75, s75, 1
	s_and_b64 vcc, vcc, s[78:79]
	s_cmp_eq_u64 vcc, 0
	s_nop 1
	s_cbranch_scc1 Lkvd_34
	s_cmp_lt_u32 s75, 100000
	s_cbranch_scc1 Lkvp_33
	s_mov_b32 s50, 1
Lkvd_34:
	v_cvt_pk_bf16_f32 v96, v64, v65
	v_cvt_pk_bf16_f32 v97, v66, v67
	v_cvt_pk_bf16_f32 v98, v68, v69
	v_cvt_pk_bf16_f32 v99, v70, v71
	v_cvt_pk_bf16_f32 v100, v72, v73
	v_cvt_pk_bf16_f32 v101, v74, v75
	v_cvt_pk_bf16_f32 v102, v76, v77
	v_cvt_pk_bf16_f32 v103, v78, v79
	ds_write_b64 v249, v[96:97] offset:0
	ds_write_b64 v249, v[98:99] offset:128
	ds_write_b64 v249, v[100:101] offset:256
	ds_write_b64 v249, v[102:103] offset:384
	s_waitcnt lgkmcnt(0)
	s_branch Lqe_29
Lq23_28:
	s_sub_u32 s68, s46, 2
	s_lshl_b32 s86, s66, 7
	s_mul_i32 s69, s68, 7168
	s_add_u32 s86, s86, s69
	s_lshl_b32 s87, s68, 10
	s_lshl_b32 s88, s45, 7
	s_mul_i32 s69, s68, 28672
	s_add_u32 s88, s88, s69
	s_and_b32 s69, s46, 1
	s_lshl_b32 s70, s65, 1
	s_add_u32 s69, s69, s70
	s_lshr_b32 s70, s46, 1
	s_lshl_b32 s71, s66, 1
	s_add_u32 s70, s70, s71
	s_cmp_eq_u32 s47, 0
	s_cbranch_scc1 Lrr_36
	s_mul_i32 s72, s69, 28672
	s_lshl_b32 s70, s70, 11
	s_add_u32 s72, s72, s70
	s_add_u32 s72, s72, s51
	buffer_load_dwordx4 v[224:227], v1, s[4:7], s72 offen sc1
	buffer_load_dwordx4 v[228:231], v1, s[4:7], s72 offen offset:1024 sc1
	s_branch Lre_37
Lrr_36:
	s_lshl_b32 s72, s44, 8
	s_lshl_b32 s73, s69, 5
	s_add_u32 s72, s72, s73
	s_mul_i32 s72, s72, 896
	s_lshl_b32 s73, s70, 6
	s_add_u32 s72, s72, s73
	v_and_b32 v13, 31, v0
	v_mul_u32_u24 v13, 896, v13
	v_lshrrev_b32 v14, 5, v0
	v_lshl_add_u32 v13, v14, 3, v13
	buffer_load_dwordx2 v[224:225], v13, s[32:35], s72 offen offset:0
	buffer_load_dwordx2 v[226:227], v13, s[32:35], s72 offen offset:16
	buffer_load_dwordx2 v[228:229], v13, s[32:35], s72 offen offset:32
	buffer_load_dwordx2 v[230:231], v13, s[32:35], s72 offen offset:48
Lre_37:
	s_and_b32 s69, s46, 1
	s_lshl_b32 s70, s65, 1
	s_add_u32 s69, s69, s70
	s_lshr_b32 s70, s46, 1
	s_lshl_b32 s71, s66, 1
	s_add_u32 s70, s70, s71
	s_mul_i32 s72, s69, 28672
	s_lshl_b32 s73, s70, 11
	s_add_u32 s72, s72, s73
	s_add_u32 s72, s72, s53
	s_mov_b64 exec, 0xffff
	buffer_load_dword v255, v247, s[4:7], s72 offen
	s_mov_b64 exec, -1
	s_mul_i32 s72, s69, 3584
	s_lshl_b32 s73, s66, 9
	s_add_u32 s72, s72, s73
	s_add_u32 s72, s72, s54
	s_mov_b64 exec, 0xf
	buffer_load_dword v255, v247, s[4:7], s72 offen
	s_mov_b64 exec, -1
	v_pk_fma_f32 v[48:49], v[112:113], v[10:11], v[48:49] op_sel_hi:[1,0,1]
	v_pk_fma_f32 v[50:51], v[114:115], v[10:11], v[50:51] op_sel_hi:[1,0,1]
	s_add_u32 m0, s87, 45056
	s_add_u32 s92, s86, 0
	buffer_load_dwordx4 v5, s[8:11], s92 offen lds
	v_pk_fma_f32 v[52:53], v[116:117], v[10:11], v[52:53] op_sel_hi:[1,0,1]
	v_pk_fma_f32 v[54:55], v[118:119], v[10:11], v[54:55] op_sel_hi:[1,0,1]
	s_add_u32 m0, s87, 47104
	s_add_u32 s92, s86, 14336
	buffer_load_dwordx4 v5, s[8:11], s92 offen lds
	v_pk_fma_f32 v[56:57], v[120:121], v[10:11], v[56:57] op_sel_hi:[1,0,1]
	v_pk_fma_f32 v[58:59], v[122:123], v[10:11], v[58:59] op_sel_hi:[1,0,1]
	s_add_u32 m0, s87, 49152
	s_add_u32 s92, s86, 28672
	buffer_load_dwordx4 v5, s[8:11], s92 offen lds
	v_pk_fma_f32 v[60:61], v[124:125], v[10:11], v[60:61] op_sel_hi:[1,0,1]
	v_pk_fma_f32 v[62:63], v[126:127], v[10:11], v[62:63] op_sel_hi:[1,0,1]
	s_add_u32 m0, s87, 51200
	s_add_u32 s92, s86, 43008
	buffer_load_dwordx4 v5, s[8:11], s92 offen lds
	v_cvt_pk_bf16_f32 v144, v48, v49
	v_cvt_pk_bf16_f32 v145, v50, v51
	s_add_u32 m0, s87, 53248
	s_add_u32 s92, s86, 57344
	buffer_load_dwordx4 v5, s[8:11], s92 offen lds
	v_cvt_pk_bf16_f32 v146, v52, v53
	v_cvt_pk_bf16_f32 v147, v54, v55
	s_add_u32 m0, s87, 55296
	s_add_u32 s92, s86, 71680
	buffer_load_dwordx4 v5, s[8:11], s92 offen lds
	v_cvt_pk_bf16_f32 v148, v56, v57
	v_cvt_pk_bf16_f32 v149, v58, v59
	s_add_u32 m0, s87, 57344
	s_add_u32 s92, s86, 86016
	buffer_load_dwordx4 v5, s[8:11], s92 offen lds
	v_cvt_pk_bf16_f32 v150, v60, v61
	v_cvt_pk_bf16_f32 v151, v62, v63
	s_add_u32 m0, s87, 59392
	s_add_u32 s92, s86, 100352
	buffer_load_dwordx4 v5, s[8:11], s92 offen lds
	v_mfma_f32_32x32x16_bf16 v[80:95], a[248:251], v[144:147], 0
	v_mfma_f32_32x32x16_bf16 v[80:95], a[252:255], v[148:151], v[80:95]
	s_add_u32 m0, s87, 61440
	s_add_u32 s92, s86, 114688
	buffer_load_dwordx4 v5, s[8:11], s92 offen lds
	s_nop 8
	v_cndmask_b32 v83, v83, v80, s[96:97]
	v_cndmask_b32 v87, v87, v80, s[96:97]
	s_add_u32 m0, s87, 63488
	s_add_u32 s92, s86, 129024
	buffer_load_dwordx4 v5, s[8:11], s92 offen lds
	v_cndmask_b32 v91, v91, v80, s[96:97]
	v_cndmask_b32 v95, v95, v80, s[96:97]
	s_add_u32 m0, s87, 65536
	s_add_u32 s92, s86, 143360
	buffer_load_dwordx4 v5, s[8:11], s92 offen lds
	v_max3_f32 v152, v80, v81, v82
	v_min3_f32 v153, v80, v81, v82
	s_add_u32 m0, s87, 67584
	s_add_u32 s92, s86, 157696
	buffer_load_dwordx4 v5, s[8:11], s92 offen lds
	v_max3_f32 v154, v83, v84, v85
	v_min3_f32 v155, v83, v84, v85
	s_add_u32 m0, s87, 69632
	s_add_u32 s92, s86, 172032
	buffer_load_dwordx4 v5, s[8:11], s92 offen lds
	v_max3_f32 v152, v152, v86, v87
	v_min3_f32 v153, v153, v86, v87
	s_add_u32 m0, s87, 71680
	s_add_u32 s92, s86, 186368
	buffer_load_dwordx4 v5, s[8:11], s92 offen lds
	v_max3_f32 v154, v154, v88, v89
	v_min3_f32 v155, v155, v88, v89
	s_add_u32 m0, s87, 73728
	s_add_u32 s92, s86, 200704
	buffer_load_dwordx4 v5, s[8:11], s92 offen lds
	v_max3_f32 v152, v152, v90, v91
	v_min3_f32 v153, v153, v90, v91
	s_add_u32 m0, s87, 75776
	s_add_u32 s92, s86, 215040
	buffer_load_dwordx4 v5, s[8:11], s92 offen lds
	v_max3_f32 v154, v154, v92, v93
	v_min3_f32 v155, v155, v92, v93
	s_add_u32 m0, s87, 77824
	s_add_u32 s92, s86, 229376
	buffer_load_dwordx4 v5, s[8:11], s92 offen lds
	v_max3_f32 v152, v152, v94, v95
	v_min3_f32 v153, v153, v94, v95
	s_add_u32 m0, s87, 79872
	s_add_u32 s92, s86, 243712
	buffer_load_dwordx4 v5, s[8:11], s92 offen lds
	v_max_f32 v152, v152, v154
	v_min_f32 v153, v153, v155
	s_add_u32 m0, s87, 81920
	s_add_u32 s92, s86, 258048
	buffer_load_dwordx4 v5, s[8:11], s92 offen lds
	v_mov_b32 v154, v152
	v_mov_b32 v155, v153
	s_add_u32 m0, s87, 83968
	s_add_u32 s92, s86, 272384
	buffer_load_dwordx4 v5, s[8:11], s92 offen lds
	v_permlane32_swap_b32 v152, v154
	v_permlane32_swap_b32 v153, v155
	s_add_u32 m0, s87, 86016
	s_add_u32 s92, s86, 286720
	buffer_load_dwordx4 v5, s[8:11], s92 offen lds
	v_max_f32 v152, v152, v154
	v_min_f32 v153, v153, v155
	s_add_u32 m0, s87, 88064
	s_add_u32 s92, s86, 301056
	buffer_load_dwordx4 v5, s[8:11], s92 offen lds
	v_mul_f32 v152, v152, v12
	v_mul_f32 v153, v153, v12
	s_add_u32 m0, s87, 90112
	s_add_u32 s92, s86, 315392
	buffer_load_dwordx4 v5, s[8:11], s92 offen lds
	v_pk_fma_f32 v[96:97], v[80:81], v[12:13], v[152:153] op_sel:[0,0,0] op_sel_hi:[1,0,0] neg_lo:[0,0,1] neg_hi:[0,0,1]
	v_pk_fma_f32 v[192:193], v[80:81], v[12:13], v[152:153] op_sel:[0,0,1] op_sel_hi:[1,0,1] neg_lo:[1,0,0] neg_hi:[1,0,0]
	s_add_u32 m0, s87, 92160
	s_add_u32 s92, s86, 329728
	buffer_load_dwordx4 v5, s[8:11], s92 offen lds
	v_pk_fma_f32 v[98:99], v[82:83], v[12:13], v[152:153] op_sel:[0,0,0] op_sel_hi:[1,0,0] neg_lo:[0,0,1] neg_hi:[0,0,1]
	v_pk_fma_f32 v[194:195], v[82:83], v[12:13], v[152:153] op_sel:[0,0,1] op_sel_hi:[1,0,1] neg_lo:[1,0,0] neg_hi:[1,0,0]
	s_add_u32 m0, s87, 94208
	s_add_u32 s92, s86, 344064
	buffer_load_dwordx4 v5, s[8:11], s92 offen lds
	v_pk_fma_f32 v[100:101], v[84:85], v[12:13], v[152:153] op_sel:[0,0,0] op_sel_hi:[1,0,0] neg_lo:[0,0,1] neg_hi:[0,0,1]
	v_pk_fma_f32 v[196:197], v[84:85], v[12:13], v[152:153] op_sel:[0,0,1] op_sel_hi:[1,0,1] neg_lo:[1,0,0] neg_hi:[1,0,0]
	s_add_u32 m0, s87, 96256
	s_add_u32 s92, s86, 358400
	buffer_load_dwordx4 v5, s[8:11], s92 offen lds
	v_pk_fma_f32 v[102:103], v[86:87], v[12:13], v[152:153] op_sel:[0,0,0] op_sel_hi:[1,0,0] neg_lo:[0,0,1] neg_hi:[0,0,1]
	v_pk_fma_f32 v[198:199], v[86:87], v[12:13], v[152:153] op_sel:[0,0,1] op_sel_hi:[1,0,1] neg_lo:[1,0,0] neg_hi:[1,0,0]
	s_add_u32 m0, s87, 98304
	s_add_u32 s92, s86, 372736
	buffer_load_dwordx4 v5, s[8:11], s92 offen lds
	v_pk_fma_f32 v[104:105], v[88:89], v[12:13], v[152:153] op_sel:[0,0,0] op_sel_hi:[1,0,0] neg_lo:[0,0,1] neg_hi:[0,0,1]
	v_pk_fma_f32 v[200:201], v[88:89], v[12:13], v[152:153] op_sel:[0,0,1] op_sel_hi:[1,0,1] neg_lo:[1,0,0] neg_hi:[1,0,0]
	s_add_u32 m0, s87, 100352
	s_add_u32 s92, s86, 387072
	buffer_load_dwordx4 v5, s[8:11], s92 offen lds
	v_pk_fma_f32 v[106:107], v[90:91], v[12:13], v[152:153] op_sel:[0,0,0] op_sel_hi:[1,0,0] neg_lo:[0,0,1] neg_hi:[0,0,1]
	v_pk_fma_f32 v[202:203], v[90:91], v[12:13], v[152:153] op_sel:[0,0,1] op_sel_hi:[1,0,1] neg_lo:[1,0,0] neg_hi:[1,0,0]
	s_add_u32 m0, s87, 104448
	s_add_u32 s92, s88, 0
	buffer_load_dwordx4 v6, s[16:19], s92 offen lds
	v_pk_fma_f32 v[108:109], v[92:93], v[12:13], v[152:153] op_sel:[0,0,0] op_sel_hi:[1,0,0] neg_lo:[0,0,1] neg_hi:[0,0,1]
	v_pk_fma_f32 v[204:205], v[92:93], v[12:13], v[152:153] op_sel:[0,0,1] op_sel_hi:[1,0,1] neg_lo:[1,0,0] neg_hi:[1,0,0]
	s_add_u32 m0, s87, 106496
	s_add_u32 s92, s88, 57344
	buffer_load_dwordx4 v6, s[16:19], s92 offen lds
	v_pk_fma_f32 v[110:111], v[94:95], v[12:13], v[152:153] op_sel:[0,0,0] op_sel_hi:[1,0,0] neg_lo:[0,0,1] neg_hi:[0,0,1]
	v_pk_fma_f32 v[206:207], v[94:95], v[12:13], v[152:153] op_sel:[0,0,1] op_sel_hi:[1,0,1] neg_lo:[1,0,0] neg_hi:[1,0,0]
	s_add_u32 m0, s87, 108544
	s_add_u32 s92, s88, 114688
	buffer_load_dwordx4 v6, s[16:19], s92 offen lds
	v_exp_f32 v96, v96
	v_exp_f32 v192, v192
	s_add_u32 m0, s87, 110592
	s_add_u32 s92, s88, 172032
	buffer_load_dwordx4 v6, s[16:19], s92 offen lds
	v_exp_f32 v97, v97
	v_exp_f32 v193, v193
	s_add_u32 m0, s87, 112640
	s_add_u32 s92, s88, 229376
	buffer_load_dwordx4 v6, s[16:19], s92 offen lds
	v_exp_f32 v98, v98
	v_exp_f32 v194, v194
	s_add_u32 m0, s87, 114688
	s_add_u32 s92, s88, 286720
	buffer_load_dwordx4 v6, s[16:19], s92 offen lds
	v_exp_f32 v99, v99
	v_exp_f32 v195, v195
	s_add_u32 m0, s87, 116736
	s_add_u32 s92, s88, 344064
	buffer_load_dwordx4 v6, s[16:19], s92 offen lds
	v_exp_f32 v100, v100
	v_exp_f32 v196, v196
	s_add_u32 m0, s87, 118784
	s_add_u32 s92, s88, 401408
	buffer_load_dwordx4 v6, s[16:19], s92 offen lds
	v_exp_f32 v101, v101
	v_exp_f32 v197, v197
	s_add_u32 m0, s87, 120832
	s_add_u32 s92, s88, 458752
	buffer_load_dwordx4 v6, s[16:19], s92 offen lds
	v_exp_f32 v102, v102
	v_exp_f32 v198, v198
	s_add_u32 m0, s87, 122880
	s_add_u32 s92, s88, 516096
	buffer_load_dwordx4 v6, s[16:19], s92 offen lds
	v_exp_f32 v103, v103
	v_exp_f32 v199, v199
	s_add_u32 m0, s87, 124928
	s_add_u32 s92, s88, 573440
	buffer_load_dwordx4 v6, s[16:19], s92 offen lds
	v_exp_f32 v104, v104
	v_exp_f32 v200, v200
	s_add_u32 m0, s87, 126976
	s_add_u32 s92, s88, 630784
	buffer_load_dwordx4 v6, s[16:19], s92 offen lds
	v_exp_f32 v105, v105
	v_exp_f32 v201, v201
	s_add_u32 m0, s87, 129024
	s_add_u32 s92, s88, 688128
	buffer_load_dwordx4 v6, s[16:19], s92 offen lds
	v_exp_f32 v106, v106
	v_exp_f32 v202, v202
	s_add_u32 m0, s87, 131072
	s_add_u32 s92, s88, 745472
	buffer_load_dwordx4 v6, s[16:19], s92 offen lds
	v_exp_f32 v107, v107
	v_exp_f32 v203, v203
	v_exp_f32 v108, v108
	v_exp_f32 v204, v204
	v_exp_f32 v109, v109
	v_exp_f32 v205, v205
	v_exp_f32 v110, v110
	v_exp_f32 v206, v206
	v_exp_f32 v111, v111
	v_exp_f32 v207, v207
	v_cndmask_b32 v99, v99, 0, s[96:97]
	v_cndmask_b32 v195, v195, 0, s[96:97]
	v_cndmask_b32 v103, v103, 0, s[96:97]
	v_cndmask_b32 v199, v199, 0, s[96:97]
	v_cndmask_b32 v107, v107, 0, s[96:97]
	v_cndmask_b32 v203, v203, 0, s[96:97]
	v_cndmask_b32 v111, v111, 0, s[96:97]
	v_cndmask_b32 v207, v207, 0, s[96:97]
	v_pk_add_f32 v[152:153], v[96:97], v[98:99]
	v_pk_add_f32 v[154:155], v[192:193], v[194:195]
	v_pk_add_f32 v[156:157], v[100:101], v[102:103]
	v_pk_add_f32 v[158:159], v[196:197], v[198:199]
	v_pk_add_f32 v[152:153], v[152:153], v[104:105]
	v_pk_add_f32 v[154:155], v[154:155], v[200:201]
	v_pk_add_f32 v[156:157], v[156:157], v[106:107]
	v_pk_add_f32 v[158:159], v[158:159], v[202:203]
	v_pk_add_f32 v[152:153], v[152:153], v[108:109]
	v_pk_add_f32 v[154:155], v[154:155], v[204:205]
	v_pk_add_f32 v[156:157], v[156:157], v[110:111]
	v_pk_add_f32 v[158:159], v[158:159], v[206:207]
	v_pk_add_f32 v[152:153], v[152:153], v[156:157]
	v_pk_add_f32 v[154:155], v[154:155], v[158:159]
	v_add_f32 v152, v152, v153
	v_add_f32 v154, v154, v155
	v_mov_b32 v153, v152
	v_mov_b32 v155, v154
	s_nop 0
	v_permlane32_swap_b32 v152, v153
	v_permlane32_swap_b32 v154, v155
	v_add_f32 v152, v152, v153
	v_add_f32 v154, v154, v155
	v_rcp_f32 v152, v152
	v_rcp_f32 v154, v154
	v_pk_mul_f32 v[96:97], v[96:97], v[152:153] op_sel_hi:[1,0]
	v_pk_mul_f32 v[192:193], v[192:193], v[154:155] op_sel_hi:[1,0]
	v_pk_mul_f32 v[98:99], v[98:99], v[152:153] op_sel_hi:[1,0]
	v_pk_mul_f32 v[194:195], v[194:195], v[154:155] op_sel_hi:[1,0]
	v_pk_mul_f32 v[100:101], v[100:101], v[152:153] op_sel_hi:[1,0]
	v_pk_mul_f32 v[196:197], v[196:197], v[154:155] op_sel_hi:[1,0]
	v_pk_mul_f32 v[102:103], v[102:103], v[152:153] op_sel_hi:[1,0]
	v_pk_mul_f32 v[198:199], v[198:199], v[154:155] op_sel_hi:[1,0]
	v_pk_mul_f32 v[104:105], v[104:105], v[152:153] op_sel_hi:[1,0]
	v_pk_mul_f32 v[200:201], v[200:201], v[154:155] op_sel_hi:[1,0]
	v_pk_mul_f32 v[106:107], v[106:107], v[152:153] op_sel_hi:[1,0]
	v_pk_mul_f32 v[202:203], v[202:203], v[154:155] op_sel_hi:[1,0]
	v_pk_mul_f32 v[108:109], v[108:109], v[152:153] op_sel_hi:[1,0]
	v_pk_mul_f32 v[204:205], v[204:205], v[154:155] op_sel_hi:[1,0]
	v_pk_mul_f32 v[110:111], v[110:111], v[152:153] op_sel_hi:[1,0]
	v_pk_mul_f32 v[206:207], v[206:207], v[154:155] op_sel_hi:[1,0]
	v_cvt_pk_bf16_f32 v160, v96, v97
	v_cvt_pk_bf16_f32 v168, v192, v193
	v_cvt_pk_bf16_f32 v161, v98, v99
	v_cvt_pk_bf16_f32 v169, v194, v195
	v_cvt_pk_bf16_f32 v162, v100, v101
	v_cvt_pk_bf16_f32 v170, v196, v197
	v_cvt_pk_bf16_f32 v163, v102, v103
	v_cvt_pk_bf16_f32 v171, v198, v199
	v_cvt_pk_bf16_f32 v164, v104, v105
	v_cvt_pk_bf16_f32 v172, v200, v201
	v_cvt_pk_bf16_f32 v165, v106, v107
	v_cvt_pk_bf16_f32 v173, v202, v203
	v_cvt_pk_bf16_f32 v166, v108, v109
	v_cvt_pk_bf16_f32 v174, v204, v205
	v_cvt_pk_bf16_f32 v167, v110, v111
	v_cvt_pk_bf16_f32 v175, v206, v207
	s_nop 1
Lqe_29:
	s_barrier
	v_add_u32 v13, 40960, v1
	ds_read_b128 v[96:99], v13 offset:0
	ds_read_b128 v[100:103], v13 offset:1024
	ds_read_b128 v[104:107], v13 offset:2048
	ds_read_b128 v[108:111], v13 offset:3072
	s_waitcnt lgkmcnt(3)
	v_mfma_f32_32x32x16_bf16 v[16:31], v[96:99], v[160:163], 0
	s_waitcnt lgkmcnt(2)
	v_mfma_f32_32x32x16_bf16 v[16:31], v[100:103], v[164:167], v[16:31]
	s_waitcnt lgkmcnt(1)
	v_mfma_f32_32x32x16_bf16 v[16:31], v[104:107], v[168:171], v[16:31]
	s_waitcnt lgkmcnt(0)
	v_mfma_f32_32x32x16_bf16 v[16:31], v[108:111], v[172:175], v[16:31]
	s_nop 11
	v_mov_b32 v32, v28
	v_mov_b32 v33, v28
	s_nop 1
	v_permlane32_swap_b32 v32, v33
	v_add_f32 v33, 0x358637bd, v33
	v_rcp_f32 v34, v33
	s_nop 0
	v_pk_mul_f32 v[16:17], v[16:17], v[34:35] op_sel_hi:[1,0]
	v_pk_mul_f32 v[18:19], v[18:19], v[34:35] op_sel_hi:[1,0]
	v_pk_mul_f32 v[20:21], v[20:21], v[34:35] op_sel_hi:[1,0]
	v_pk_mul_f32 v[22:23], v[22:23], v[34:35] op_sel_hi:[1,0]
	v_pk_mul_f32 v[24:25], v[24:25], v[34:35] op_sel_hi:[1,0]
	v_pk_mul_f32 v[26:27], v[26:27], v[34:35] op_sel_hi:[1,0]
	v_pk_mul_f32 v[28:29], v[28:29], v[34:35] op_sel_hi:[1,0]
	v_pk_mul_f32 v[30:31], v[30:31], v[34:35] op_sel_hi:[1,0]
	v_cndmask_b32 v28, v28, 0, s[96:97]
	v_cndmask_b32 v29, v29, 0, s[96:97]
	v_cndmask_b32 v30, v30, 0, s[96:97]
	v_cndmask_b32 v31, v31, 0, s[96:97]
	v_cvt_pk_bf16_f32 v40, v16, v17
	v_cvt_pk_bf16_f32 v41, v18, v19
	v_cvt_pk_bf16_f32 v42, v20, v21
	v_cvt_pk_bf16_f32 v43, v22, v23
	v_cvt_pk_bf16_f32 v44, v24, v25
	v_cvt_pk_bf16_f32 v45, v26, v27
	v_cvt_pk_bf16_f32 v46, v28, v29
	v_cvt_pk_bf16_f32 v47, v30, v31
	buffer_store_dwordx4 v[40:43], v1, s[4:7], s85 offen
	buffer_store_dwordx4 v[44:47], v1, s[4:7], s85 offen offset:1024
	s_add_u32 s80, s61, 128
	s_waitcnt vmcnt(0) lgkmcnt(0)
	s_barrier
	s_cmp_lg_u32 s46, 0
	s_cbranch_scc1 Lw_38
	s_lshl_b32 s68, s45, 2
	s_add_u32 s68, s68, s80
	v_mov_b32 v10, 1
	s_mov_b64 exec, 1
	s_cmp_lg_u32 s48, 0
	s_cbranch_scc1 Lh_39
	buffer_store_dword v10, off, s[4:7], s68
	s_branch Le_40
Lh_39:
	buffer_wbl2 sc1
	s_waitcnt vmcnt(0)
	buffer_store_dword v10, off, s[4:7], s68 sc1
Le_40:
	s_mov_b64 exec, -1
Lw_38:
	s_cmp_lg_u32 s46, 3
	s_cbranch_scc1 Lw_41
	s_cmp_lg_u32 s47, 0
	s_cbranch_scc1 Lx_42
	s_lshl_b32 s68, s63, 7
	s_add_u32 s68, s68, 16384
	v_mov_b32 v10, 1
	s_mov_b64 exec, 1
	buffer_atomic_add v10, off, s[4:7], s68 sc1
	s_mov_b64 exec, -1
Lx_42:
Lw_41:
	s_cmp_ge_u32 s45, 28
	s_cbranch_scc1 L_idle
L_code_p2b:
	s_lshr_b32 s73, s46, 1
	s_mul_i32 s73, s73, 28672
	s_add_u32 s73, s73, 45056
	s_lshr_b32 s68, s46, 1
	s_lshl_b32 s68, s68, 6
	v_xor_b32 v14, s68, v3
	v_add_u32 v14, s73, v14
	v_xor_b32 v15, 64, v14
	v_lshrrev_b32 v12, 5, v0
	v_lshlrev_b32 v12, 9, v12
	v_sub_u32 v13, v15, v12
	v_sub_u32 v12, v14, v12
	s_lshr_b32 s68, s65, 1
	s_lshl_b32 s68, s68, 4
	s_lshl_b32 s81, 0xffff, s68
	s_and_b32 s68, s46, 1
	s_lshl_b32 s69, s65, 1
	s_add_u32 s68, s68, s69
	s_lshl_b32 s68, s68, 15
	s_add_u32 s68, s68, s57
	s_lshr_b32 s69, s46, 1
	s_lshl_b32 s69, s69, 14
	s_add_u32 s82, s68, s69
	s_xor_b32 s68, s46, 2
	s_mul_i32 s68, s68, 1
	s_add_u32 s68, s68, 0
	s_lshl_b32 s68, s68, 12
	s_add_u32 s68, s68, 133120
	v_add_u32 v112, s68, v1
	s_mul_i32 s68, s46, 4096
	s_add_u32 s68, s68, 133120
	v_add_u32 v116, s68, v1
	s_add_u32 s80, s61, 128
	s_cmp_lg_u32 s46, 0
	s_cbranch_scc1 Lw_43
	s_mov_b32 s76, s81
	s_mov_b32 s77, 0
	v_and_b32 v11, 31, v0
	v_lshlrev_b32 v11, 2, v11
	s_cmp_lg_u32 s50, 0
	s_nop 0
	s_cbranch_scc1 Ldone_45
	s_mov_b32 s75, 0
Lpoll_44:
	buffer_load_dword v10, v11, s[4:7], s80 offen sc1
	s_waitcnt vmcnt(0)
	v_cmp_ne_u32 vcc, 1, v10
	s_add_u32 s75, s75, 1
	s_and_b64 vcc, vcc, s[76:77]
	s_cmp_eq_u64 vcc, 0
	s_nop 1
	s_cbranch_scc1 Ldone_45
	s_cmp_lt_u32 s75, 100000
	s_cbranch_scc1 Lpoll_44
	s_mov_b32 s50, 1
Ldone_45:
	s_cmp_eq_u32 s48, 0
	s_cbranch_scc1 Le_47
	buffer_inv sc1
	s_waitcnt vmcnt(0)
Le_47:
Lw_43:
	s_barrier
	s_add_u32 s84, s82, 0
	buffer_load_dwordx4 a[0:3], v1, s[4:7], s84 offen offset:0 sc1
	buffer_load_dwordx4 a[4:7], v1, s[4:7], s84 offen offset:1024 sc1
	buffer_load_dwordx4 a[8:11], v1, s[4:7], s84 offen offset:2048 sc1
	buffer_load_dwordx4 a[12:15], v1, s[4:7], s84 offen offset:3072 sc1
	s_add_u32 s84, s82, 4096
	buffer_load_dwordx4 a[16:19], v1, s[4:7], s84 offen offset:0 sc1
	buffer_load_dwordx4 a[20:23], v1, s[4:7], s84 offen offset:1024 sc1
	buffer_load_dwordx4 a[24:27], v1, s[4:7], s84 offen offset:2048 sc1
	buffer_load_dwordx4 a[28:31], v1, s[4:7], s84 offen offset:3072 sc1
	s_add_u32 s84, s82, 8192
	buffer_load_dwordx4 a[32:35], v1, s[4:7], s84 offen offset:0 sc1
	buffer_load_dwordx4 a[36:39], v1, s[4:7], s84 offen offset:1024 sc1
	ds_read_b64_tr_b16 v[80:81], v14 offset:0
	ds_read_b64_tr_b16 v[82:83], v14 offset:1024
	ds_read_b64_tr_b16 v[84:85], v15 offset:0
	ds_read_b64_tr_b16 v[86:87], v15 offset:1024
	ds_read_b64_tr_b16 v[88:89], v14 offset:2048
	ds_read_b64_tr_b16 v[90:91], v12 offset:3072
	ds_read_b64_tr_b16 v[92:93], v15 offset:2048
	ds_read_b64_tr_b16 v[94:95], v13 offset:3072
	ds_read_b64_tr_b16 v[104:105], v14 offset:3584
	ds_read_b64_tr_b16 v[106:107], v14 offset:4608
	ds_read_b64_tr_b16 v[108:109], v15 offset:3584
	ds_read_b64_tr_b16 v[110:111], v15 offset:4608
	s_waitcnt lgkmcnt(8)
	s_waitcnt vmcnt(9)
	v_mfma_f32_32x32x16_bf16 v[16:31], v[80:83], a[0:3], 0
	buffer_load_dwordx4 a[40:43], v1, s[4:7], s84 offen offset:2048 sc1
	v_mfma_f32_32x32x16_bf16 v[32:47], v[84:87], a[0:3], 0
	ds_read_b64_tr_b16 v[80:81], v14 offset:5632
	ds_read_b64_tr_b16 v[82:83], v12 offset:6656
	ds_read_b64_tr_b16 v[84:85], v15 offset:5632
	ds_read_b64_tr_b16 v[86:87], v13 offset:6656
	s_waitcnt lgkmcnt(8)
	s_waitcnt vmcnt(9)
	v_mfma_f32_32x32x16_bf16 v[16:31], v[88:91], a[4:7], v[16:31]
	buffer_load_dwordx4 a[44:47], v1, s[4:7], s84 offen offset:3072 sc1
	v_mfma_f32_32x32x16_bf16 v[32:47], v[92:95], a[4:7], v[32:47]
	ds_read_b64_tr_b16 v[88:89], v14 offset:7168
	ds_read_b64_tr_b16 v[90:91], v14 offset:8192
	ds_read_b64_tr_b16 v[92:93], v15 offset:7168
	ds_read_b64_tr_b16 v[94:95], v15 offset:8192
	s_waitcnt lgkmcnt(8)
	s_waitcnt vmcnt(9)
	v_mfma_f32_32x32x16_bf16 v[16:31], v[104:107], a[8:11], v[16:31]
	s_add_u32 s84, s82, 12288
	buffer_load_dwordx4 a[48:51], v1, s[4:7], s84 offen offset:0 sc1
	v_mfma_f32_32x32x16_bf16 v[32:47], v[108:111], a[8:11], v[32:47]
	ds_read_b64_tr_b16 v[104:105], v14 offset:9216
	ds_read_b64_tr_b16 v[106:107], v12 offset:10240
	ds_read_b64_tr_b16 v[108:109], v15 offset:9216
	ds_read_b64_tr_b16 v[110:111], v13 offset:10240
	s_waitcnt lgkmcnt(8)
	s_waitcnt vmcnt(9)
	v_mfma_f32_32x32x16_bf16 v[16:31], v[80:83], a[12:15], v[16:31]
	buffer_load_dwordx4 a[52:55], v1, s[4:7], s84 offen offset:1024 sc1
	v_mfma_f32_32x32x16_bf16 v[32:47], v[84:87], a[12:15], v[32:47]
	ds_read_b64_tr_b16 v[80:81], v14 offset:10752
	ds_read_b64_tr_b16 v[82:83], v14 offset:11776
	ds_read_b64_tr_b16 v[84:85], v15 offset:10752
	ds_read_b64_tr_b16 v[86:87], v15 offset:11776
	s_waitcnt lgkmcnt(8)
	s_waitcnt vmcnt(9)
	v_mfma_f32_32x32x16_bf16 v[16:31], v[88:91], a[16:19], v[16:31]
	buffer_load_dwordx4 a[56:59], v1, s[4:7], s84 offen offset:2048 sc1
	v_mfma_f32_32x32x16_bf16 v[32:47], v[92:95], a[16:19], v[32:47]
	ds_read_b64_tr_b16 v[88:89], v14 offset:12800
	ds_read_b64_tr_b16 v[90:91], v12 offset:13824
	ds_read_b64_tr_b16 v[92:93], v15 offset:12800
	ds_read_b64_tr_b16 v[94:95], v13 offset:13824
	s_waitcnt lgkmcnt(8)
	s_waitcnt vmcnt(9)
	v_mfma_f32_32x32x16_bf16 v[16:31], v[104:107], a[20:23], v[16:31]
	buffer_load_dwordx4 a[60:63], v1, s[4:7], s84 offen offset:3072 sc1
	v_mfma_f32_32x32x16_bf16 v[32:47], v[108:111], a[20:23], v[32:47]
	ds_read_b64_tr_b16 v[104:105], v14 offset:14336
	ds_read_b64_tr_b16 v[106:107], v14 offset:15360
	ds_read_b64_tr_b16 v[108:109], v15 offset:14336
	ds_read_b64_tr_b16 v[110:111], v15 offset:15360
	s_waitcnt lgkmcnt(8)
	s_waitcnt vmcnt(9)
	v_mfma_f32_32x32x16_bf16 v[16:31], v[80:83], a[24:27], v[16:31]
	v_mfma_f32_32x32x16_bf16 v[32:47], v[84:87], a[24:27], v[32:47]
	ds_read_b64_tr_b16 v[80:81], v14 offset:16384
	ds_read_b64_tr_b16 v[82:83], v12 offset:17408
	ds_read_b64_tr_b16 v[84:85], v15 offset:16384
	ds_read_b64_tr_b16 v[86:87], v13 offset:17408
	s_waitcnt lgkmcnt(8)
	s_waitcnt vmcnt(8)
	v_mfma_f32_32x32x16_bf16 v[16:31], v[88:91], a[28:31], v[16:31]
	v_mfma_f32_32x32x16_bf16 v[32:47], v[92:95], a[28:31], v[32:47]
	ds_read_b64_tr_b16 v[88:89], v14 offset:17920
	ds_read_b64_tr_b16 v[90:91], v14 offset:18944
	ds_read_b64_tr_b16 v[92:93], v15 offset:17920
	ds_read_b64_tr_b16 v[94:95], v15 offset:18944
	s_waitcnt lgkmcnt(8)
	s_waitcnt vmcnt(7)
	v_mfma_f32_32x32x16_bf16 v[16:31], v[104:107], a[32:35], v[16:31]
	v_mfma_f32_32x32x16_bf16 v[32:47], v[108:111], a[32:35], v[32:47]
	ds_read_b64_tr_b16 v[104:105], v14 offset:19968
	ds_read_b64_tr_b16 v[106:107], v12 offset:20992
	ds_read_b64_tr_b16 v[108:109], v15 offset:19968
	ds_read_b64_tr_b16 v[110:111], v13 offset:20992
	s_waitcnt lgkmcnt(8)
	s_waitcnt vmcnt(6)
	v_mfma_f32_32x32x16_bf16 v[16:31], v[80:83], a[36:39], v[16:31]
	v_mfma_f32_32x32x16_bf16 v[32:47], v[84:87], a[36:39], v[32:47]
	ds_read_b64_tr_b16 v[80:81], v14 offset:21504
	ds_read_b64_tr_b16 v[82:83], v14 offset:22528
	ds_read_b64_tr_b16 v[84:85], v15 offset:21504
	ds_read_b64_tr_b16 v[86:87], v15 offset:22528
	s_waitcnt lgkmcnt(8)
	s_waitcnt vmcnt(5)
	v_mfma_f32_32x32x16_bf16 v[16:31], v[88:91], a[40:43], v[16:31]
	v_mfma_f32_32x32x16_bf16 v[32:47], v[92:95], a[40:43], v[32:47]
	ds_read_b64_tr_b16 v[88:89], v14 offset:23552
	ds_read_b64_tr_b16 v[90:91], v12 offset:24576
	ds_read_b64_tr_b16 v[92:93], v15 offset:23552
	ds_read_b64_tr_b16 v[94:95], v13 offset:24576
	s_waitcnt lgkmcnt(8)
	s_waitcnt vmcnt(4)
	v_mfma_f32_32x32x16_bf16 v[16:31], v[104:107], a[44:47], v[16:31]
	v_mfma_f32_32x32x16_bf16 v[32:47], v[108:111], a[44:47], v[32:47]
	ds_read_b64_tr_b16 v[104:105], v14 offset:25088
	ds_read_b64_tr_b16 v[106:107], v14 offset:26112
	ds_read_b64_tr_b16 v[108:109], v15 offset:25088
	ds_read_b64_tr_b16 v[110:111], v15 offset:26112
	s_waitcnt lgkmcnt(8)
	s_waitcnt vmcnt(3)
	v_mfma_f32_32x32x16_bf16 v[16:31], v[80:83], a[48:51], v[16:31]
	v_mfma_f32_32x32x16_bf16 v[32:47], v[84:87], a[48:51], v[32:47]
	ds_read_b64_tr_b16 v[80:81], v14 offset:27136
	ds_read_b64_tr_b16 v[82:83], v12 offset:28160
	ds_read_b64_tr_b16 v[84:85], v15 offset:27136
	ds_read_b64_tr_b16 v[86:87], v13 offset:28160
	s_waitcnt lgkmcnt(8)
	s_waitcnt vmcnt(2)
	v_mfma_f32_32x32x16_bf16 v[16:31], v[88:91], a[52:55], v[16:31]
	v_mfma_f32_32x32x16_bf16 v[32:47], v[92:95], a[52:55], v[32:47]
	s_waitcnt lgkmcnt(4)
	s_waitcnt vmcnt(1)
	v_mfma_f32_32x32x16_bf16 v[16:31], v[104:107], a[56:59], v[16:31]
	v_mfma_f32_32x32x16_bf16 v[32:47], v[108:111], a[56:59], v[32:47]
	s_waitcnt lgkmcnt(0)
	s_waitcnt vmcnt(0)
	v_mfma_f32_32x32x16_bf16 v[16:31], v[80:83], a[60:63], v[16:31]
	v_mfma_f32_32x32x16_bf16 v[32:47], v[84:87], a[60:63], v[32:47]
	s_nop 11
	ds_write_b128 v112, v[32:35] offset:0
	ds_write_b128 v112, v[36:39] offset:1024
	ds_write_b128 v112, v[40:43] offset:2048
	ds_write_b128 v112, v[44:47] offset:3072
	s_waitcnt lgkmcnt(0)
	s_barrier
	ds_read_b128 v[32:35], v116 offset:0
	ds_read_b128 v[36:39], v116 offset:1024
	ds_read_b128 v[40:43], v116 offset:2048
	ds_read_b128 v[44:47], v116 offset:3072
	v_lshlrev_b32 v80, 16, v224
	v_and_b32 v81, 0xffff0000, v224
	v_lshlrev_b32 v82, 16, v225
	v_and_b32 v83, 0xffff0000, v225
	v_lshlrev_b32 v84, 16, v226
	v_and_b32 v85, 0xffff0000, v226
	v_lshlrev_b32 v86, 16, v227
	v_and_b32 v87, 0xffff0000, v227
	v_lshlrev_b32 v88, 16, v228
	v_and_b32 v89, 0xffff0000, v228
	v_lshlrev_b32 v90, 16, v229
	v_and_b32 v91, 0xffff0000, v229
	v_lshlrev_b32 v92, 16, v230
	v_and_b32 v93, 0xffff0000, v230
	v_lshlrev_b32 v94, 16, v231
	v_and_b32 v95, 0xffff0000, v231
	v_pk_add_f32 v[16:17], v[16:17], v[80:81]
	v_pk_add_f32 v[18:19], v[18:19], v[82:83]
	v_pk_add_f32 v[20:21], v[20:21], v[84:85]
	v_pk_add_f32 v[22:23], v[22:23], v[86:87]
	v_pk_add_f32 v[24:25], v[24:25], v[88:89]
	v_pk_add_f32 v[26:27], v[26:27], v[90:91]
	v_pk_add_f32 v[28:29], v[28:29], v[92:93]
	v_pk_add_f32 v[30:31], v[30:31], v[94:95]
	s_waitcnt lgkmcnt(0)
	v_pk_add_f32 v[16:17], v[16:17], v[32:33]
	v_pk_add_f32 v[18:19], v[18:19], v[34:35]
	v_pk_add_f32 v[20:21], v[20:21], v[36:37]
	v_pk_add_f32 v[22:23], v[22:23], v[38:39]
	v_pk_add_f32 v[24:25], v[24:25], v[40:41]
	v_pk_add_f32 v[26:27], v[26:27], v[42:43]
	v_pk_add_f32 v[28:29], v[28:29], v[44:45]
	v_pk_add_f32 v[30:31], v[30:31], v[46:47]
	v_cvt_pk_bf16_f32 v64, v16, v17
	v_cvt_pk_bf16_f32 v65, v18, v19
	v_cvt_pk_bf16_f32 v66, v20, v21
	v_cvt_pk_bf16_f32 v67, v22, v23
	v_cvt_pk_bf16_f32 v68, v24, v25
	v_cvt_pk_bf16_f32 v69, v26, v27
	v_cvt_pk_bf16_f32 v70, v28, v29
	v_cvt_pk_bf16_f32 v71, v30, v31
	s_and_b32 s69, s46, 1
	s_lshl_b32 s70, s65, 1
	s_add_u32 s69, s69, s70
	s_lshr_b32 s70, s46, 1
	s_lshl_b32 s71, s66, 1
	s_add_u32 s70, s70, s71
	s_mul_i32 s72, s69, 28672
	s_lshl_b32 s73, s70, 11
	s_add_u32 s72, s72, s73
	s_add_u32 s72, s72, s53
	buffer_store_dwordx4 v[64:67], v1, s[4:7], s72 offen
	buffer_store_dwordx4 v[68:71], v1, s[4:7], s72 offen offset:1024
	v_pk_add_f32 v[12:13], v[16:17], v[18:19]
	v_pk_mul_f32 v[14:15], v[16:17], v[16:17]
	v_pk_fma_f32 v[14:15], v[18:19], v[18:19], v[14:15]
	v_pk_add_f32 v[12:13], v[12:13], v[20:21]
	v_pk_fma_f32 v[14:15], v[20:21], v[20:21], v[14:15]
	v_pk_add_f32 v[12:13], v[12:13], v[22:23]
	v_pk_fma_f32 v[14:15], v[22:23], v[22:23], v[14:15]
	v_pk_add_f32 v[12:13], v[12:13], v[24:25]
	v_pk_fma_f32 v[14:15], v[24:25], v[24:25], v[14:15]
	v_pk_add_f32 v[12:13], v[12:13], v[26:27]
	v_pk_fma_f32 v[14:15], v[26:27], v[26:27], v[14:15]
	v_pk_add_f32 v[12:13], v[12:13], v[28:29]
	v_pk_fma_f32 v[14:15], v[28:29], v[28:29], v[14:15]
	v_pk_add_f32 v[12:13], v[12:13], v[30:31]
	v_pk_fma_f32 v[14:15], v[30:31], v[30:31], v[14:15]
	v_add_f32 v12, v12, v13
	v_add_f32 v14, v14, v15
	v_mov_b32 v13, v12
	v_mov_b32 v15, v14
	s_nop 0
	v_permlane32_swap_b32 v12, v13
	v_permlane32_swap_b32 v14, v15
	v_add_f32 v12, v12, v13
	v_add_f32 v13, v14, v15
	s_mul_i32 s72, s69, 3584
	s_lshl_b32 s73, s66, 9
	s_add_u32 s72, s72, s73
	s_lshr_b32 s73, s46, 1
	s_lshl_b32 s73, s73, 3
	s_add_u32 s72, s72, s73
	s_add_u32 s72, s72, s54
	s_mov_b64 exec, 0xffffffff
	buffer_store_dwordx2 v[12:13], v1, s[4:7], s72 offen
	s_mov_b64 exec, -1
	s_add_u32 s80, s61, 256
	s_waitcnt vmcnt(0) lgkmcnt(0)
	s_barrier
	s_cmp_lg_u32 s46, 0
	s_cbranch_scc1 Lw_48
	s_lshl_b32 s68, s45, 2
	s_add_u32 s68, s68, s80
	v_mov_b32 v10, 1
	s_mov_b64 exec, 1
	s_cmp_lg_u32 s48, 0
	s_cbranch_scc1 Lh_49
	buffer_store_dword v10, off, s[4:7], s68
	s_branch Le_50
Lh_49:
	buffer_wbl2 sc1
	s_waitcnt vmcnt(0)
	buffer_store_dword v10, off, s[4:7], s68 sc1
Le_50:
	s_mov_b64 exec, -1
Lw_48:
	s_cmp_lg_u32 s46, 1
	s_cbranch_scc1 Lw_51
	s_mul_i32 s68, s45, (((L_code_end-L_code_p4)+4095)/4096)*128
	s_add_u32 s68, s68, L_code_p4-interleave_layers__linear_kernel_hedgehog__geglu_ffn__prompt_kernel
	v_lshlrev_b32 v14, 7, v0
	v_add_u32 v14, s68, v14
	v_min_u32 v14, CODE_BYTES-4, v14
	s_mov_b32 exec_lo, (1<<(((L_code_end-L_code_p4)+4095)/4096))-1
	s_mov_b32 exec_hi, 0
	global_load_dword v255, v14, s[98:99]
	s_mov_b64 exec, -1
Lw_51:
	s_cmp_lt_u32 s46, 1
	s_cbranch_scc1 Lw_52
	s_sub_u32 s68, s46, 1
	s_lshl_b32 s90, s45, 7
	s_mul_i32 s91, s68, 28672
	s_add_u32 s90, s90, s91
	s_lshl_b32 s91, s68, 10
	s_add_u32 m0, s91, 133120
	s_add_u32 s92, s90, 802816
	buffer_load_dwordx4 v6, s[16:19], s92 offen lds
	s_add_u32 m0, s91, 136192
	s_add_u32 s92, s90, 888832
	buffer_load_dwordx4 v6, s[16:19], s92 offen lds
	s_add_u32 m0, s91, 139264
	s_add_u32 s92, s90, 974848
	buffer_load_dwordx4 v6, s[16:19], s92 offen lds
	s_add_u32 m0, s91, 142336
	s_add_u32 s92, s90, 1060864
	buffer_load_dwordx4 v6, s[16:19], s92 offen lds
	s_add_u32 m0, s91, 145408
	s_add_u32 s92, s90, 1146880
	buffer_load_dwordx4 v6, s[16:19], s92 offen lds
	s_add_u32 m0, s91, 148480
	s_add_u32 s92, s90, 1232896
	buffer_load_dwordx4 v6, s[16:19], s92 offen lds
	s_add_u32 m0, s91, 151552
	s_add_u32 s92, s90, 1318912
	buffer_load_dwordx4 v6, s[16:19], s92 offen lds
	s_add_u32 m0, s91, 154624
	s_add_u32 s92, s90, 1404928
	buffer_load_dwordx4 v6, s[16:19], s92 offen lds
	s_add_u32 m0, s91, 157696
	s_add_u32 s92, s90, 1490944
	buffer_load_dwordx4 v6, s[16:19], s92 offen lds
	s_cmp_gt_u32 s46, 1
	s_cbranch_scc1 Lx_53
	s_add_u32 m0, s91, 160768
	s_add_u32 s92, s90, 1576960
	buffer_load_dwordx4 v6, s[16:19], s92 offen lds
Lx_53:
	s_add_u32 m0, s91, 40960
	s_add_u32 s92, s90, 1146880
	buffer_load_dwordx4 v6, s[12:15], s92 offen lds
	s_add_u32 m0, s91, 44032
	s_add_u32 s92, s90, 1232896
	buffer_load_dwordx4 v6, s[12:15], s92 offen lds
	s_add_u32 m0, s91, 47104
	s_add_u32 s92, s90, 1318912
	buffer_load_dwordx4 v6, s[12:15], s92 offen lds
	s_add_u32 m0, s91, 50176
	s_add_u32 s92, s90, 1404928
	buffer_load_dwordx4 v6, s[12:15], s92 offen lds
	s_add_u32 m0, s91, 53248
	s_add_u32 s92, s90, 1490944
	buffer_load_dwordx4 v6, s[12:15], s92 offen lds
	s_cmp_gt_u32 s46, 1
	s_cbranch_scc1 Lx_54
	s_add_u32 m0, s91, 56320
	s_add_u32 s92, s90, 1576960
	buffer_load_dwordx4 v6, s[12:15], s92 offen lds
Lx_54:
Lw_52:
	v_add_u32 v12, 104448, v3
	v_add_u32 v13, 104448, v4
	s_lshl_b32 s68, s46, 1
	s_add_u32 s68, s68, 0
	s_mul_i32 s82, s68, 28672
	s_add_u32 s82, s82, s53
	s_mul_i32 s86, s68, 3584
	s_add_u32 s86, s86, s54
	s_mul_i32 s88, s68, 114688
	s_add_u32 s88, s88, s58
	s_lshl_b32 s69, s45, 12
	s_add_u32 s88, s88, s69
	s_lshl_b32 s68, s46, 1
	s_add_u32 s68, s68, 1
	s_mul_i32 s83, s68, 28672
	s_add_u32 s83, s83, s53
	s_mul_i32 s87, s68, 3584
	s_add_u32 s87, s87, s54
	s_mul_i32 s89, s68, 114688
	s_add_u32 s89, s89, s58
	s_lshl_b32 s69, s45, 12
	s_add_u32 s89, s89, s69
	s_add_u32 s80, s61, 256
	s_cmp_lg_u32 s46, 0
	s_cbranch_scc1 Lw_55
	s_mov_b32 s76, 268435455
	s_mov_b32 s77, 0
	v_and_b32 v11, 31, v0
	v_lshlrev_b32 v11, 2, v11
	s_cmp_lg_u32 s50, 0
	s_nop 0
	s_cbranch_scc1 Ldone_57
	s_mov_b32 s75, 0
Lpoll_56:
	buffer_load_dword v10, v11, s[4:7], s80 offen sc1
	s_waitcnt vmcnt(0)
	v_cmp_ne_u32 vcc, 1, v10
	s_add_u32 s75, s75, 1
	s_and_b64 vcc, vcc, s[76:77]
	s_cmp_eq_u64 vcc, 0
	s_nop 1
	s_cbranch_scc1 Ldone_57
	s_cmp_lt_u32 s75, 100000
	s_cbranch_scc1 Lpoll_56
	s_mov_b32 s50, 1
Ldone_57:
	s_cmp_eq_u32 s48, 0
	s_cbranch_scc1 Le_59
	buffer_inv sc1
	s_waitcnt vmcnt(0)
Le_59:
Lw_55:
	s_barrier
	s_add_u32 s74, s82, 0
	buffer_load_dwordx4 a[0:3], v1, s[4:7], s74 offen offset:0 sc1
	s_add_u32 s74, s83, 0
	buffer_load_dwordx4 a[4:7], v1, s[4:7], s74 offen offset:0 sc1
	s_add_u32 s74, s82, 0
	buffer_load_dwordx4 a[8:11], v1, s[4:7], s74 offen offset:1024 sc1
	s_add_u32 s74, s83, 0
	buffer_load_dwordx4 a[12:15], v1, s[4:7], s74 offen offset:1024 sc1
	s_add_u32 s74, s82, 0
	buffer_load_dwordx4 a[16:19], v1, s[4:7], s74 offen offset:2048 sc1
	s_add_u32 s74, s83, 0
	buffer_load_dwordx4 a[20:23], v1, s[4:7], s74 offen offset:2048 sc1
	s_add_u32 s74, s82, 0
	buffer_load_dwordx4 a[24:27], v1, s[4:7], s74 offen offset:3072 sc1
	s_add_u32 s74, s83, 0
	buffer_load_dwordx4 a[28:31], v1, s[4:7], s74 offen offset:3072 sc1
	s_add_u32 s74, s82, 4096
	buffer_load_dwordx4 a[32:35], v1, s[4:7], s74 offen offset:0 sc1
	s_add_u32 s74, s83, 4096
	buffer_load_dwordx4 a[36:39], v1, s[4:7], s74 offen offset:0 sc1
	s_and_b32 s68, s46, 1
	s_lshl_b32 s68, s68, 6
	v_xor_b32 v233, s68, v3
	s_lshr_b32 s68, s46, 1
	s_mul_i32 s68, s68, 104448
	v_add_u32 v233, s68, v233
	v_mov_b32 v96, 0x3f803f80
	v_mov_b32 v97, 0x3f803f80
	v_mov_b32 v98, 0x3f803f80
	v_mov_b32 v99, 0x3f803f80
	ds_read_b64_tr_b16 v[144:145], v3 offset:0
	ds_read_b64_tr_b16 v[146:147], v3 offset:1024
	ds_read_b64_tr_b16 v[148:149], v12 offset:0
	ds_read_b64_tr_b16 v[150:151], v12 offset:1024
	ds_read_b64_tr_b16 v[152:153], v3 offset:2048
	ds_read_b64_tr_b16 v[154:155], v3 offset:3072
	ds_read_b64_tr_b16 v[156:157], v12 offset:2048
	ds_read_b64_tr_b16 v[158:159], v12 offset:3072
	ds_read_b64_tr_b16 v[100:101], v233 offset:0
	ds_read_b64_tr_b16 v[102:103], v233 offset:1024
	ds_read_b64_tr_b16 v[104:105], v233 offset:2048
	ds_read_b64_tr_b16 v[106:107], v233 offset:3072
	s_waitcnt vmcnt(9)
	s_waitcnt lgkmcnt(10)
	v_mfma_f32_32x32x16_bf16 v[16:31], v[144:147], a[0:3], 0
	ds_read_b64_tr_b16 v[160:161], v3 offset:4096
	ds_read_b64_tr_b16 v[162:163], v3 offset:5120
	s_add_u32 s74, s82, 4096
	buffer_load_dwordx4 a[40:43], v1, s[4:7], s74 offen offset:1024 sc1
	s_waitcnt vmcnt(9)
	v_mfma_f32_32x32x16_bf16 v[32:47], v[144:147], a[4:7], 0
	s_waitcnt lgkmcnt(10)
	v_mfma_f32_32x32x16_bf16 v[48:63], v[148:151], a[0:3], 0
	ds_read_b64_tr_b16 v[164:165], v12 offset:4096
	ds_read_b64_tr_b16 v[166:167], v12 offset:5120
	s_add_u32 s74, s83, 4096
	buffer_load_dwordx4 a[44:47], v1, s[4:7], s74 offen offset:1024 sc1
	v_mfma_f32_32x32x16_bf16 v[64:79], v[148:151], a[4:7], 0
	s_waitcnt lgkmcnt(6)
	v_mfma_f32_32x32x16_bf16 v[200:215], v[100:103], v[96:99], 0
	ds_read_b64_tr_b16 v[108:109], v233 offset:4096
	ds_read_b64_tr_b16 v[110:111], v233 offset:5120
	s_waitcnt vmcnt(9)
	v_mfma_f32_32x32x16_bf16 v[16:31], v[152:155], a[8:11], v[16:31]
	ds_read_b64_tr_b16 v[144:145], v3 offset:6144
	ds_read_b64_tr_b16 v[146:147], v3 offset:7168
	s_add_u32 s74, s82, 4096
	buffer_load_dwordx4 a[48:51], v1, s[4:7], s74 offen offset:2048 sc1
	s_waitcnt vmcnt(9)
	v_mfma_f32_32x32x16_bf16 v[32:47], v[152:155], a[12:15], v[32:47]
	v_mfma_f32_32x32x16_bf16 v[48:63], v[156:159], a[8:11], v[48:63]
	ds_read_b64_tr_b16 v[148:149], v12 offset:6144
	ds_read_b64_tr_b16 v[150:151], v12 offset:7168
	s_add_u32 s74, s83, 4096
	buffer_load_dwordx4 a[52:55], v1, s[4:7], s74 offen offset:2048 sc1
	v_mfma_f32_32x32x16_bf16 v[64:79], v[156:159], a[12:15], v[64:79]
	s_waitcnt lgkmcnt(10)
	v_mfma_f32_32x32x16_bf16 v[200:215], v[104:107], v[96:99], v[200:215]
	ds_read_b64_tr_b16 v[100:101], v233 offset:6144
	ds_read_b64_tr_b16 v[102:103], v233 offset:7168
	s_waitcnt vmcnt(9)
	s_waitcnt lgkmcnt(10)
	v_mfma_f32_32x32x16_bf16 v[16:31], v[160:163], a[16:19], v[16:31]
	ds_read_b64_tr_b16 v[152:153], v3 offset:8192
	ds_read_b64_tr_b16 v[154:155], v3 offset:9216
	s_add_u32 s74, s82, 4096
	buffer_load_dwordx4 a[56:59], v1, s[4:7], s74 offen offset:3072 sc1
	s_waitcnt vmcnt(9)
	v_mfma_f32_32x32x16_bf16 v[32:47], v[160:163], a[20:23], v[32:47]
	s_waitcnt lgkmcnt(10)
	v_mfma_f32_32x32x16_bf16 v[48:63], v[164:167], a[16:19], v[48:63]
	ds_read_b64_tr_b16 v[156:157], v12 offset:8192
	ds_read_b64_tr_b16 v[158:159], v12 offset:9216
	s_add_u32 s74, s83, 4096
	buffer_load_dwordx4 a[60:63], v1, s[4:7], s74 offen offset:3072 sc1
	v_mfma_f32_32x32x16_bf16 v[64:79], v[164:167], a[20:23], v[64:79]
	s_waitcnt lgkmcnt(10)
	v_mfma_f32_32x32x16_bf16 v[200:215], v[108:111], v[96:99], v[200:215]
	ds_read_b64_tr_b16 v[104:105], v233 offset:8192
	ds_read_b64_tr_b16 v[106:107], v233 offset:9216
	s_waitcnt vmcnt(9)
	s_waitcnt lgkmcnt(10)
	v_mfma_f32_32x32x16_bf16 v[16:31], v[144:147], a[24:27], v[16:31]
	ds_read_b64_tr_b16 v[160:161], v3 offset:10240
	ds_read_b64_tr_b16 v[162:163], v3 offset:11264
	s_add_u32 s74, s82, 8192
	buffer_load_dwordx4 a[64:67], v1, s[4:7], s74 offen offset:0 sc1
	s_waitcnt vmcnt(9)
	v_mfma_f32_32x32x16_bf16 v[32:47], v[144:147], a[28:31], v[32:47]
	s_waitcnt lgkmcnt(10)
	v_mfma_f32_32x32x16_bf16 v[48:63], v[148:151], a[24:27], v[48:63]
	ds_read_b64_tr_b16 v[164:165], v12 offset:10240
	ds_read_b64_tr_b16 v[166:167], v12 offset:11264
	s_add_u32 s74, s83, 8192
	buffer_load_dwordx4 a[68:71], v1, s[4:7], s74 offen offset:0 sc1
	v_mfma_f32_32x32x16_bf16 v[64:79], v[148:151], a[28:31], v[64:79]
	s_waitcnt lgkmcnt(10)
	v_mfma_f32_32x32x16_bf16 v[200:215], v[100:103], v[96:99], v[200:215]
	ds_read_b64_tr_b16 v[108:109], v233 offset:10240
	ds_read_b64_tr_b16 v[110:111], v233 offset:11264
	s_waitcnt vmcnt(9)
	s_waitcnt lgkmcnt(10)
	v_mfma_f32_32x32x16_bf16 v[16:31], v[152:155], a[32:35], v[16:31]
	ds_read_b64_tr_b16 v[144:145], v3 offset:12288
	ds_read_b64_tr_b16 v[146:147], v3 offset:13312
	s_add_u32 s74, s82, 8192
	buffer_load_dwordx4 a[72:75], v1, s[4:7], s74 offen offset:1024 sc1
	s_waitcnt vmcnt(9)
	v_mfma_f32_32x32x16_bf16 v[32:47], v[152:155], a[36:39], v[32:47]
	s_waitcnt lgkmcnt(10)
	v_mfma_f32_32x32x16_bf16 v[48:63], v[156:159], a[32:35], v[48:63]
	ds_read_b64_tr_b16 v[148:149], v12 offset:12288
	ds_read_b64_tr_b16 v[150:151], v12 offset:13312
	s_add_u32 s74, s83, 8192
	buffer_load_dwordx4 a[76:79], v1, s[4:7], s74 offen offset:1024 sc1
	v_mfma_f32_32x32x16_bf16 v[64:79], v[156:159], a[36:39], v[64:79]
	s_waitcnt lgkmcnt(10)
	v_mfma_f32_32x32x16_bf16 v[200:215], v[104:107], v[96:99], v[200:215]
	ds_read_b64_tr_b16 v[100:101], v233 offset:12288
	ds_read_b64_tr_b16 v[102:103], v233 offset:13312
	s_waitcnt vmcnt(9)
	s_waitcnt lgkmcnt(10)
	v_mfma_f32_32x32x16_bf16 v[16:31], v[160:163], a[40:43], v[16:31]
	ds_read_b64_tr_b16 v[152:153], v3 offset:14336
	ds_read_b64_tr_b16 v[154:155], v3 offset:15360
	s_add_u32 s74, s82, 8192
	buffer_load_dwordx4 a[80:83], v1, s[4:7], s74 offen offset:2048 sc1
	s_waitcnt vmcnt(9)
	v_mfma_f32_32x32x16_bf16 v[32:47], v[160:163], a[44:47], v[32:47]
	s_waitcnt lgkmcnt(10)
	v_mfma_f32_32x32x16_bf16 v[48:63], v[164:167], a[40:43], v[48:63]
	ds_read_b64_tr_b16 v[156:157], v12 offset:14336
	ds_read_b64_tr_b16 v[158:159], v12 offset:15360
	s_add_u32 s74, s83, 8192
	buffer_load_dwordx4 a[84:87], v1, s[4:7], s74 offen offset:2048 sc1
	v_mfma_f32_32x32x16_bf16 v[64:79], v[164:167], a[44:47], v[64:79]
	s_waitcnt lgkmcnt(10)
	v_mfma_f32_32x32x16_bf16 v[200:215], v[108:111], v[96:99], v[200:215]
	ds_read_b64_tr_b16 v[104:105], v233 offset:14336
	ds_read_b64_tr_b16 v[106:107], v233 offset:15360
	s_waitcnt vmcnt(9)
	s_waitcnt lgkmcnt(10)
	v_mfma_f32_32x32x16_bf16 v[16:31], v[144:147], a[48:51], v[16:31]
	ds_read_b64_tr_b16 v[160:161], v3 offset:16384
	ds_read_b64_tr_b16 v[162:163], v3 offset:17408
	s_add_u32 s74, s82, 8192
	buffer_load_dwordx4 a[88:91], v1, s[4:7], s74 offen offset:3072 sc1
	s_waitcnt vmcnt(9)
	v_mfma_f32_32x32x16_bf16 v[32:47], v[144:147], a[52:55], v[32:47]
	s_waitcnt lgkmcnt(10)
	v_mfma_f32_32x32x16_bf16 v[48:63], v[148:151], a[48:51], v[48:63]
	ds_read_b64_tr_b16 v[164:165], v12 offset:16384
	ds_read_b64_tr_b16 v[166:167], v12 offset:17408
	s_add_u32 s74, s83, 8192
	buffer_load_dwordx4 a[92:95], v1, s[4:7], s74 offen offset:3072 sc1
	v_mfma_f32_32x32x16_bf16 v[64:79], v[148:151], a[52:55], v[64:79]
	s_waitcnt lgkmcnt(10)
	v_mfma_f32_32x32x16_bf16 v[200:215], v[100:103], v[96:99], v[200:215]
	ds_read_b64_tr_b16 v[108:109], v233 offset:16384
	ds_read_b64_tr_b16 v[110:111], v233 offset:17408
	buffer_load_dwordx4 v[168:171], v7, s[4:7], s86 offen offset:0 sc1
	s_waitcnt vmcnt(10)
	s_waitcnt lgkmcnt(10)
	v_mfma_f32_32x32x16_bf16 v[16:31], v[152:155], a[56:59], v[16:31]
	ds_read_b64_tr_b16 v[144:145], v3 offset:18432
	ds_read_b64_tr_b16 v[146:147], v3 offset:19456
	s_add_u32 s74, s82, 12288
	buffer_load_dwordx4 a[96:99], v1, s[4:7], s74 offen offset:0 sc1
	s_waitcnt vmcnt(10)
	v_mfma_f32_32x32x16_bf16 v[32:47], v[152:155], a[60:63], v[32:47]
	s_waitcnt lgkmcnt(10)
	v_mfma_f32_32x32x16_bf16 v[48:63], v[156:159], a[56:59], v[48:63]
	ds_read_b64_tr_b16 v[148:149], v12 offset:18432
	ds_read_b64_tr_b16 v[150:151], v12 offset:19456
	s_add_u32 s74, s83, 12288
	buffer_load_dwordx4 a[100:103], v1, s[4:7], s74 offen offset:0 sc1
	v_mfma_f32_32x32x16_bf16 v[64:79], v[156:159], a[60:63], v[64:79]
	s_waitcnt lgkmcnt(10)
	v_mfma_f32_32x32x16_bf16 v[200:215], v[104:107], v[96:99], v[200:215]
	ds_read_b64_tr_b16 v[100:101], v233 offset:18432
	ds_read_b64_tr_b16 v[102:103], v233 offset:19456
	s_waitcnt vmcnt(10)
	s_waitcnt lgkmcnt(10)
	v_mfma_f32_32x32x16_bf16 v[16:31], v[160:163], a[64:67], v[16:31]
	ds_read_b64_tr_b16 v[152:153], v3 offset:20480
	ds_read_b64_tr_b16 v[154:155], v3 offset:21504
	s_add_u32 s74, s82, 12288
	buffer_load_dwordx4 a[104:107], v1, s[4:7], s74 offen offset:1024 sc1
	s_waitcnt vmcnt(10)
	v_mfma_f32_32x32x16_bf16 v[32:47], v[160:163], a[68:71], v[32:47]
	s_waitcnt lgkmcnt(10)
	v_mfma_f32_32x32x16_bf16 v[48:63], v[164:167], a[64:67], v[48:63]
	ds_read_b64_tr_b16 v[156:157], v12 offset:20480
	ds_read_b64_tr_b16 v[158:159], v12 offset:21504
	s_add_u32 s74, s83, 12288
	buffer_load_dwordx4 a[108:111], v1, s[4:7], s74 offen offset:1024 sc1
	v_mfma_f32_32x32x16_bf16 v[64:79], v[164:167], a[68:71], v[64:79]
	s_waitcnt lgkmcnt(10)
	v_mfma_f32_32x32x16_bf16 v[200:215], v[108:111], v[96:99], v[200:215]
	ds_read_b64_tr_b16 v[104:105], v233 offset:20480
	ds_read_b64_tr_b16 v[106:107], v233 offset:21504
	buffer_load_dwordx4 v[172:175], v7, s[4:7], s86 offen offset:512 sc1
	s_waitcnt vmcnt(11)
	s_waitcnt lgkmcnt(10)
	v_mfma_f32_32x32x16_bf16 v[16:31], v[144:147], a[72:75], v[16:31]
	ds_read_b64_tr_b16 v[160:161], v3 offset:22528
	ds_read_b64_tr_b16 v[162:163], v3 offset:23552
	s_add_u32 s74, s82, 12288
	buffer_load_dwordx4 a[112:115], v1, s[4:7], s74 offen offset:2048 sc1
	s_waitcnt vmcnt(11)
	v_mfma_f32_32x32x16_bf16 v[32:47], v[144:147], a[76:79], v[32:47]
	s_waitcnt lgkmcnt(10)
	v_mfma_f32_32x32x16_bf16 v[48:63], v[148:151], a[72:75], v[48:63]
	ds_read_b64_tr_b16 v[164:165], v12 offset:22528
	ds_read_b64_tr_b16 v[166:167], v12 offset:23552
	s_add_u32 s74, s83, 12288
	buffer_load_dwordx4 a[116:119], v1, s[4:7], s74 offen offset:2048 sc1
	v_mfma_f32_32x32x16_bf16 v[64:79], v[148:151], a[76:79], v[64:79]
	s_waitcnt lgkmcnt(10)
	v_mfma_f32_32x32x16_bf16 v[200:215], v[100:103], v[96:99], v[200:215]
	ds_read_b64_tr_b16 v[108:109], v233 offset:22528
	ds_read_b64_tr_b16 v[110:111], v233 offset:23552
	s_waitcnt vmcnt(11)
	s_waitcnt lgkmcnt(10)
	v_mfma_f32_32x32x16_bf16 v[16:31], v[152:155], a[80:83], v[16:31]
	ds_read_b64_tr_b16 v[144:145], v3 offset:24576
	ds_read_b64_tr_b16 v[146:147], v3 offset:25600
	s_add_u32 s74, s82, 12288
	buffer_load_dwordx4 a[120:123], v1, s[4:7], s74 offen offset:3072 sc1
	s_waitcnt vmcnt(11)
	v_mfma_f32_32x32x16_bf16 v[32:47], v[152:155], a[84:87], v[32:47]
	s_waitcnt lgkmcnt(10)
	v_mfma_f32_32x32x16_bf16 v[48:63], v[156:159], a[80:83], v[48:63]
	ds_read_b64_tr_b16 v[148:149], v12 offset:24576
	ds_read_b64_tr_b16 v[150:151], v12 offset:25600
	s_add_u32 s74, s83, 12288
	buffer_load_dwordx4 a[124:127], v1, s[4:7], s74 offen offset:3072 sc1
	v_mfma_f32_32x32x16_bf16 v[64:79], v[156:159], a[84:87], v[64:79]
	s_waitcnt lgkmcnt(10)
	v_mfma_f32_32x32x16_bf16 v[200:215], v[104:107], v[96:99], v[200:215]
	ds_read_b64_tr_b16 v[100:101], v233 offset:24576
	ds_read_b64_tr_b16 v[102:103], v233 offset:25600
	buffer_load_dwordx4 v[176:179], v7, s[4:7], s86 offen offset:1024 sc1
	s_waitcnt vmcnt(12)
	s_waitcnt lgkmcnt(10)
	v_mfma_f32_32x32x16_bf16 v[16:31], v[160:163], a[88:91], v[16:31]
	ds_read_b64_tr_b16 v[152:153], v3 offset:26624
	ds_read_b64_tr_b16 v[154:155], v3 offset:27648
	s_add_u32 s74, s82, 16384
	buffer_load_dwordx4 a[128:131], v1, s[4:7], s74 offen offset:0 sc1
	s_waitcnt vmcnt(12)
	v_mfma_f32_32x32x16_bf16 v[32:47], v[160:163], a[92:95], v[32:47]
	s_waitcnt lgkmcnt(10)
	v_mfma_f32_32x32x16_bf16 v[48:63], v[164:167], a[88:91], v[48:63]
	ds_read_b64_tr_b16 v[156:157], v12 offset:26624
	ds_read_b64_tr_b16 v[158:159], v12 offset:27648
	s_add_u32 s74, s83, 16384
	buffer_load_dwordx4 a[132:135], v1, s[4:7], s74 offen offset:0 sc1
	v_mfma_f32_32x32x16_bf16 v[64:79], v[164:167], a[92:95], v[64:79]
	s_waitcnt lgkmcnt(10)
	v_mfma_f32_32x32x16_bf16 v[200:215], v[108:111], v[96:99], v[200:215]
	ds_read_b64_tr_b16 v[104:105], v233 offset:26624
	ds_read_b64_tr_b16 v[106:107], v233 offset:27648
	s_barrier
	s_waitcnt vmcnt(11)
	s_waitcnt lgkmcnt(10)
	v_mfma_f32_32x32x16_bf16 v[16:31], v[144:147], a[96:99], v[16:31]
	ds_read_b64_tr_b16 v[160:161], v3 offset:28672
	ds_read_b64_tr_b16 v[162:163], v3 offset:29696
	s_add_u32 s74, s82, 16384
	buffer_load_dwordx4 a[136:139], v1, s[4:7], s74 offen offset:1024 sc1
	s_waitcnt vmcnt(11)
	v_mfma_f32_32x32x16_bf16 v[32:47], v[144:147], a[100:103], v[32:47]
	s_waitcnt lgkmcnt(10)
	v_mfma_f32_32x32x16_bf16 v[48:63], v[148:151], a[96:99], v[48:63]
	ds_read_b64_tr_b16 v[164:165], v12 offset:28672
	ds_read_b64_tr_b16 v[166:167], v12 offset:29696
	s_add_u32 s74, s83, 16384
	buffer_load_dwordx4 a[140:143], v1, s[4:7], s74 offen offset:1024 sc1
	v_mfma_f32_32x32x16_bf16 v[64:79], v[148:151], a[100:103], v[64:79]
	s_waitcnt lgkmcnt(10)
	v_mfma_f32_32x32x16_bf16 v[200:215], v[100:103], v[96:99], v[200:215]
	ds_read_b64_tr_b16 v[108:109], v233 offset:28672
	ds_read_b64_tr_b16 v[110:111], v233 offset:29696
	v_mov_b32 v234, 0x40000000
	v_cndmask_b32 v234, v7, v234, s[96:97]
	buffer_load_dwordx4 v[180:183], v234, s[4:7], s86 offen offset:1536 sc1
	s_waitcnt vmcnt(12)
	s_waitcnt lgkmcnt(10)
	v_mfma_f32_32x32x16_bf16 v[16:31], v[152:155], a[104:107], v[16:31]
	ds_read_b64_tr_b16 v[144:145], v3 offset:30720
	ds_read_b64_tr_b16 v[146:147], v3 offset:31744
	s_add_u32 s74, s82, 16384
	buffer_load_dwordx4 a[144:147], v1, s[4:7], s74 offen offset:2048 sc1
	s_waitcnt vmcnt(12)
	v_mfma_f32_32x32x16_bf16 v[32:47], v[152:155], a[108:111], v[32:47]
	s_waitcnt lgkmcnt(10)
	v_mfma_f32_32x32x16_bf16 v[48:63], v[156:159], a[104:107], v[48:63]
	ds_read_b64_tr_b16 v[148:149], v12 offset:30720
	ds_read_b64_tr_b16 v[150:151], v12 offset:31744
	s_add_u32 s74, s83, 16384
	buffer_load_dwordx4 a[148:151], v1, s[4:7], s74 offen offset:2048 sc1
	v_mfma_f32_32x32x16_bf16 v[64:79], v[156:159], a[108:111], v[64:79]
	s_waitcnt lgkmcnt(10)
	v_mfma_f32_32x32x16_bf16 v[200:215], v[104:107], v[96:99], v[200:215]
	ds_read_b64_tr_b16 v[100:101], v233 offset:30720
	ds_read_b64_tr_b16 v[102:103], v233 offset:31744
	s_waitcnt vmcnt(11)
	s_waitcnt lgkmcnt(10)
	v_mfma_f32_32x32x16_bf16 v[16:31], v[160:163], a[112:115], v[16:31]
	ds_read_b64_tr_b16 v[152:153], v3 offset:32768
	ds_read_b64_tr_b16 v[154:155], v3 offset:33792
	s_add_u32 s74, s82, 16384
	buffer_load_dwordx4 a[152:155], v1, s[4:7], s74 offen offset:3072 sc1
	s_waitcnt vmcnt(11)
	v_mfma_f32_32x32x16_bf16 v[32:47], v[160:163], a[116:119], v[32:47]
	s_waitcnt lgkmcnt(10)
	v_mfma_f32_32x32x16_bf16 v[48:63], v[164:167], a[112:115], v[48:63]
	ds_read_b64_tr_b16 v[156:157], v12 offset:32768
	ds_read_b64_tr_b16 v[158:159], v12 offset:33792
	s_add_u32 s74, s83, 16384
	buffer_load_dwordx4 a[156:159], v1, s[4:7], s74 offen offset:3072 sc1
	v_mfma_f32_32x32x16_bf16 v[64:79], v[164:167], a[116:119], v[64:79]
	s_waitcnt lgkmcnt(10)
	v_mfma_f32_32x32x16_bf16 v[200:215], v[108:111], v[96:99], v[200:215]
	ds_read_b64_tr_b16 v[104:105], v233 offset:32768
	ds_read_b64_tr_b16 v[106:107], v233 offset:33792
	buffer_load_dwordx4 v[184:187], v7, s[4:7], s87 offen offset:0 sc1
	s_waitcnt vmcnt(12)
	s_waitcnt lgkmcnt(10)
	v_mfma_f32_32x32x16_bf16 v[16:31], v[144:147], a[120:123], v[16:31]
	ds_read_b64_tr_b16 v[160:161], v3 offset:34816
	ds_read_b64_tr_b16 v[162:163], v3 offset:35840
	s_add_u32 s74, s82, 20480
	buffer_load_dwordx4 a[160:163], v1, s[4:7], s74 offen offset:0 sc1
	s_waitcnt vmcnt(12)
	v_mfma_f32_32x32x16_bf16 v[32:47], v[144:147], a[124:127], v[32:47]
	s_waitcnt lgkmcnt(10)
	v_mfma_f32_32x32x16_bf16 v[48:63], v[148:151], a[120:123], v[48:63]
	ds_read_b64_tr_b16 v[164:165], v12 offset:34816
	ds_read_b64_tr_b16 v[166:167], v12 offset:35840
	s_add_u32 s74, s83, 20480
	buffer_load_dwordx4 a[164:167], v1, s[4:7], s74 offen offset:0 sc1
	v_mfma_f32_32x32x16_bf16 v[64:79], v[148:151], a[124:127], v[64:79]
	s_waitcnt lgkmcnt(10)
	v_mfma_f32_32x32x16_bf16 v[200:215], v[100:103], v[96:99], v[200:215]
	ds_read_b64_tr_b16 v[108:109], v233 offset:34816
	ds_read_b64_tr_b16 v[110:111], v233 offset:35840
	s_waitcnt vmcnt(11)
	s_waitcnt lgkmcnt(10)
	v_mfma_f32_32x32x16_bf16 v[16:31], v[152:155], a[128:131], v[16:31]
	ds_read_b64_tr_b16 v[144:145], v3 offset:36864
	ds_read_b64_tr_b16 v[146:147], v3 offset:37888
	s_add_u32 s74, s82, 20480
	buffer_load_dwordx4 a[168:171], v1, s[4:7], s74 offen offset:1024 sc1
	s_waitcnt vmcnt(11)
	v_mfma_f32_32x32x16_bf16 v[32:47], v[152:155], a[132:135], v[32:47]
	s_waitcnt lgkmcnt(10)
	v_mfma_f32_32x32x16_bf16 v[48:63], v[156:159], a[128:131], v[48:63]
	ds_read_b64_tr_b16 v[148:149], v12 offset:36864
	ds_read_b64_tr_b16 v[150:151], v12 offset:37888
	s_add_u32 s74, s83, 20480
	buffer_load_dwordx4 a[172:175], v1, s[4:7], s74 offen offset:1024 sc1
	v_mfma_f32_32x32x16_bf16 v[64:79], v[156:159], a[132:135], v[64:79]
	s_waitcnt lgkmcnt(10)
	v_mfma_f32_32x32x16_bf16 v[200:215], v[104:107], v[96:99], v[200:215]
	ds_read_b64_tr_b16 v[100:101], v233 offset:36864
	ds_read_b64_tr_b16 v[102:103], v233 offset:37888
	buffer_load_dwordx4 v[188:191], v7, s[4:7], s87 offen offset:512 sc1
	s_waitcnt vmcnt(12)
	s_waitcnt lgkmcnt(10)
	v_mfma_f32_32x32x16_bf16 v[16:31], v[160:163], a[136:139], v[16:31]
	ds_read_b64_tr_b16 v[152:153], v3 offset:38912
	ds_read_b64_tr_b16 v[154:155], v3 offset:39936
	s_add_u32 s74, s82, 20480
	buffer_load_dwordx4 a[176:179], v1, s[4:7], s74 offen offset:2048 sc1
	s_waitcnt vmcnt(12)
	v_mfma_f32_32x32x16_bf16 v[32:47], v[160:163], a[140:143], v[32:47]
	s_waitcnt lgkmcnt(10)
	v_mfma_f32_32x32x16_bf16 v[48:63], v[164:167], a[136:139], v[48:63]
	ds_read_b64_tr_b16 v[156:157], v12 offset:38912
	ds_read_b64_tr_b16 v[158:159], v12 offset:39936
	s_add_u32 s74, s83, 20480
	buffer_load_dwordx4 a[180:183], v1, s[4:7], s74 offen offset:2048 sc1
	v_mfma_f32_32x32x16_bf16 v[64:79], v[164:167], a[140:143], v[64:79]
	s_waitcnt lgkmcnt(10)
	v_mfma_f32_32x32x16_bf16 v[200:215], v[108:111], v[96:99], v[200:215]
	ds_read_b64_tr_b16 v[104:105], v233 offset:38912
	ds_read_b64_tr_b16 v[106:107], v233 offset:39936
	s_waitcnt vmcnt(11)
	s_waitcnt lgkmcnt(10)
	v_mfma_f32_32x32x16_bf16 v[16:31], v[144:147], a[144:147], v[16:31]
	ds_read_b64_tr_b16 v[160:161], v3 offset:40960
	ds_read_b64_tr_b16 v[162:163], v3 offset:41984
	s_add_u32 s74, s82, 20480
	buffer_load_dwordx4 a[184:187], v1, s[4:7], s74 offen offset:3072 sc1
	s_waitcnt vmcnt(11)
	v_mfma_f32_32x32x16_bf16 v[32:47], v[144:147], a[148:151], v[32:47]
	s_waitcnt lgkmcnt(10)
	v_mfma_f32_32x32x16_bf16 v[48:63], v[148:151], a[144:147], v[48:63]
	ds_read_b64_tr_b16 v[164:165], v12 offset:40960
	ds_read_b64_tr_b16 v[166:167], v12 offset:41984
	s_add_u32 s74, s83, 20480
	buffer_load_dwordx4 a[188:191], v1, s[4:7], s74 offen offset:3072 sc1
	v_mfma_f32_32x32x16_bf16 v[64:79], v[148:151], a[148:151], v[64:79]
	s_waitcnt lgkmcnt(10)
	v_mfma_f32_32x32x16_bf16 v[200:215], v[100:103], v[96:99], v[200:215]
	ds_read_b64_tr_b16 v[108:109], v233 offset:40960
	ds_read_b64_tr_b16 v[110:111], v233 offset:41984
	buffer_load_dwordx4 v[192:195], v7, s[4:7], s87 offen offset:1024 sc1
	s_waitcnt vmcnt(12)
	s_waitcnt lgkmcnt(10)
	v_mfma_f32_32x32x16_bf16 v[16:31], v[152:155], a[152:155], v[16:31]
	ds_read_b64_tr_b16 v[144:145], v3 offset:43008
	ds_read_b64_tr_b16 v[146:147], v3 offset:44032
	s_add_u32 s74, s82, 24576
	buffer_load_dwordx4 a[192:195], v1, s[4:7], s74 offen offset:0 sc1
	s_waitcnt vmcnt(12)
	v_mfma_f32_32x32x16_bf16 v[32:47], v[152:155], a[156:159], v[32:47]
	s_waitcnt lgkmcnt(10)
	v_mfma_f32_32x32x16_bf16 v[48:63], v[156:159], a[152:155], v[48:63]
	ds_read_b64_tr_b16 v[148:149], v12 offset:43008
	ds_read_b64_tr_b16 v[150:151], v12 offset:44032
	s_add_u32 s74, s83, 24576
	buffer_load_dwordx4 a[196:199], v1, s[4:7], s74 offen offset:0 sc1
	v_mfma_f32_32x32x16_bf16 v[64:79], v[156:159], a[156:159], v[64:79]
	s_waitcnt lgkmcnt(10)
	v_mfma_f32_32x32x16_bf16 v[200:215], v[104:107], v[96:99], v[200:215]
	ds_read_b64_tr_b16 v[100:101], v233 offset:43008
	ds_read_b64_tr_b16 v[102:103], v233 offset:44032
	s_waitcnt vmcnt(11)
	s_waitcnt lgkmcnt(10)
	v_mfma_f32_32x32x16_bf16 v[16:31], v[160:163], a[160:163], v[16:31]
	ds_read_b64_tr_b16 v[152:153], v3 offset:45056
	ds_read_b64_tr_b16 v[154:155], v3 offset:46080
	s_add_u32 s74, s82, 24576
	buffer_load_dwordx4 a[200:203], v1, s[4:7], s74 offen offset:1024 sc1
	s_waitcnt vmcnt(11)
	v_mfma_f32_32x32x16_bf16 v[32:47], v[160:163], a[164:167], v[32:47]
	s_waitcnt lgkmcnt(10)
	v_mfma_f32_32x32x16_bf16 v[48:63], v[164:167], a[160:163], v[48:63]
	ds_read_b64_tr_b16 v[156:157], v12 offset:45056
	ds_read_b64_tr_b16 v[158:159], v12 offset:46080
	s_add_u32 s74, s83, 24576
	buffer_load_dwordx4 a[204:207], v1, s[4:7], s74 offen offset:1024 sc1
	v_mfma_f32_32x32x16_bf16 v[64:79], v[164:167], a[164:167], v[64:79]
	s_waitcnt lgkmcnt(10)
	v_mfma_f32_32x32x16_bf16 v[200:215], v[108:111], v[96:99], v[200:215]
	ds_read_b64_tr_b16 v[104:105], v233 offset:45056
	ds_read_b64_tr_b16 v[106:107], v233 offset:46080
	v_mov_b32 v235, 0x40000000
	v_cndmask_b32 v235, v7, v235, s[96:97]
	buffer_load_dwordx4 v[196:199], v235, s[4:7], s87 offen offset:1536 sc1
	s_waitcnt vmcnt(12)
	s_waitcnt lgkmcnt(10)
	v_mfma_f32_32x32x16_bf16 v[16:31], v[144:147], a[168:171], v[16:31]
	ds_read_b64_tr_b16 v[160:161], v3 offset:47104
	ds_read_b64_tr_b16 v[162:163], v3 offset:48128
	s_add_u32 s74, s82, 24576
	buffer_load_dwordx4 a[208:211], v1, s[4:7], s74 offen offset:2048 sc1
	s_waitcnt vmcnt(12)
	v_mfma_f32_32x32x16_bf16 v[32:47], v[144:147], a[172:175], v[32:47]
	s_waitcnt lgkmcnt(10)
	v_mfma_f32_32x32x16_bf16 v[48:63], v[148:151], a[168:171], v[48:63]
	ds_read_b64_tr_b16 v[164:165], v12 offset:47104
	ds_read_b64_tr_b16 v[166:167], v12 offset:48128
	s_add_u32 s74, s83, 24576
	buffer_load_dwordx4 a[212:215], v1, s[4:7], s74 offen offset:2048 sc1
	v_mfma_f32_32x32x16_bf16 v[64:79], v[148:151], a[172:175], v[64:79]
	s_waitcnt lgkmcnt(10)
	v_mfma_f32_32x32x16_bf16 v[200:215], v[100:103], v[96:99], v[200:215]
	ds_read_b64_tr_b16 v[108:109], v233 offset:47104
	ds_read_b64_tr_b16 v[110:111], v233 offset:48128
	s_waitcnt vmcnt(11)
	s_waitcnt lgkmcnt(10)
	v_mfma_f32_32x32x16_bf16 v[16:31], v[152:155], a[176:179], v[16:31]
	ds_read_b64_tr_b16 v[144:145], v3 offset:49152
	ds_read_b64_tr_b16 v[146:147], v3 offset:50176
	s_add_u32 s74, s82, 24576
	buffer_load_dwordx4 a[216:219], v1, s[4:7], s74 offen offset:3072 sc1
	s_waitcnt vmcnt(11)
	v_mfma_f32_32x32x16_bf16 v[32:47], v[152:155], a[180:183], v[32:47]
	s_waitcnt lgkmcnt(10)
	v_mfma_f32_32x32x16_bf16 v[48:63], v[156:159], a[176:179], v[48:63]
	ds_read_b64_tr_b16 v[148:149], v12 offset:49152
	ds_read_b64_tr_b16 v[150:151], v12 offset:50176
	s_add_u32 s74, s83, 24576
	buffer_load_dwordx4 a[220:223], v1, s[4:7], s74 offen offset:3072 sc1
	v_mfma_f32_32x32x16_bf16 v[64:79], v[156:159], a[180:183], v[64:79]
	s_waitcnt lgkmcnt(10)
	v_mfma_f32_32x32x16_bf16 v[200:215], v[104:107], v[96:99], v[200:215]
	ds_read_b64_tr_b16 v[100:101], v233 offset:49152
	ds_read_b64_tr_b16 v[102:103], v233 offset:50176
	s_waitcnt vmcnt(11)
	s_waitcnt lgkmcnt(10)
	v_mfma_f32_32x32x16_bf16 v[16:31], v[160:163], a[184:187], v[16:31]
	ds_read_b64_tr_b16 v[152:153], v3 offset:51200
	ds_read_b64_tr_b16 v[154:155], v3 offset:52224
	s_waitcnt vmcnt(10)
	v_mfma_f32_32x32x16_bf16 v[32:47], v[160:163], a[188:191], v[32:47]
	s_waitcnt lgkmcnt(10)
	v_mfma_f32_32x32x16_bf16 v[48:63], v[164:167], a[184:187], v[48:63]
	ds_read_b64_tr_b16 v[156:157], v12 offset:51200
	ds_read_b64_tr_b16 v[158:159], v12 offset:52224
	v_mfma_f32_32x32x16_bf16 v[64:79], v[164:167], a[188:191], v[64:79]
	s_waitcnt lgkmcnt(10)
	v_mfma_f32_32x32x16_bf16 v[200:215], v[108:111], v[96:99], v[200:215]
	ds_read_b64_tr_b16 v[104:105], v233 offset:51200
	ds_read_b64_tr_b16 v[106:107], v233 offset:52224
	s_waitcnt vmcnt(8)
	s_waitcnt lgkmcnt(10)
	v_mfma_f32_32x32x16_bf16 v[16:31], v[144:147], a[192:195], v[16:31]
	ds_read_b64_tr_b16 v[160:161], v3 offset:53248
	ds_read_b64_tr_b16 v[162:163], v3 offset:54272
	s_waitcnt vmcnt(4)
	v_add_f32 v170, v170, v174
	v_add_f32 v171, v171, v175
	v_add_f32 v168, v168, v172
	v_add_f32 v169, v169, v173
	v_mfma_f32_32x32x16_bf16 v[32:47], v[144:147], a[196:199], v[32:47]
	v_add_f32 v170, v170, v178
	v_add_f32 v171, v171, v179
	v_add_f32 v168, v168, v176
	v_add_f32 v169, v169, v177
	v_add_f32 v170, v170, v182
	s_waitcnt lgkmcnt(10)
	v_mfma_f32_32x32x16_bf16 v[48:63], v[148:151], a[192:195], v[48:63]
	ds_read_b64_tr_b16 v[164:165], v12 offset:53248
	ds_read_b64_tr_b16 v[166:167], v12 offset:54272
	v_add_f32 v171, v171, v183
	v_add_f32 v168, v168, v180
	v_add_f32 v169, v169, v181
	v_add_f32 v168, v168, v170
	v_add_f32 v169, v169, v171
	v_mfma_f32_32x32x16_bf16 v[64:79], v[148:151], a[196:199], v[64:79]
	s_waitcnt lgkmcnt(10)
	v_mfma_f32_32x32x16_bf16 v[200:215], v[100:103], v[96:99], v[200:215]
	ds_read_b64_tr_b16 v[108:109], v233 offset:53248
	ds_read_b64_tr_b16 v[110:111], v233 offset:54272
	v_mov_b32 v234, v168
	v_mov_b32 v235, v169
	s_nop 0
	v_permlane32_swap_b32 v168, v234
	v_permlane32_swap_b32 v169, v235
	v_add_f32 v168, v168, v234
	s_waitcnt lgkmcnt(10)
	v_mfma_f32_32x32x16_bf16 v[16:31], v[152:155], a[200:203], v[16:31]
	ds_read_b64_tr_b16 v[144:145], v3 offset:55296
	ds_read_b64_tr_b16 v[146:147], v3 offset:56320
	v_add_f32 v169, v169, v235
	v_mul_f32 v10, 0xbb124925, v168
	v_mul_f32 v169, 0x3b124925, v169
	v_fma_f32 v169, -v10, v10, v169
	v_max_f32 v169, 0, v169
	v_mfma_f32_32x32x16_bf16 v[32:47], v[152:155], a[204:207], v[32:47]
	v_add_f32 v169, 0x3727c5ac, v169
	v_rsq_f32 v14, v169
	v_add_f32 v186, v186, v190
	v_add_f32 v187, v187, v191
	s_waitcnt lgkmcnt(10)
	v_mfma_f32_32x32x16_bf16 v[48:63], v[156:159], a[200:203], v[48:63]
	ds_read_b64_tr_b16 v[148:149], v12 offset:55296
	ds_read_b64_tr_b16 v[150:151], v12 offset:56320
	v_add_f32 v184, v184, v188
	v_add_f32 v185, v185, v189
	v_add_f32 v186, v186, v194
	v_add_f32 v187, v187, v195
	v_add_f32 v184, v184, v192
	v_mfma_f32_32x32x16_bf16 v[64:79], v[156:159], a[204:207], v[64:79]
	s_waitcnt lgkmcnt(10)
	v_mfma_f32_32x32x16_bf16 v[200:215], v[104:107], v[96:99], v[200:215]
	ds_read_b64_tr_b16 v[100:101], v233 offset:55296
	ds_read_b64_tr_b16 v[102:103], v233 offset:56320
	v_add_f32 v185, v185, v193
	v_add_f32 v186, v186, v198
	v_add_f32 v187, v187, v199
	v_add_f32 v184, v184, v196
	v_add_f32 v185, v185, v197
	s_waitcnt vmcnt(3)
	s_waitcnt lgkmcnt(10)
	v_mfma_f32_32x32x16_bf16 v[16:31], v[160:163], a[208:211], v[16:31]
	v_add_f32 v184, v184, v186
	v_add_f32 v185, v185, v187
	v_mov_b32 v234, v184
	v_mov_b32 v235, v185
	s_nop 0
	v_permlane32_swap_b32 v184, v234
	s_waitcnt vmcnt(2)
	v_mfma_f32_32x32x16_bf16 v[32:47], v[160:163], a[212:215], v[32:47]
	v_permlane32_swap_b32 v185, v235
	v_add_f32 v184, v184, v234
	v_add_f32 v185, v185, v235
	v_mul_f32 v11, 0xbb124925, v184
	v_mul_f32 v185, 0x3b124925, v185
	s_waitcnt lgkmcnt(8)
	v_mfma_f32_32x32x16_bf16 v[48:63], v[164:167], a[208:211], v[48:63]
	v_fma_f32 v185, -v11, v11, v185
	v_max_f32 v185, 0, v185
	v_add_f32 v185, 0x3727c5ac, v185
	v_rsq_f32 v15, v185
	v_mfma_f32_32x32x16_bf16 v[64:79], v[164:167], a[212:215], v[64:79]
	s_waitcnt lgkmcnt(6)
	v_mfma_f32_32x32x16_bf16 v[200:215], v[108:111], v[96:99], v[200:215]
	v_mul_f32 v234, v14, v14
	v_mov_b32 v252, v169
	v_mul_f32 v250, 0xc0135761, v14
	v_mul_f32 v234, v234, v14
	v_mul_f32 v251, 0xbdd2d3e8, v234
	s_waitcnt vmcnt(1)
	s_waitcnt lgkmcnt(4)
	v_mfma_f32_32x32x16_bf16 v[16:31], v[144:147], a[216:219], v[16:31]
	v_mul_f32 v234, v15, v15
	v_mov_b32 v238, v185
	v_mul_f32 v236, 0xc0135761, v15
	v_mul_f32 v234, v234, v15
	v_mul_f32 v237, 0xbdd2d3e8, v234
	s_waitcnt vmcnt(0)
	v_mfma_f32_32x32x16_bf16 v[32:47], v[144:147], a[220:223], v[32:47]
	s_waitcnt lgkmcnt(2)
	v_mfma_f32_32x32x16_bf16 v[48:63], v[148:151], a[216:219], v[48:63]
	v_mfma_f32_32x32x16_bf16 v[64:79], v[148:151], a[220:223], v[64:79]
	s_waitcnt lgkmcnt(0)
	v_mfma_f32_32x32x16_bf16 v[200:215], v[100:103], v[96:99], v[200:215]
	s_and_b32 s69, s46, 1
	s_lshl_b32 s70, s65, 1
	s_add_u32 s69, s69, s70
	s_lshr_b32 s70, s46, 1
	s_lshl_b32 s71, s66, 1
	s_add_u32 s70, s70, s71
	s_mul_i32 s72, s69, 28672
	s_lshl_b32 s70, s70, 11
	s_add_u32 s72, s72, s70
	s_add_u32 s72, s72, s53
	buffer_load_dwordx4 v[224:227], v1, s[4:7], s72 offen sc1
	buffer_load_dwordx4 v[228:231], v1, s[4:7], s72 offen offset:1024 sc1
	s_mul_i32 s90, s46, 401408
	s_lshl_b32 s69, s66, 7
	s_add_u32 s90, s90, s69
	s_mul_i32 s85, s46, 11264
	s_add_u32 s85, s85, 57344
	s_mul_i32 s91, s46, 28672
	s_cmp_ge_u32 s46, 2
	s_cselect_b32 s68, 47104, 0
	s_add_u32 s91, s91, s68
	s_sub_u32 s91, s91, 11264
	v_mul_u32_u24 v233, 896, v0
	s_mul_i32 s68, s65, 90
	s_add_u32 s68, s68, 88
	s_mul_i32 s68, s68, 896
	s_add_u32 s67, s68, s90
	ds_read_b64_tr_b16 v[144:145], v4 offset:0
	ds_read_b64_tr_b16 v[146:147], v4 offset:1024
	ds_read_b64_tr_b16 v[148:149], v13 offset:0
	ds_read_b64_tr_b16 v[150:151], v13 offset:1024
	ds_read_b64_tr_b16 v[152:153], v4 offset:2048
	ds_read_b64_tr_b16 v[154:155], v4 offset:3072
	ds_read_b64_tr_b16 v[156:157], v13 offset:2048
	ds_read_b64_tr_b16 v[158:159], v13 offset:3072
	s_waitcnt lgkmcnt(6)
	v_mfma_f32_32x32x16_bf16 v[80:95], v[144:147], a[0:3], 0
	ds_read_b64_tr_b16 v[160:161], v4 offset:4096
	ds_read_b64_tr_b16 v[162:163], v4 offset:5120
	s_lshl_b32 s69, s46, 7
	s_add_u32 s69, s69, 162304
	v_add_u32 v232, s69, v8
	s_mov_b32 exec_lo, 1
	s_mov_b32 exec_hi, 1
	ds_write_b128 v232, v[200:203] offset:0
	ds_write_b128 v232, v[204:207] offset:32
	ds_write_b128 v232, v[208:211] offset:64
	ds_write_b128 v232, v[212:215] offset:96
	s_mov_b64 exec, -1
	v_mfma_f32_32x32x16_bf16 v[96:111], v[144:147], a[4:7], 0
	s_waitcnt lgkmcnt(0)
	s_barrier
	v_add_u32 v232, 162304, v8
	ds_read_b128 v[168:171], v232 offset:0
	v_mfma_f32_32x32x16_bf16 v[112:127], v[148:151], a[0:3], 0
	ds_read_b64_tr_b16 v[164:165], v13 offset:4096
	ds_read_b64_tr_b16 v[166:167], v13 offset:5120
	ds_read_b128 v[172:175], v232 offset:32
	ds_read_b128 v[176:179], v232 offset:64
	ds_read_b128 v[180:183], v232 offset:96
	ds_read_b128 v[184:187], v232 offset:256
	v_mfma_f32_32x32x16_bf16 v[128:143], v[148:151], a[4:7], 0
	ds_read_b128 v[188:191], v232 offset:288
	ds_read_b128 v[192:195], v232 offset:320
	ds_read_b128 v[196:199], v232 offset:352
	s_waitcnt lgkmcnt(0)
	v_fmac_f32 v16, v10, v168
	v_mfma_f32_32x32x16_bf16 v[80:95], v[152:155], a[8:11], v[80:95]
	ds_read_b64_tr_b16 v[144:145], v4 offset:6144
	ds_read_b64_tr_b16 v[146:147], v4 offset:7168
	v_fmac_f32 v17, v10, v169
	v_fmac_f32 v18, v10, v170
	v_fmac_f32 v19, v10, v171
	v_fmac_f32 v20, v10, v172
	v_mfma_f32_32x32x16_bf16 v[96:111], v[152:155], a[12:15], v[96:111]
	v_fmac_f32 v21, v10, v173
	v_fmac_f32 v22, v10, v174
	v_fmac_f32 v23, v10, v175
	v_fmac_f32 v24, v10, v176
	v_fmac_f32 v25, v10, v177
	v_mfma_f32_32x32x16_bf16 v[112:127], v[156:159], a[8:11], v[112:127]
	ds_read_b64_tr_b16 v[148:149], v13 offset:6144
	ds_read_b64_tr_b16 v[150:151], v13 offset:7168
	s_add_u32 m0, s85, 0
	s_add_u32 s92, s90, 0
	buffer_load_dwordx4 v5, s[20:23], s92 offen lds
	v_fmac_f32 v26, v10, v178
	v_mfma_f32_32x32x16_bf16 v[128:143], v[156:159], a[12:15], v[128:143]
	v_fmac_f32 v27, v10, v179
	v_fmac_f32 v28, v10, v180
	v_fmac_f32 v29, v10, v181
	v_fmac_f32 v30, v10, v182
	v_fmac_f32 v31, v10, v183
	v_mfma_f32_32x32x16_bf16 v[80:95], v[160:163], a[16:19], v[80:95]
	ds_read_b64_tr_b16 v[152:153], v4 offset:8192
	ds_read_b64_tr_b16 v[154:155], v4 offset:9216
	v_fmac_f32 v48, v10, v184
	v_fmac_f32 v49, v10, v185
	v_fmac_f32 v50, v10, v186
	v_fmac_f32 v51, v10, v187
	v_mfma_f32_32x32x16_bf16 v[96:111], v[160:163], a[20:23], v[96:111]
	v_fmac_f32 v52, v10, v188
	v_fmac_f32 v53, v10, v189
	v_fmac_f32 v54, v10, v190
	v_fmac_f32 v55, v10, v191
	v_fmac_f32 v56, v10, v192
	v_mfma_f32_32x32x16_bf16 v[112:127], v[164:167], a[16:19], v[112:127]
	ds_read_b64_tr_b16 v[156:157], v13 offset:8192
	ds_read_b64_tr_b16 v[158:159], v13 offset:9216
	v_fmac_f32 v57, v10, v193
	v_fmac_f32 v58, v10, v194
	v_fmac_f32 v59, v10, v195
	v_fmac_f32 v60, v10, v196
	v_mfma_f32_32x32x16_bf16 v[128:143], v[164:167], a[20:23], v[128:143]
	s_add_u32 m0, s85, 1024
	s_add_u32 s92, s90, 7168
	buffer_load_dwordx4 v5, s[20:23], s92 offen lds
	v_fmac_f32 v61, v10, v197
	v_fmac_f32 v62, v10, v198
	s_waitcnt lgkmcnt(6)
	v_mfma_f32_32x32x16_bf16 v[80:95], v[144:147], a[24:27], v[80:95]
	ds_read_b64_tr_b16 v[160:161], v4 offset:10240
	ds_read_b64_tr_b16 v[162:163], v4 offset:11264
	v_fmac_f32 v63, v10, v199
	v_mul_f32 v200, v16, v16
	v_mul_f32 v201, v17, v17
	v_mul_f32 v202, v18, v18
	v_mfma_f32_32x32x16_bf16 v[96:111], v[144:147], a[28:31], v[96:111]
	v_mul_f32 v203, v19, v19
	v_mul_f32 v204, v20, v20
	v_mul_f32 v205, v21, v21
	v_mul_f32 v206, v22, v22
	v_mul_f32 v207, v23, v23
	s_waitcnt lgkmcnt(6)
	v_mfma_f32_32x32x16_bf16 v[112:127], v[148:151], a[24:27], v[112:127]
	ds_read_b64_tr_b16 v[164:165], v13 offset:10240
	ds_read_b64_tr_b16 v[166:167], v13 offset:11264
	v_mul_f32 v208, v24, v24
	v_mul_f32 v209, v25, v25
	v_mul_f32 v210, v26, v26
	v_mul_f32 v211, v27, v27
	v_mfma_f32_32x32x16_bf16 v[128:143], v[148:151], a[28:31], v[128:143]
	v_mul_f32 v212, v28, v28
	v_mul_f32 v213, v29, v29
	v_mul_f32 v214, v30, v30
	v_mul_f32 v215, v31, v31
	s_waitcnt lgkmcnt(6)
	v_mfma_f32_32x32x16_bf16 v[80:95], v[152:155], a[32:35], v[80:95]
	ds_read_b64_tr_b16 v[144:145], v4 offset:12288
	ds_read_b64_tr_b16 v[146:147], v4 offset:13312
	s_add_u32 m0, s85, 2048
	s_add_u32 s92, s90, 14336
	buffer_load_dwordx4 v5, s[20:23], s92 offen lds
	v_fma_f32 v200, v200, v251, v250
	v_fma_f32 v201, v201, v251, v250
	v_mfma_f32_32x32x16_bf16 v[96:111], v[152:155], a[36:39], v[96:111]
	v_fma_f32 v202, v202, v251, v250
	v_fma_f32 v203, v203, v251, v250
	v_fma_f32 v204, v204, v251, v250
	v_fma_f32 v205, v205, v251, v250
	v_fma_f32 v206, v206, v251, v250
	s_waitcnt lgkmcnt(6)
	v_mfma_f32_32x32x16_bf16 v[112:127], v[156:159], a[32:35], v[112:127]
	ds_read_b64_tr_b16 v[148:149], v13 offset:12288
	ds_read_b64_tr_b16 v[150:151], v13 offset:13312
	v_fma_f32 v207, v207, v251, v250
	v_fma_f32 v208, v208, v251, v250
	v_fma_f32 v209, v209, v251, v250
	v_fma_f32 v210, v210, v251, v250
	v_mfma_f32_32x32x16_bf16 v[128:143], v[156:159], a[36:39], v[128:143]
	v_fma_f32 v211, v211, v251, v250
	v_fma_f32 v212, v212, v251, v250
	v_fma_f32 v213, v213, v251, v250
	v_fma_f32 v214, v214, v251, v250
	v_fma_f32 v215, v215, v251, v250
	s_waitcnt lgkmcnt(6)
	v_mfma_f32_32x32x16_bf16 v[80:95], v[160:163], a[40:43], v[80:95]
	ds_read_b64_tr_b16 v[152:153], v4 offset:14336
	ds_read_b64_tr_b16 v[154:155], v4 offset:15360
	v_mul_f32 v200, v200, v16
	v_mul_f32 v201, v201, v17
	v_mul_f32 v202, v202, v18
	v_mfma_f32_32x32x16_bf16 v[96:111], v[160:163], a[44:47], v[96:111]
	s_add_u32 m0, s85, 3072
	s_add_u32 s92, s90, 21504
	buffer_load_dwordx4 v5, s[20:23], s92 offen lds
	v_mul_f32 v203, v203, v19
	v_mul_f32 v204, v204, v20
	v_mul_f32 v205, v205, v21
	s_waitcnt lgkmcnt(6)
	v_mfma_f32_32x32x16_bf16 v[112:127], v[164:167], a[40:43], v[112:127]
	ds_read_b64_tr_b16 v[156:157], v13 offset:14336
	ds_read_b64_tr_b16 v[158:159], v13 offset:15360
	v_mul_f32 v206, v206, v22
	v_mul_f32 v207, v207, v23
	v_mul_f32 v208, v208, v24
	v_mul_f32 v209, v209, v25
	v_mfma_f32_32x32x16_bf16 v[128:143], v[164:167], a[44:47], v[128:143]
	v_mul_f32 v210, v210, v26
	v_mul_f32 v211, v211, v27
	v_mul_f32 v212, v212, v28
	v_mul_f32 v213, v213, v29
	v_mul_f32 v214, v214, v30
	s_waitcnt lgkmcnt(6)
	v_mfma_f32_32x32x16_bf16 v[80:95], v[144:147], a[48:51], v[80:95]
	ds_read_b64_tr_b16 v[160:161], v4 offset:16384
	ds_read_b64_tr_b16 v[162:163], v4 offset:17408
	v_mul_f32 v215, v215, v31
	v_exp_f32 v200, v200
	v_mul_f32 v48, v48, v16
	v_mfma_f32_32x32x16_bf16 v[96:111], v[144:147], a[52:55], v[96:111]
	v_exp_f32 v201, v201
	v_mul_f32 v49, v49, v17
	v_exp_f32 v202, v202
	s_waitcnt lgkmcnt(6)
	v_mfma_f32_32x32x16_bf16 v[112:127], v[148:151], a[48:51], v[112:127]
	ds_read_b64_tr_b16 v[164:165], v13 offset:16384
	ds_read_b64_tr_b16 v[166:167], v13 offset:17408
	v_mul_f32 v50, v50, v18
	s_add_u32 m0, s85, 4096
	s_add_u32 s92, s90, 28672
	buffer_load_dwordx4 v5, s[20:23], s92 offen lds
	v_mfma_f32_32x32x16_bf16 v[128:143], v[148:151], a[52:55], v[128:143]
	v_exp_f32 v203, v203
	v_mul_f32 v51, v51, v19
	v_exp_f32 v204, v204
	s_waitcnt lgkmcnt(6)
	v_mfma_f32_32x32x16_bf16 v[80:95], v[152:155], a[56:59], v[80:95]
	ds_read_b64_tr_b16 v[144:145], v4 offset:18432
	ds_read_b64_tr_b16 v[146:147], v4 offset:19456
	v_mul_f32 v52, v52, v20
	v_exp_f32 v205, v205
	v_mul_f32 v53, v53, v21
	v_mfma_f32_32x32x16_bf16 v[96:111], v[152:155], a[60:63], v[96:111]
	v_exp_f32 v206, v206
	v_mul_f32 v54, v54, v22
	v_exp_f32 v207, v207
	s_waitcnt lgkmcnt(6)
	v_mfma_f32_32x32x16_bf16 v[112:127], v[156:159], a[56:59], v[112:127]
	ds_read_b64_tr_b16 v[148:149], v13 offset:18432
	ds_read_b64_tr_b16 v[150:151], v13 offset:19456
	v_mul_f32 v55, v55, v23
	v_exp_f32 v208, v208
	v_mul_f32 v56, v56, v24
	v_mfma_f32_32x32x16_bf16 v[128:143], v[156:159], a[60:63], v[128:143]
	v_exp_f32 v209, v209
	v_mul_f32 v57, v57, v25
	v_exp_f32 v210, v210
	s_waitcnt lgkmcnt(6)
	v_mfma_f32_32x32x16_bf16 v[80:95], v[160:163], a[64:67], v[80:95]
	ds_read_b64_tr_b16 v[152:153], v4 offset:20480
	ds_read_b64_tr_b16 v[154:155], v4 offset:21504
	v_mul_f32 v58, v58, v26
	v_exp_f32 v211, v211
	v_mul_f32 v59, v59, v27
	v_mfma_f32_32x32x16_bf16 v[96:111], v[160:163], a[68:71], v[96:111]
	v_exp_f32 v212, v212
	s_add_u32 m0, s85, 5120
	s_add_u32 s92, s90, 35840
	buffer_load_dwordx4 v5, s[20:23], s92 offen lds
	s_waitcnt lgkmcnt(6)
	v_mfma_f32_32x32x16_bf16 v[112:127], v[164:167], a[64:67], v[112:127]
	ds_read_b64_tr_b16 v[156:157], v13 offset:20480
	ds_read_b64_tr_b16 v[158:159], v13 offset:21504
	v_mul_f32 v60, v60, v28
	v_exp_f32 v213, v213
	v_mul_f32 v61, v61, v29
	v_mfma_f32_32x32x16_bf16 v[128:143], v[164:167], a[68:71], v[128:143]
	v_exp_f32 v214, v214
	v_mul_f32 v62, v62, v30
	v_exp_f32 v215, v215
	s_waitcnt lgkmcnt(6)
	v_mfma_f32_32x32x16_bf16 v[80:95], v[144:147], a[72:75], v[80:95]
	ds_read_b64_tr_b16 v[160:161], v4 offset:22528
	ds_read_b64_tr_b16 v[162:163], v4 offset:23552
	v_mul_f32 v63, v63, v31
	v_fma_f32 v200, v200, v252, v252
	v_fma_f32 v201, v201, v252, v252
	v_fma_f32 v202, v202, v252, v252
	v_mfma_f32_32x32x16_bf16 v[96:111], v[144:147], a[76:79], v[96:111]
	v_fma_f32 v203, v203, v252, v252
	v_fma_f32 v204, v204, v252, v252
	v_fma_f32 v205, v205, v252, v252
	v_fma_f32 v206, v206, v252, v252
	v_fma_f32 v207, v207, v252, v252
	s_waitcnt lgkmcnt(6)
	v_mfma_f32_32x32x16_bf16 v[112:127], v[148:151], a[72:75], v[112:127]
	ds_read_b64_tr_b16 v[164:165], v13 offset:22528
	ds_read_b64_tr_b16 v[166:167], v13 offset:23552
	v_fma_f32 v208, v208, v252, v252
	v_fma_f32 v209, v209, v252, v252
	v_fma_f32 v210, v210, v252, v252
	v_fma_f32 v211, v211, v252, v252
	v_mfma_f32_32x32x16_bf16 v[128:143], v[148:151], a[76:79], v[128:143]
	s_add_u32 m0, s85, 6144
	s_add_u32 s92, s90, 43008
	buffer_load_dwordx4 v5, s[20:23], s92 offen lds
	v_fma_f32 v212, v212, v252, v252
	v_fma_f32 v213, v213, v252, v252
	s_waitcnt lgkmcnt(6)
	v_mfma_f32_32x32x16_bf16 v[80:95], v[152:155], a[80:83], v[80:95]
	ds_read_b64_tr_b16 v[144:145], v4 offset:24576
	ds_read_b64_tr_b16 v[146:147], v4 offset:25600
	v_fma_f32 v214, v214, v252, v252
	v_fma_f32 v215, v215, v252, v252
	v_rcp_f32 v200, v200
	v_mfma_f32_32x32x16_bf16 v[96:111], v[152:155], a[84:87], v[96:111]
	v_rcp_f32 v201, v201
	v_rcp_f32 v202, v202
	s_waitcnt lgkmcnt(6)
	v_mfma_f32_32x32x16_bf16 v[112:127], v[156:159], a[80:83], v[112:127]
	ds_read_b64_tr_b16 v[148:149], v13 offset:24576
	ds_read_b64_tr_b16 v[150:151], v13 offset:25600
	v_rcp_f32 v203, v203
	v_rcp_f32 v204, v204
	v_mfma_f32_32x32x16_bf16 v[128:143], v[156:159], a[84:87], v[128:143]
	v_rcp_f32 v205, v205
	v_rcp_f32 v206, v206
	v_rcp_f32 v207, v207
	s_waitcnt lgkmcnt(6)
	v_mfma_f32_32x32x16_bf16 v[80:95], v[160:163], a[88:91], v[80:95]
	ds_read_b64_tr_b16 v[152:153], v4 offset:26624
	ds_read_b64_tr_b16 v[154:155], v4 offset:27648
	v_rcp_f32 v208, v208
	v_rcp_f32 v209, v209
	v_mfma_f32_32x32x16_bf16 v[96:111], v[160:163], a[92:95], v[96:111]
	v_rcp_f32 v210, v210
	v_rcp_f32 v211, v211
	s_waitcnt lgkmcnt(6)
	v_mfma_f32_32x32x16_bf16 v[112:127], v[164:167], a[88:91], v[112:127]
	ds_read_b64_tr_b16 v[156:157], v13 offset:26624
	ds_read_b64_tr_b16 v[158:159], v13 offset:27648
	v_rcp_f32 v212, v212
	v_rcp_f32 v213, v213
	v_mfma_f32_32x32x16_bf16 v[128:143], v[164:167], a[92:95], v[128:143]
	v_rcp_f32 v214, v214
	s_add_u32 m0, s85, 7168
	s_add_u32 s92, s90, 50176
	buffer_load_dwordx4 v5, s[20:23], s92 offen lds
	s_waitcnt lgkmcnt(6)
	v_mfma_f32_32x32x16_bf16 v[80:95], v[144:147], a[96:99], v[80:95]
	ds_read_b64_tr_b16 v[160:161], v4 offset:28672
	ds_read_b64_tr_b16 v[162:163], v4 offset:29696
	v_rcp_f32 v215, v215
	v_mul_f32 v48, v48, v200
	v_mul_f32 v49, v49, v201
	v_mul_f32 v50, v50, v202
	v_mfma_f32_32x32x16_bf16 v[96:111], v[144:147], a[100:103], v[96:111]
	v_mul_f32 v51, v51, v203
	v_mul_f32 v52, v52, v204
	v_mul_f32 v53, v53, v205
	v_mul_f32 v54, v54, v206
	v_mul_f32 v55, v55, v207
	s_waitcnt lgkmcnt(6)
	v_mfma_f32_32x32x16_bf16 v[112:127], v[148:151], a[96:99], v[112:127]
	ds_read_b64_tr_b16 v[164:165], v13 offset:28672
	ds_read_b64_tr_b16 v[166:167], v13 offset:29696
	v_mul_f32 v56, v56, v208
	v_mul_f32 v57, v57, v209
	v_mul_f32 v58, v58, v210
	v_mul_f32 v59, v59, v211
	v_mfma_f32_32x32x16_bf16 v[128:143], v[148:151], a[100:103], v[128:143]
	v_mul_f32 v60, v60, v212
	v_mul_f32 v61, v61, v213
	v_mul_f32 v62, v62, v214
	v_mul_f32 v63, v63, v215
	v_cvt_pk_bf16_f32 v216, v48, v49
	s_waitcnt lgkmcnt(6)
	v_mfma_f32_32x32x16_bf16 v[80:95], v[152:155], a[104:107], v[80:95]
	ds_read_b64_tr_b16 v[144:145], v4 offset:30720
	ds_read_b64_tr_b16 v[146:147], v4 offset:31744
	v_cvt_pk_bf16_f32 v217, v50, v51
	s_add_u32 m0, s85, 8192
	s_add_u32 s92, s90, 57344
	buffer_load_dwordx4 v5, s[20:23], s92 offen lds
	v_mfma_f32_32x32x16_bf16 v[96:111], v[152:155], a[108:111], v[96:111]
	v_cvt_pk_bf16_f32 v218, v52, v53
	v_cvt_pk_bf16_f32 v219, v54, v55
	v_cvt_pk_bf16_f32 v220, v56, v57
	v_cvt_pk_bf16_f32 v221, v58, v59
	v_cvt_pk_bf16_f32 v222, v60, v61
	s_waitcnt lgkmcnt(6)
	v_mfma_f32_32x32x16_bf16 v[112:127], v[156:159], a[104:107], v[112:127]
	ds_read_b64_tr_b16 v[148:149], v13 offset:30720
	ds_read_b64_tr_b16 v[150:151], v13 offset:31744
	v_cvt_pk_bf16_f32 v223, v62, v63
	buffer_store_dwordx4 v[216:219], v1, s[4:7], s88 offen offset:0
	buffer_store_dwordx4 v[220:223], v1, s[4:7], s88 offen offset:1024
	v_fmac_f32 v32, v11, v168
	v_fmac_f32 v33, v11, v169
	v_mfma_f32_32x32x16_bf16 v[128:143], v[156:159], a[108:111], v[128:143]
	v_fmac_f32 v34, v11, v170
	v_fmac_f32 v35, v11, v171
	v_fmac_f32 v36, v11, v172
	v_fmac_f32 v37, v11, v173
	v_fmac_f32 v38, v11, v174
	s_waitcnt lgkmcnt(6)
	v_mfma_f32_32x32x16_bf16 v[80:95], v[160:163], a[112:115], v[80:95]
	ds_read_b64_tr_b16 v[152:153], v4 offset:32768
	ds_read_b64_tr_b16 v[154:155], v4 offset:33792
	v_fmac_f32 v39, v11, v175
	v_fmac_f32 v40, v11, v176
	v_fmac_f32 v41, v11, v177
	v_fmac_f32 v42, v11, v178
	v_mfma_f32_32x32x16_bf16 v[96:111], v[160:163], a[116:119], v[96:111]
	v_fmac_f32 v43, v11, v179
	s_add_u32 m0, s85, 9216
	s_add_u32 s92, s90, 64512
	buffer_load_dwordx4 v5, s[20:23], s92 offen lds
	v_fmac_f32 v44, v11, v180
	s_waitcnt lgkmcnt(6)
	v_mfma_f32_32x32x16_bf16 v[112:127], v[164:167], a[112:115], v[112:127]
	ds_read_b64_tr_b16 v[156:157], v13 offset:32768
	ds_read_b64_tr_b16 v[158:159], v13 offset:33792
	v_fmac_f32 v45, v11, v181
	v_fmac_f32 v46, v11, v182
	v_fmac_f32 v47, v11, v183
	v_fmac_f32 v64, v11, v184
	v_mfma_f32_32x32x16_bf16 v[128:143], v[164:167], a[116:119], v[128:143]
	v_fmac_f32 v65, v11, v185
	v_fmac_f32 v66, v11, v186
	v_fmac_f32 v67, v11, v187
	v_fmac_f32 v68, v11, v188
	v_fmac_f32 v69, v11, v189
	s_waitcnt lgkmcnt(6)
	v_mfma_f32_32x32x16_bf16 v[80:95], v[144:147], a[120:123], v[80:95]
	ds_read_b64_tr_b16 v[160:161], v4 offset:34816
	ds_read_b64_tr_b16 v[162:163], v4 offset:35840
	v_fmac_f32 v70, v11, v190
	v_fmac_f32 v71, v11, v191
	v_fmac_f32 v72, v11, v192
	v_fmac_f32 v73, v11, v193
	v_mfma_f32_32x32x16_bf16 v[96:111], v[144:147], a[124:127], v[96:111]
	v_fmac_f32 v74, v11, v194
	v_fmac_f32 v75, v11, v195
	v_fmac_f32 v76, v11, v196
	v_fmac_f32 v77, v11, v197
	v_fmac_f32 v78, v11, v198
	s_waitcnt lgkmcnt(6)
	v_mfma_f32_32x32x16_bf16 v[112:127], v[148:151], a[120:123], v[112:127]
	ds_read_b64_tr_b16 v[164:165], v13 offset:34816
	ds_read_b64_tr_b16 v[166:167], v13 offset:35840
	s_add_u32 m0, s85, 10240
	s_add_u32 s92, s90, 71680
	buffer_load_dwordx4 v5, s[20:23], s92 offen lds
	v_fmac_f32 v79, v11, v199
	v_mfma_f32_32x32x16_bf16 v[128:143], v[148:151], a[124:127], v[128:143]
	v_mul_f32 v200, v32, v32
	v_mul_f32 v201, v33, v33
	v_mul_f32 v202, v34, v34
	v_mul_f32 v203, v35, v35
	v_mul_f32 v204, v36, v36
	s_waitcnt lgkmcnt(6)
	v_mfma_f32_32x32x16_bf16 v[80:95], v[152:155], a[128:131], v[80:95]
	ds_read_b64_tr_b16 v[144:145], v4 offset:36864
	ds_read_b64_tr_b16 v[146:147], v4 offset:37888
	v_mul_f32 v205, v37, v37
	v_mul_f32 v206, v38, v38
	v_mul_f32 v207, v39, v39
	v_mul_f32 v208, v40, v40
	v_mfma_f32_32x32x16_bf16 v[96:111], v[152:155], a[132:135], v[96:111]
	v_mul_f32 v209, v41, v41
	v_mul_f32 v210, v42, v42
	v_mul_f32 v211, v43, v43
	v_mul_f32 v212, v44, v44
	v_mul_f32 v213, v45, v45
	s_waitcnt lgkmcnt(6)
	v_mfma_f32_32x32x16_bf16 v[112:127], v[156:159], a[128:131], v[112:127]
	ds_read_b64_tr_b16 v[148:149], v13 offset:36864
	ds_read_b64_tr_b16 v[150:151], v13 offset:37888
	v_mul_f32 v214, v46, v46
	v_mul_f32 v215, v47, v47
	v_fma_f32 v200, v200, v237, v236
	v_fma_f32 v201, v201, v237, v236
	v_mfma_f32_32x32x16_bf16 v[128:143], v[156:159], a[132:135], v[128:143]
	s_add_u32 s68, s67, 0
	s_mov_b64 exec, 0xffff
	buffer_load_dword v255, v233, s[20:23], s68 offen
	s_mov_b64 exec, -1
	v_fma_f32 v202, v202, v237, v236
	v_fma_f32 v203, v203, v237, v236
	v_fma_f32 v204, v204, v237, v236
	s_waitcnt lgkmcnt(6)
	v_mfma_f32_32x32x16_bf16 v[80:95], v[160:163], a[136:139], v[80:95]
	ds_read_b64_tr_b16 v[152:153], v4 offset:38912
	ds_read_b64_tr_b16 v[154:155], v4 offset:39936
	v_fma_f32 v205, v205, v237, v236
	v_fma_f32 v206, v206, v237, v236
	v_fma_f32 v207, v207, v237, v236
	v_fma_f32 v208, v208, v237, v236
	v_mfma_f32_32x32x16_bf16 v[96:111], v[160:163], a[140:143], v[96:111]
	v_fma_f32 v209, v209, v237, v236
	v_fma_f32 v210, v210, v237, v236
	v_fma_f32 v211, v211, v237, v236
	v_fma_f32 v212, v212, v237, v236
	v_fma_f32 v213, v213, v237, v236
	s_waitcnt lgkmcnt(6)
	v_mfma_f32_32x32x16_bf16 v[112:127], v[164:167], a[136:139], v[112:127]
	ds_read_b64_tr_b16 v[156:157], v13 offset:38912
	ds_read_b64_tr_b16 v[158:159], v13 offset:39936
	v_fma_f32 v214, v214, v237, v236
	v_fma_f32 v215, v215, v237, v236
	v_mul_f32 v200, v200, v32
	v_mul_f32 v201, v201, v33
	v_mfma_f32_32x32x16_bf16 v[128:143], v[164:167], a[140:143], v[128:143]
	v_mul_f32 v202, v202, v34
	v_mul_f32 v203, v203, v35
	v_mul_f32 v204, v204, v36
	s_add_u32 s68, s67, 14336
	s_mov_b64 exec, 0xffff
	buffer_load_dword v255, v233, s[20:23], s68 offen
	s_mov_b64 exec, -1
	s_waitcnt lgkmcnt(6)
	v_mfma_f32_32x32x16_bf16 v[80:95], v[144:147], a[144:147], v[80:95]
	ds_read_b64_tr_b16 v[160:161], v4 offset:40960
	ds_read_b64_tr_b16 v[162:163], v4 offset:41984
	v_mul_f32 v205, v205, v37
	v_mul_f32 v206, v206, v38
	v_mul_f32 v207, v207, v39
	v_mul_f32 v208, v208, v40
	v_mfma_f32_32x32x16_bf16 v[96:111], v[144:147], a[148:151], v[96:111]
	v_mul_f32 v209, v209, v41
	v_mul_f32 v210, v210, v42
	v_mul_f32 v211, v211, v43
	v_mul_f32 v212, v212, v44
	v_mul_f32 v213, v213, v45
	s_waitcnt lgkmcnt(6)
	v_mfma_f32_32x32x16_bf16 v[112:127], v[148:151], a[144:147], v[112:127]
	ds_read_b64_tr_b16 v[164:165], v13 offset:40960
	ds_read_b64_tr_b16 v[166:167], v13 offset:41984
	v_mul_f32 v214, v214, v46
	v_mul_f32 v215, v215, v47
	v_exp_f32 v200, v200
	v_mfma_f32_32x32x16_bf16 v[128:143], v[148:151], a[148:151], v[128:143]
	v_mul_f32 v64, v64, v32
	v_exp_f32 v201, v201
	v_mul_f32 v65, v65, v33
	s_waitcnt lgkmcnt(6)
	v_mfma_f32_32x32x16_bf16 v[80:95], v[152:155], a[152:155], v[80:95]
	ds_read_b64_tr_b16 v[144:145], v4 offset:43008
	ds_read_b64_tr_b16 v[146:147], v4 offset:44032
	v_exp_f32 v202, v202
	v_mul_f32 v66, v66, v34
	v_exp_f32 v203, v203
	v_mfma_f32_32x32x16_bf16 v[96:111], v[152:155], a[156:159], v[96:111]
	v_mul_f32 v67, v67, v35
	s_add_u32 s68, s67, 28672
	s_mov_b64 exec, 0xffff
	buffer_load_dword v255, v233, s[20:23], s68 offen
	s_mov_b64 exec, -1
	v_exp_f32 v204, v204
	s_waitcnt lgkmcnt(6)
	v_mfma_f32_32x32x16_bf16 v[112:127], v[156:159], a[152:155], v[112:127]
	ds_read_b64_tr_b16 v[148:149], v13 offset:43008
	ds_read_b64_tr_b16 v[150:151], v13 offset:44032
	v_mul_f32 v68, v68, v36
	v_exp_f32 v205, v205
	v_mul_f32 v69, v69, v37
	v_mfma_f32_32x32x16_bf16 v[128:143], v[156:159], a[156:159], v[128:143]
	v_exp_f32 v206, v206
	v_mul_f32 v70, v70, v38
	v_exp_f32 v207, v207
	s_waitcnt lgkmcnt(6)
	v_mfma_f32_32x32x16_bf16 v[80:95], v[160:163], a[160:163], v[80:95]
	ds_read_b64_tr_b16 v[152:153], v4 offset:45056
	ds_read_b64_tr_b16 v[154:155], v4 offset:46080
	v_mul_f32 v71, v71, v39
	v_exp_f32 v208, v208
	v_mul_f32 v72, v72, v40
	v_mfma_f32_32x32x16_bf16 v[96:111], v[160:163], a[164:167], v[96:111]
	v_exp_f32 v209, v209
	v_mul_f32 v73, v73, v41
	v_exp_f32 v210, v210
	s_waitcnt lgkmcnt(6)
	v_mfma_f32_32x32x16_bf16 v[112:127], v[164:167], a[160:163], v[112:127]
	ds_read_b64_tr_b16 v[156:157], v13 offset:45056
	ds_read_b64_tr_b16 v[158:159], v13 offset:46080
	v_mul_f32 v74, v74, v42
	v_exp_f32 v211, v211
	v_mul_f32 v75, v75, v43
	v_mfma_f32_32x32x16_bf16 v[128:143], v[164:167], a[164:167], v[128:143]
	v_exp_f32 v212, v212
	v_mul_f32 v76, v76, v44
	v_exp_f32 v213, v213
	s_waitcnt lgkmcnt(6)
	v_mfma_f32_32x32x16_bf16 v[80:95], v[144:147], a[168:171], v[80:95]
	ds_read_b64_tr_b16 v[160:161], v4 offset:47104
	ds_read_b64_tr_b16 v[162:163], v4 offset:48128
	s_add_u32 s68, s67, 43008
	s_mov_b64 exec, 0xffff
	buffer_load_dword v255, v233, s[20:23], s68 offen
	s_mov_b64 exec, -1
	v_mul_f32 v77, v77, v45
	v_mfma_f32_32x32x16_bf16 v[96:111], v[144:147], a[172:175], v[96:111]
	v_exp_f32 v214, v214
	v_mul_f32 v78, v78, v46
	v_exp_f32 v215, v215
	v_mul_f32 v79, v79, v47
	s_waitcnt lgkmcnt(6)
	v_mfma_f32_32x32x16_bf16 v[112:127], v[148:151], a[168:171], v[112:127]
	ds_read_b64_tr_b16 v[164:165], v13 offset:47104
	ds_read_b64_tr_b16 v[166:167], v13 offset:48128
	v_fma_f32 v200, v200, v238, v238
	v_fma_f32 v201, v201, v238, v238
	v_fma_f32 v202, v202, v238, v238
	v_fma_f32 v203, v203, v238, v238
	v_mfma_f32_32x32x16_bf16 v[128:143], v[148:151], a[172:175], v[128:143]
	v_fma_f32 v204, v204, v238, v238
	v_fma_f32 v205, v205, v238, v238
	v_fma_f32 v206, v206, v238, v238
	v_fma_f32 v207, v207, v238, v238
	v_fma_f32 v208, v208, v238, v238
	s_waitcnt lgkmcnt(6)
	v_mfma_f32_32x32x16_bf16 v[80:95], v[152:155], a[176:179], v[80:95]
	ds_read_b64_tr_b16 v[144:145], v4 offset:49152
	ds_read_b64_tr_b16 v[146:147], v4 offset:50176
	v_fma_f32 v209, v209, v238, v238
	v_fma_f32 v210, v210, v238, v238
	v_fma_f32 v211, v211, v238, v238
	v_fma_f32 v212, v212, v238, v238
	v_mfma_f32_32x32x16_bf16 v[96:111], v[152:155], a[180:183], v[96:111]
	v_fma_f32 v213, v213, v238, v238
	s_add_u32 s68, s67, 57344
	s_mov_b64 exec, 0xffff
	buffer_load_dword v255, v233, s[20:23], s68 offen
	s_mov_b64 exec, -1
	v_fma_f32 v214, v214, v238, v238
	v_fma_f32 v215, v215, v238, v238
	s_waitcnt lgkmcnt(6)
	v_mfma_f32_32x32x16_bf16 v[112:127], v[156:159], a[176:179], v[112:127]
	ds_read_b64_tr_b16 v[148:149], v13 offset:49152
	ds_read_b64_tr_b16 v[150:151], v13 offset:50176
	v_rcp_f32 v200, v200
	v_rcp_f32 v201, v201
	v_mfma_f32_32x32x16_bf16 v[128:143], v[156:159], a[180:183], v[128:143]
	v_rcp_f32 v202, v202
	v_rcp_f32 v203, v203
	s_waitcnt lgkmcnt(6)
	v_mfma_f32_32x32x16_bf16 v[80:95], v[160:163], a[184:187], v[80:95]
	ds_read_b64_tr_b16 v[152:153], v4 offset:51200
	ds_read_b64_tr_b16 v[154:155], v4 offset:52224
	v_rcp_f32 v204, v204
	v_rcp_f32 v205, v205
	v_mfma_f32_32x32x16_bf16 v[96:111], v[160:163], a[188:191], v[96:111]
	v_rcp_f32 v206, v206
	v_rcp_f32 v207, v207
	v_rcp_f32 v208, v208
	s_waitcnt lgkmcnt(6)
	v_mfma_f32_32x32x16_bf16 v[112:127], v[164:167], a[184:187], v[112:127]
	ds_read_b64_tr_b16 v[156:157], v13 offset:51200
	ds_read_b64_tr_b16 v[158:159], v13 offset:52224
	v_rcp_f32 v209, v209
	v_rcp_f32 v210, v210
	v_mfma_f32_32x32x16_bf16 v[128:143], v[164:167], a[188:191], v[128:143]
	v_rcp_f32 v211, v211
	v_rcp_f32 v212, v212
	s_waitcnt lgkmcnt(6)
	v_mfma_f32_32x32x16_bf16 v[80:95], v[144:147], a[192:195], v[80:95]
	ds_read_b64_tr_b16 v[160:161], v4 offset:53248
	ds_read_b64_tr_b16 v[162:163], v4 offset:54272
	v_rcp_f32 v213, v213
	v_rcp_f32 v214, v214
	v_mfma_f32_32x32x16_bf16 v[96:111], v[144:147], a[196:199], v[96:111]
	v_rcp_f32 v215, v215
	v_mul_f32 v64, v64, v200
	s_add_u32 s68, s67, 71680
	s_mov_b64 exec, 0x3ff
	buffer_load_dword v255, v233, s[20:23], s68 offen
	s_mov_b64 exec, -1
	v_mul_f32 v65, v65, v201
	s_waitcnt lgkmcnt(6)
	v_mfma_f32_32x32x16_bf16 v[112:127], v[148:151], a[192:195], v[112:127]
	ds_read_b64_tr_b16 v[164:165], v13 offset:53248
	ds_read_b64_tr_b16 v[166:167], v13 offset:54272
	v_mul_f32 v66, v66, v202
	v_mul_f32 v67, v67, v203
	v_mul_f32 v68, v68, v204
	v_mul_f32 v69, v69, v205
	v_mfma_f32_32x32x16_bf16 v[128:143], v[148:151], a[196:199], v[128:143]
	v_mul_f32 v70, v70, v206
	v_mul_f32 v71, v71, v207
	v_mul_f32 v72, v72, v208
	v_mul_f32 v73, v73, v209
	v_mul_f32 v74, v74, v210
	s_waitcnt lgkmcnt(6)
	v_mfma_f32_32x32x16_bf16 v[80:95], v[152:155], a[200:203], v[80:95]
	ds_read_b64_tr_b16 v[144:145], v4 offset:55296
	ds_read_b64_tr_b16 v[146:147], v4 offset:56320
	v_mul_f32 v75, v75, v211
	v_mul_f32 v76, v76, v212
	v_mul_f32 v77, v77, v213
	v_mul_f32 v78, v78, v214
	v_mfma_f32_32x32x16_bf16 v[96:111], v[152:155], a[204:207], v[96:111]
	v_mul_f32 v79, v79, v215
	v_cvt_pk_bf16_f32 v216, v64, v65
	v_cvt_pk_bf16_f32 v217, v66, v67
	v_cvt_pk_bf16_f32 v218, v68, v69
	v_cvt_pk_bf16_f32 v219, v70, v71
	s_waitcnt lgkmcnt(6)
	v_mfma_f32_32x32x16_bf16 v[112:127], v[156:159], a[200:203], v[112:127]
	ds_read_b64_tr_b16 v[148:149], v13 offset:55296
	ds_read_b64_tr_b16 v[150:151], v13 offset:56320
	v_cvt_pk_bf16_f32 v220, v72, v73
	v_cvt_pk_bf16_f32 v221, v74, v75
	v_cvt_pk_bf16_f32 v222, v76, v77
	v_cvt_pk_bf16_f32 v223, v78, v79
	v_mfma_f32_32x32x16_bf16 v[128:143], v[156:159], a[204:207], v[128:143]
	buffer_store_dwordx4 v[216:219], v1, s[4:7], s89 offen offset:0
	buffer_store_dwordx4 v[220:223], v1, s[4:7], s89 offen offset:1024
	ds_read_b128 v[168:171], v232 offset:128
	ds_read_b128 v[172:175], v232 offset:160
	ds_read_b128 v[176:179], v232 offset:192
	ds_read_b128 v[180:183], v232 offset:224
	s_waitcnt lgkmcnt(10)
	v_mfma_f32_32x32x16_bf16 v[80:95], v[160:163], a[208:211], v[80:95]
	ds_read_b128 v[184:187], v232 offset:384
	ds_read_b128 v[188:191], v232 offset:416
	ds_read_b128 v[192:195], v232 offset:448
	ds_read_b128 v[196:199], v232 offset:480
	v_mfma_f32_32x32x16_bf16 v[96:111], v[160:163], a[212:215], v[96:111]
	s_waitcnt lgkmcnt(12)
	v_mfma_f32_32x32x16_bf16 v[112:127], v[164:167], a[208:211], v[112:127]
	v_mfma_f32_32x32x16_bf16 v[128:143], v[164:167], a[212:215], v[128:143]
	s_waitcnt lgkmcnt(10)
	v_mfma_f32_32x32x16_bf16 v[80:95], v[144:147], a[216:219], v[80:95]
	v_mfma_f32_32x32x16_bf16 v[96:111], v[144:147], a[220:223], v[96:111]
	s_waitcnt lgkmcnt(8)
	v_mfma_f32_32x32x16_bf16 v[112:127], v[148:151], a[216:219], v[112:127]
	v_mfma_f32_32x32x16_bf16 v[128:143], v[148:151], a[220:223], v[128:143]
	s_barrier
	s_waitcnt lgkmcnt(0)
	s_nop 5
	v_pk_fma_f32 v[80:81], v[168:169], v[10:11], v[80:81] op_sel:[0,0,0] op_sel_hi:[1,0,1]
	v_pk_fma_f32 v[82:83], v[170:171], v[10:11], v[82:83] op_sel:[0,0,0] op_sel_hi:[1,0,1]
	v_pk_fma_f32 v[84:85], v[172:173], v[10:11], v[84:85] op_sel:[0,0,0] op_sel_hi:[1,0,1]
	v_pk_fma_f32 v[86:87], v[174:175], v[10:11], v[86:87] op_sel:[0,0,0] op_sel_hi:[1,0,1]
	v_pk_fma_f32 v[88:89], v[176:177], v[10:11], v[88:89] op_sel:[0,0,0] op_sel_hi:[1,0,1]
	v_pk_fma_f32 v[90:91], v[178:179], v[10:11], v[90:91] op_sel:[0,0,0] op_sel_hi:[1,0,1]
	v_pk_fma_f32 v[92:93], v[180:181], v[10:11], v[92:93] op_sel:[0,0,0] op_sel_hi:[1,0,1]
	v_pk_fma_f32 v[94:95], v[182:183], v[10:11], v[94:95] op_sel:[0,0,0] op_sel_hi:[1,0,1]
	v_pk_fma_f32 v[112:113], v[184:185], v[10:11], v[112:113] op_sel:[0,0,0] op_sel_hi:[1,0,1]
	v_pk_fma_f32 v[114:115], v[186:187], v[10:11], v[114:115] op_sel:[0,0,0] op_sel_hi:[1,0,1]
	v_pk_fma_f32 v[116:117], v[188:189], v[10:11], v[116:117] op_sel:[0,0,0] op_sel_hi:[1,0,1]
	v_pk_fma_f32 v[118:119], v[190:191], v[10:11], v[118:119] op_sel:[0,0,0] op_sel_hi:[1,0,1]
	v_pk_fma_f32 v[120:121], v[192:193], v[10:11], v[120:121] op_sel:[0,0,0] op_sel_hi:[1,0,1]
	v_pk_fma_f32 v[122:123], v[194:195], v[10:11], v[122:123] op_sel:[0,0,0] op_sel_hi:[1,0,1]
	s_add_u32 m0, s91, 11264
	s_add_u32 s92, s90, 78848
	buffer_load_dwordx4 v5, s[20:23], s92 offen lds
	v_pk_fma_f32 v[124:125], v[196:197], v[10:11], v[124:125] op_sel:[0,0,0] op_sel_hi:[1,0,1]
	v_pk_fma_f32 v[126:127], v[198:199], v[10:11], v[126:127] op_sel:[0,0,0] op_sel_hi:[1,0,1]
	v_pk_mul_f32 v[200:201], v[80:81], v[80:81]
	v_pk_mul_f32 v[202:203], v[82:83], v[82:83]
	v_pk_mul_f32 v[204:205], v[84:85], v[84:85]
	v_pk_mul_f32 v[206:207], v[86:87], v[86:87]
	v_pk_mul_f32 v[208:209], v[88:89], v[88:89]
	v_pk_mul_f32 v[210:211], v[90:91], v[90:91]
	v_pk_mul_f32 v[212:213], v[92:93], v[92:93]
	v_pk_mul_f32 v[214:215], v[94:95], v[94:95]
	v_pk_fma_f32 v[200:201], v[200:201], v[250:251], v[250:251] op_sel:[0,1,0] op_sel_hi:[1,1,0]
	v_pk_fma_f32 v[202:203], v[202:203], v[250:251], v[250:251] op_sel:[0,1,0] op_sel_hi:[1,1,0]
	v_pk_fma_f32 v[204:205], v[204:205], v[250:251], v[250:251] op_sel:[0,1,0] op_sel_hi:[1,1,0]
	v_pk_fma_f32 v[206:207], v[206:207], v[250:251], v[250:251] op_sel:[0,1,0] op_sel_hi:[1,1,0]
	v_pk_fma_f32 v[208:209], v[208:209], v[250:251], v[250:251] op_sel:[0,1,0] op_sel_hi:[1,1,0]
	s_add_u32 m0, s91, 12288
	s_add_u32 s92, s90, 86016
	buffer_load_dwordx4 v5, s[20:23], s92 offen lds
	v_pk_fma_f32 v[210:211], v[210:211], v[250:251], v[250:251] op_sel:[0,1,0] op_sel_hi:[1,1,0]
	v_pk_fma_f32 v[212:213], v[212:213], v[250:251], v[250:251] op_sel:[0,1,0] op_sel_hi:[1,1,0]
	v_pk_fma_f32 v[214:215], v[214:215], v[250:251], v[250:251] op_sel:[0,1,0] op_sel_hi:[1,1,0]
	v_pk_mul_f32 v[200:201], v[200:201], v[80:81]
	v_pk_mul_f32 v[202:203], v[202:203], v[82:83]
	v_pk_mul_f32 v[204:205], v[204:205], v[84:85]
	v_pk_mul_f32 v[206:207], v[206:207], v[86:87]
	v_pk_mul_f32 v[208:209], v[208:209], v[88:89]
	v_pk_mul_f32 v[210:211], v[210:211], v[90:91]
	v_pk_mul_f32 v[212:213], v[212:213], v[92:93]
	v_pk_mul_f32 v[214:215], v[214:215], v[94:95]
	v_exp_f32 v200, v200
	v_exp_f32 v201, v201
	v_pk_mul_f32 v[112:113], v[112:113], v[80:81]
	v_exp_f32 v202, v202
	s_add_u32 m0, s91, 13312
	s_add_u32 s92, s90, 93184
	buffer_load_dwordx4 v5, s[20:23], s92 offen lds
	v_exp_f32 v203, v203
	v_pk_mul_f32 v[114:115], v[114:115], v[82:83]
	v_exp_f32 v204, v204
	v_exp_f32 v205, v205
	v_pk_mul_f32 v[116:117], v[116:117], v[84:85]
	v_exp_f32 v206, v206
	v_exp_f32 v207, v207
	v_pk_mul_f32 v[118:119], v[118:119], v[86:87]
	v_exp_f32 v208, v208
	v_exp_f32 v209, v209
	v_pk_mul_f32 v[120:121], v[120:121], v[88:89]
	v_exp_f32 v210, v210
	v_exp_f32 v211, v211
	v_pk_mul_f32 v[122:123], v[122:123], v[90:91]
	v_exp_f32 v212, v212
	s_add_u32 m0, s91, 14336
	s_add_u32 s92, s90, 100352
	buffer_load_dwordx4 v5, s[20:23], s92 offen lds
	v_exp_f32 v213, v213
	v_pk_mul_f32 v[124:125], v[124:125], v[92:93]
	v_exp_f32 v214, v214
	v_exp_f32 v215, v215
	v_pk_mul_f32 v[126:127], v[126:127], v[94:95]
	v_pk_fma_f32 v[200:201], v[200:201], v[252:253], v[252:253] op_sel:[0,0,0] op_sel_hi:[1,0,0]
	v_pk_fma_f32 v[202:203], v[202:203], v[252:253], v[252:253] op_sel:[0,0,0] op_sel_hi:[1,0,0]
	v_pk_fma_f32 v[204:205], v[204:205], v[252:253], v[252:253] op_sel:[0,0,0] op_sel_hi:[1,0,0]
	v_pk_fma_f32 v[206:207], v[206:207], v[252:253], v[252:253] op_sel:[0,0,0] op_sel_hi:[1,0,0]
	v_pk_fma_f32 v[208:209], v[208:209], v[252:253], v[252:253] op_sel:[0,0,0] op_sel_hi:[1,0,0]
	v_pk_fma_f32 v[210:211], v[210:211], v[252:253], v[252:253] op_sel:[0,0,0] op_sel_hi:[1,0,0]
	v_pk_fma_f32 v[212:213], v[212:213], v[252:253], v[252:253] op_sel:[0,0,0] op_sel_hi:[1,0,0]
	v_pk_fma_f32 v[214:215], v[214:215], v[252:253], v[252:253] op_sel:[0,0,0] op_sel_hi:[1,0,0]
	v_rcp_f32 v200, v200
	v_rcp_f32 v201, v201
	s_add_u32 m0, s91, 15360
	s_add_u32 s92, s90, 107520
	buffer_load_dwordx4 v5, s[20:23], s92 offen lds
	v_rcp_f32 v202, v202
	v_rcp_f32 v203, v203
	v_rcp_f32 v204, v204
	v_rcp_f32 v205, v205
	v_rcp_f32 v206, v206
	v_rcp_f32 v207, v207
	v_rcp_f32 v208, v208
	v_rcp_f32 v209, v209
	v_rcp_f32 v210, v210
	v_rcp_f32 v211, v211
	v_rcp_f32 v212, v212
	v_rcp_f32 v213, v213
	v_rcp_f32 v214, v214
	v_rcp_f32 v215, v215
	v_pk_mul_f32 v[112:113], v[112:113], v[200:201]
	s_add_u32 m0, s91, 16384
	s_add_u32 s92, s90, 114688
	buffer_load_dwordx4 v5, s[20:23], s92 offen lds
	v_pk_mul_f32 v[114:115], v[114:115], v[202:203]
	v_pk_mul_f32 v[116:117], v[116:117], v[204:205]
	v_pk_mul_f32 v[118:119], v[118:119], v[206:207]
	v_pk_mul_f32 v[120:121], v[120:121], v[208:209]
	v_pk_mul_f32 v[122:123], v[122:123], v[210:211]
	v_pk_mul_f32 v[124:125], v[124:125], v[212:213]
	v_pk_mul_f32 v[126:127], v[126:127], v[214:215]
	v_cvt_pk_bf16_f32 v216, v112, v113
	v_cvt_pk_bf16_f32 v217, v114, v115
	v_cvt_pk_bf16_f32 v218, v116, v117
	v_cvt_pk_bf16_f32 v219, v118, v119
	v_cvt_pk_bf16_f32 v220, v120, v121
	v_cvt_pk_bf16_f32 v221, v122, v123
	v_cvt_pk_bf16_f32 v222, v124, v125
	v_cvt_pk_bf16_f32 v223, v126, v127
	s_add_u32 m0, s91, 17408
	s_add_u32 s92, s90, 121856
	buffer_load_dwordx4 v5, s[20:23], s92 offen lds
	buffer_store_dwordx4 v[216:219], v1, s[4:7], s88 offen offset:2048
	buffer_store_dwordx4 v[220:223], v1, s[4:7], s88 offen offset:3072
	v_pk_fma_f32 v[96:97], v[168:169], v[10:11], v[96:97] op_sel:[0,1,0] op_sel_hi:[1,1,1]
	v_pk_fma_f32 v[98:99], v[170:171], v[10:11], v[98:99] op_sel:[0,1,0] op_sel_hi:[1,1,1]
	v_pk_fma_f32 v[100:101], v[172:173], v[10:11], v[100:101] op_sel:[0,1,0] op_sel_hi:[1,1,1]
	v_pk_fma_f32 v[102:103], v[174:175], v[10:11], v[102:103] op_sel:[0,1,0] op_sel_hi:[1,1,1]
	v_pk_fma_f32 v[104:105], v[176:177], v[10:11], v[104:105] op_sel:[0,1,0] op_sel_hi:[1,1,1]
	v_pk_fma_f32 v[106:107], v[178:179], v[10:11], v[106:107] op_sel:[0,1,0] op_sel_hi:[1,1,1]
	v_pk_fma_f32 v[108:109], v[180:181], v[10:11], v[108:109] op_sel:[0,1,0] op_sel_hi:[1,1,1]
	v_pk_fma_f32 v[110:111], v[182:183], v[10:11], v[110:111] op_sel:[0,1,0] op_sel_hi:[1,1,1]
	v_pk_fma_f32 v[128:129], v[184:185], v[10:11], v[128:129] op_sel:[0,1,0] op_sel_hi:[1,1,1]
	v_pk_fma_f32 v[130:131], v[186:187], v[10:11], v[130:131] op_sel:[0,1,0] op_sel_hi:[1,1,1]
	v_pk_fma_f32 v[132:133], v[188:189], v[10:11], v[132:133] op_sel:[0,1,0] op_sel_hi:[1,1,1]
	v_pk_fma_f32 v[134:135], v[190:191], v[10:11], v[134:135] op_sel:[0,1,0] op_sel_hi:[1,1,1]
	v_pk_fma_f32 v[136:137], v[192:193], v[10:11], v[136:137] op_sel:[0,1,0] op_sel_hi:[1,1,1]
	v_pk_fma_f32 v[138:139], v[194:195], v[10:11], v[138:139] op_sel:[0,1,0] op_sel_hi:[1,1,1]
	s_add_u32 m0, s91, 18432
	s_add_u32 s92, s90, 129024
	buffer_load_dwordx4 v5, s[20:23], s92 offen lds
	v_pk_fma_f32 v[140:141], v[196:197], v[10:11], v[140:141] op_sel:[0,1,0] op_sel_hi:[1,1,1]
	v_pk_fma_f32 v[142:143], v[198:199], v[10:11], v[142:143] op_sel:[0,1,0] op_sel_hi:[1,1,1]
	v_pk_mul_f32 v[200:201], v[96:97], v[96:97]
	v_pk_mul_f32 v[202:203], v[98:99], v[98:99]
	v_pk_mul_f32 v[204:205], v[100:101], v[100:101]
	v_pk_mul_f32 v[206:207], v[102:103], v[102:103]
	v_pk_mul_f32 v[208:209], v[104:105], v[104:105]
	v_pk_mul_f32 v[210:211], v[106:107], v[106:107]
	v_pk_mul_f32 v[212:213], v[108:109], v[108:109]
	v_pk_mul_f32 v[214:215], v[110:111], v[110:111]
	v_pk_fma_f32 v[200:201], v[200:201], v[236:237], v[236:237] op_sel:[0,1,0] op_sel_hi:[1,1,0]
	v_pk_fma_f32 v[202:203], v[202:203], v[236:237], v[236:237] op_sel:[0,1,0] op_sel_hi:[1,1,0]
	v_pk_fma_f32 v[204:205], v[204:205], v[236:237], v[236:237] op_sel:[0,1,0] op_sel_hi:[1,1,0]
	v_pk_fma_f32 v[206:207], v[206:207], v[236:237], v[236:237] op_sel:[0,1,0] op_sel_hi:[1,1,0]
	v_pk_fma_f32 v[208:209], v[208:209], v[236:237], v[236:237] op_sel:[0,1,0] op_sel_hi:[1,1,0]
	s_add_u32 m0, s91, 19456
	s_add_u32 s92, s90, 136192
	buffer_load_dwordx4 v5, s[20:23], s92 offen lds
	v_pk_fma_f32 v[210:211], v[210:211], v[236:237], v[236:237] op_sel:[0,1,0] op_sel_hi:[1,1,0]
	v_pk_fma_f32 v[212:213], v[212:213], v[236:237], v[236:237] op_sel:[0,1,0] op_sel_hi:[1,1,0]
	v_pk_fma_f32 v[214:215], v[214:215], v[236:237], v[236:237] op_sel:[0,1,0] op_sel_hi:[1,1,0]
	v_pk_mul_f32 v[200:201], v[200:201], v[96:97]
	v_pk_mul_f32 v[202:203], v[202:203], v[98:99]
	v_pk_mul_f32 v[204:205], v[204:205], v[100:101]
	v_pk_mul_f32 v[206:207], v[206:207], v[102:103]
	v_pk_mul_f32 v[208:209], v[208:209], v[104:105]
	v_pk_mul_f32 v[210:211], v[210:211], v[106:107]
	v_pk_mul_f32 v[212:213], v[212:213], v[108:109]
	v_pk_mul_f32 v[214:215], v[214:215], v[110:111]
	v_exp_f32 v200, v200
	v_exp_f32 v201, v201
	v_pk_mul_f32 v[128:129], v[128:129], v[96:97]
	v_exp_f32 v202, v202
	s_add_u32 m0, s91, 20480
	s_add_u32 s92, s90, 143360
	buffer_load_dwordx4 v5, s[20:23], s92 offen lds
	v_exp_f32 v203, v203
	v_pk_mul_f32 v[130:131], v[130:131], v[98:99]
	v_exp_f32 v204, v204
	v_exp_f32 v205, v205
	v_pk_mul_f32 v[132:133], v[132:133], v[100:101]
	v_exp_f32 v206, v206
	v_exp_f32 v207, v207
	v_pk_mul_f32 v[134:135], v[134:135], v[102:103]
	v_exp_f32 v208, v208
	v_exp_f32 v209, v209
	v_pk_mul_f32 v[136:137], v[136:137], v[104:105]
	v_exp_f32 v210, v210
	v_exp_f32 v211, v211
	v_pk_mul_f32 v[138:139], v[138:139], v[106:107]
	v_exp_f32 v212, v212
	s_add_u32 m0, s91, 21504
	s_add_u32 s92, s90, 150528
	buffer_load_dwordx4 v5, s[20:23], s92 offen lds
	v_exp_f32 v213, v213
	v_pk_mul_f32 v[140:141], v[140:141], v[108:109]
	v_exp_f32 v214, v214
	v_exp_f32 v215, v215
	v_pk_mul_f32 v[142:143], v[142:143], v[110:111]
	v_pk_fma_f32 v[200:201], v[200:201], v[238:239], v[238:239] op_sel:[0,0,0] op_sel_hi:[1,0,0]
	v_pk_fma_f32 v[202:203], v[202:203], v[238:239], v[238:239] op_sel:[0,0,0] op_sel_hi:[1,0,0]
	v_pk_fma_f32 v[204:205], v[204:205], v[238:239], v[238:239] op_sel:[0,0,0] op_sel_hi:[1,0,0]
	v_pk_fma_f32 v[206:207], v[206:207], v[238:239], v[238:239] op_sel:[0,0,0] op_sel_hi:[1,0,0]
	v_pk_fma_f32 v[208:209], v[208:209], v[238:239], v[238:239] op_sel:[0,0,0] op_sel_hi:[1,0,0]
	v_pk_fma_f32 v[210:211], v[210:211], v[238:239], v[238:239] op_sel:[0,0,0] op_sel_hi:[1,0,0]
	v_pk_fma_f32 v[212:213], v[212:213], v[238:239], v[238:239] op_sel:[0,0,0] op_sel_hi:[1,0,0]
	v_pk_fma_f32 v[214:215], v[214:215], v[238:239], v[238:239] op_sel:[0,0,0] op_sel_hi:[1,0,0]
	v_rcp_f32 v200, v200
	v_rcp_f32 v201, v201
	s_add_u32 m0, s91, 22528
	s_add_u32 s92, s90, 157696
	buffer_load_dwordx4 v5, s[20:23], s92 offen lds
	v_rcp_f32 v202, v202
	v_rcp_f32 v203, v203
	v_rcp_f32 v204, v204
	v_rcp_f32 v205, v205
	v_rcp_f32 v206, v206
	v_rcp_f32 v207, v207
	v_rcp_f32 v208, v208
	v_rcp_f32 v209, v209
	v_rcp_f32 v210, v210
	v_rcp_f32 v211, v211
	v_rcp_f32 v212, v212
	v_rcp_f32 v213, v213
	v_rcp_f32 v214, v214
	v_rcp_f32 v215, v215
	v_pk_mul_f32 v[128:129], v[128:129], v[200:201]
	v_pk_mul_f32 v[130:131], v[130:131], v[202:203]
	v_pk_mul_f32 v[132:133], v[132:133], v[204:205]
	v_pk_mul_f32 v[134:135], v[134:135], v[206:207]
	v_pk_mul_f32 v[136:137], v[136:137], v[208:209]
	v_pk_mul_f32 v[138:139], v[138:139], v[210:211]
	v_pk_mul_f32 v[140:141], v[140:141], v[212:213]
	v_pk_mul_f32 v[142:143], v[142:143], v[214:215]
	v_cvt_pk_bf16_f32 v216, v128, v129
	v_cvt_pk_bf16_f32 v217, v130, v131
	v_cvt_pk_bf16_f32 v218, v132, v133
	v_cvt_pk_bf16_f32 v219, v134, v135
	v_cvt_pk_bf16_f32 v220, v136, v137
	v_cvt_pk_bf16_f32 v221, v138, v139
	v_cvt_pk_bf16_f32 v222, v140, v141
	v_cvt_pk_bf16_f32 v223, v142, v143
	buffer_store_dwordx4 v[216:219], v1, s[4:7], s89 offen offset:2048
	buffer_store_dwordx4 v[220:223], v1, s[4:7], s89 offen offset:3072
	s_add_u32 s80, s61, 384
	s_waitcnt vmcnt(0) lgkmcnt(0)
	s_barrier
	s_cmp_lg_u32 s46, 0
	s_cbranch_scc1 Lw_60
	s_lshl_b32 s68, s45, 2
	s_add_u32 s68, s68, s80
	v_mov_b32 v10, 1
	s_mov_b64 exec, 1
	s_cmp_lg_u32 s48, 0
	s_cbranch_scc1 Lh_61
	buffer_store_dword v10, off, s[4:7], s68
	s_branch Le_62
Lh_61:
	buffer_wbl2 sc1
	s_waitcnt vmcnt(0)
	buffer_store_dword v10, off, s[4:7], s68 sc1
Le_62:
	s_mov_b64 exec, -1
Lw_60:
	s_cmp_lt_u32 s46, 1
	s_cbranch_scc1 Lw_63
	s_add_u32 m0, s91, 23552
	s_add_u32 s92, s90, 164864
	buffer_load_dwordx4 v5, s[20:23], s92 offen lds
	s_add_u32 m0, s91, 24576
	s_add_u32 s92, s90, 172032
	buffer_load_dwordx4 v5, s[20:23], s92 offen lds
	s_add_u32 m0, s91, 25600
	s_add_u32 s92, s90, 179200
	buffer_load_dwordx4 v5, s[20:23], s92 offen lds
	s_add_u32 m0, s91, 26624
	s_add_u32 s92, s90, 186368
	buffer_load_dwordx4 v5, s[20:23], s92 offen lds
	s_add_u32 m0, s91, 27648
	s_add_u32 s92, s90, 193536
	buffer_load_dwordx4 v5, s[20:23], s92 offen lds
	s_add_u32 m0, s91, 28672
	s_add_u32 s92, s90, 200704
	buffer_load_dwordx4 v5, s[20:23], s92 offen lds
	s_add_u32 m0, s91, 29696
	s_add_u32 s92, s90, 207872
	buffer_load_dwordx4 v5, s[20:23], s92 offen lds
	s_add_u32 m0, s91, 30720
	s_add_u32 s92, s90, 215040
	buffer_load_dwordx4 v5, s[20:23], s92 offen lds
	s_add_u32 m0, s91, 31744
	s_add_u32 s92, s90, 222208
	buffer_load_dwordx4 v5, s[20:23], s92 offen lds
	s_add_u32 m0, s91, 32768
	s_add_u32 s92, s90, 229376
	buffer_load_dwordx4 v5, s[20:23], s92 offen lds
	s_add_u32 m0, s91, 33792
	s_add_u32 s92, s90, 236544
	buffer_load_dwordx4 v5, s[20:23], s92 offen lds
	s_add_u32 m0, s91, 34816
	s_add_u32 s92, s90, 243712
	buffer_load_dwordx4 v5, s[20:23], s92 offen lds
	s_add_u32 m0, s91, 35840
	s_add_u32 s92, s90, 250880
	buffer_load_dwordx4 v5, s[20:23], s92 offen lds
	s_add_u32 m0, s91, 36864
	s_add_u32 s92, s90, 258048
	buffer_load_dwordx4 v5, s[20:23], s92 offen lds
	s_add_u32 m0, s91, 37888
	s_add_u32 s92, s90, 265216
	buffer_load_dwordx4 v5, s[20:23], s92 offen lds
	s_add_u32 m0, s91, 38912
	s_add_u32 s92, s90, 272384
	buffer_load_dwordx4 v5, s[20:23], s92 offen lds
	s_sub_u32 s68, s46, 1
	s_mul_i32 s69, s68, 7168
	s_lshl_b32 s71, s66, 7
	s_add_u32 s86, s69, s71
	s_lshl_b32 s87, s68, 10
	s_add_u32 m0, s87, 12288
	s_add_u32 s92, s86, 164864
	buffer_load_dwordx4 v5, s[20:23], s92 offen lds
	s_add_u32 m0, s87, 15360
	s_add_u32 s92, s86, 186368
	buffer_load_dwordx4 v5, s[20:23], s92 offen lds
	s_add_u32 m0, s87, 18432
	s_add_u32 s92, s86, 207872
	buffer_load_dwordx4 v5, s[20:23], s92 offen lds
	s_add_u32 m0, s87, 21504
	s_add_u32 s92, s86, 229376
	buffer_load_dwordx4 v5, s[20:23], s92 offen lds
	s_add_u32 m0, s87, 24576
	s_add_u32 s92, s86, 250880
	buffer_load_dwordx4 v5, s[20:23], s92 offen lds
	s_cmp_gt_u32 s46, 1
	s_cbranch_scc1 Lx_64
	s_add_u32 m0, s87, 27648
	s_add_u32 s92, s86, 272384
	buffer_load_dwordx4 v5, s[20:23], s92 offen lds
Lx_64:
Lw_63:
	s_cmp_lg_u32 s46, 1
	s_cbranch_scc1 Lw_65
	s_mul_i32 s68, s45, (((L_code_p2b-L_layer)+4095)/4096)*128
	s_add_u32 s68, s68, L_layer-interleave_layers__linear_kernel_hedgehog__geglu_ffn__prompt_kernel
	v_lshlrev_b32 v14, 7, v0
	v_add_u32 v14, s68, v14
	v_min_u32 v14, CODE_BYTES-4, v14
	s_mov_b32 exec_lo, (1<<(((L_code_p2b-L_layer)+4095)/4096))-1
	s_mov_b32 exec_hi, 0
	global_load_dword v255, v14, s[98:99]
	s_mov_b64 exec, -1
Lw_65:
L_code_p4:
	s_add_u32 s73, s91, 11264
	s_lshr_b32 s68, s46, 1
	s_lshl_b32 s68, s68, 6
	v_xor_b32 v14, s68, v3
	v_add_u32 v14, s73, v14
	v_xor_b32 v15, 64, v14
	s_sub_u32 s68, s85, s73
	v_add_u32 v12, s68, v14
	v_xor_b32 v13, 64, v12
	s_and_b32 s68, s46, 1
	s_xor_b32 s68, s68, 0
	s_lshl_b32 s69, s65, 1
	s_add_u32 s68, s68, s69
	s_mul_i32 s68, s68, 114688
	s_add_u32 s68, s68, s58
	s_mul_i32 s69, s46, 28672
	s_add_u32 s82, s68, s69
	s_and_b32 s68, s46, 1
	s_xor_b32 s68, s68, 1
	s_lshl_b32 s69, s65, 1
	s_add_u32 s68, s68, s69
	s_mul_i32 s68, s68, 114688
	s_add_u32 s68, s68, s58
	s_mul_i32 s69, s46, 28672
	s_add_u32 s83, s68, s69
	s_xor_b32 s68, s46, 1
	s_mul_i32 s68, s68, 3
	s_add_u32 s68, s68, 0
	s_lshl_b32 s68, s68, 12
	s_add_u32 s68, s68, 86016
	v_add_u32 v112, s68, v1
	s_xor_b32 s68, s46, 2
	s_mul_i32 s68, s68, 3
	s_add_u32 s68, s68, 1
	s_lshl_b32 s68, s68, 12
	s_add_u32 s68, s68, 86016
	v_add_u32 v113, s68, v1
	s_xor_b32 s68, s46, 3
	s_mul_i32 s68, s68, 3
	s_add_u32 s68, s68, 2
	s_lshl_b32 s68, s68, 12
	s_add_u32 s68, s68, 86016
	v_add_u32 v114, s68, v1
	s_mul_i32 s68, s46, 12288
	s_add_u32 s68, s68, 86016
	v_add_u32 v116, s68, v1
	s_cmp_lg_u32 s46, 0
	s_nop 0
	s_cbranch_scc1 Lw_66
	s_cmp_lg_u32 s47, 0
	s_cbranch_scc1 Lx_67
	s_lshl_b32 s68, s63, 7
	s_add_u32 s68, s68, 16384
	s_cmp_lg_u32 s50, 0
	s_cbranch_scc1 Ldone_69
	s_mov_b32 s75, 0
Lpoll_68:
	buffer_load_dword v10, off, s[4:7], s68 sc1
	s_waitcnt vmcnt(0)
	v_cmp_ne_u32 vcc, 16, v10
	s_add_u32 s75, s75, 1
	s_cmp_eq_u64 vcc, 0
	s_nop 2
	s_cbranch_scc1 Ldone_69
	s_cmp_lt_u32 s75, 100000
	s_cbranch_scc1 Lpoll_68
	s_mov_b32 s50, 1
Ldone_69:
Lx_67:
Lw_66:
	s_add_u32 s80, s61, 384
	s_cmp_lg_u32 s46, 0
	s_cbranch_scc1 Lw_71
	s_mov_b32 s76, 268435455
	s_mov_b32 s77, 0
	v_and_b32 v11, 31, v0
	v_lshlrev_b32 v11, 2, v11
	s_cmp_lg_u32 s50, 0
	s_nop 0
	s_cbranch_scc1 Ldone_73
	s_mov_b32 s75, 0
Lpoll_72:
	buffer_load_dword v10, v11, s[4:7], s80 offen sc1
	s_waitcnt vmcnt(0)
	v_cmp_ne_u32 vcc, 1, v10
	s_add_u32 s75, s75, 1
	s_and_b64 vcc, vcc, s[76:77]
	s_cmp_eq_u64 vcc, 0
	s_nop 1
	s_cbranch_scc1 Ldone_73
	s_cmp_lt_u32 s75, 100000
	s_cbranch_scc1 Lpoll_72
	s_mov_b32 s50, 1
Ldone_73:
	s_cmp_eq_u32 s48, 0
	s_cbranch_scc1 Le_75
	buffer_inv sc1
	s_waitcnt vmcnt(0)
Le_75:
Lw_71:
	s_barrier
	s_add_u32 s74, s82, 0
	buffer_load_dwordx4 a[0:3], v1, s[4:7], s74 offen offset:0 sc1
	s_add_u32 s74, s83, 0
	buffer_load_dwordx4 a[4:7], v1, s[4:7], s74 offen offset:0 sc1
	s_add_u32 s74, s82, 0
	buffer_load_dwordx4 a[8:11], v1, s[4:7], s74 offen offset:1024 sc1
	s_add_u32 s74, s83, 0
	buffer_load_dwordx4 a[12:15], v1, s[4:7], s74 offen offset:1024 sc1
	s_add_u32 s74, s82, 0
	buffer_load_dwordx4 a[16:19], v1, s[4:7], s74 offen offset:2048 sc1
	s_add_u32 s74, s83, 0
	buffer_load_dwordx4 a[20:23], v1, s[4:7], s74 offen offset:2048 sc1
	s_add_u32 s74, s82, 0
	buffer_load_dwordx4 a[24:27], v1, s[4:7], s74 offen offset:3072 sc1
	s_add_u32 s74, s83, 0
	buffer_load_dwordx4 a[28:31], v1, s[4:7], s74 offen offset:3072 sc1
	s_add_u32 s74, s82, 4096
	buffer_load_dwordx4 a[32:35], v1, s[4:7], s74 offen offset:0 sc1
	s_add_u32 s74, s83, 4096
	buffer_load_dwordx4 a[36:39], v1, s[4:7], s74 offen offset:0 sc1
	s_add_u32 s74, s82, 4096
	buffer_load_dwordx4 a[40:43], v1, s[4:7], s74 offen offset:1024 sc1
	s_add_u32 s74, s83, 4096
	buffer_load_dwordx4 a[44:47], v1, s[4:7], s74 offen offset:1024 sc1
	ds_read_b64_tr_b16 v[80:81], v12 offset:0
	ds_read_b64_tr_b16 v[82:83], v12 offset:1024
	ds_read_b64_tr_b16 v[84:85], v13 offset:0
	ds_read_b64_tr_b16 v[86:87], v13 offset:1024
	ds_read_b64_tr_b16 v[88:89], v12 offset:2048
	ds_read_b64_tr_b16 v[90:91], v12 offset:3072
	ds_read_b64_tr_b16 v[92:93], v13 offset:2048
	ds_read_b64_tr_b16 v[94:95], v13 offset:3072
	s_waitcnt vmcnt(11)
	s_waitcnt lgkmcnt(6)
	v_mfma_f32_32x32x16_bf16 v[16:31], v[80:83], a[0:3], 0
	ds_read_b64_tr_b16 v[104:105], v12 offset:4096
	ds_read_b64_tr_b16 v[106:107], v12 offset:5120
	ds_read_b64_tr_b16 v[108:109], v13 offset:4096
	ds_read_b64_tr_b16 v[110:111], v13 offset:5120
	s_add_u32 s74, s82, 4096
	buffer_load_dwordx4 a[48:51], v1, s[4:7], s74 offen offset:2048 sc1
	s_waitcnt vmcnt(11)
	v_mfma_f32_32x32x16_bf16 v[32:47], v[80:83], a[4:7], 0
	s_waitcnt lgkmcnt(8)
	v_mfma_f32_32x32x16_bf16 v[48:63], v[84:87], a[0:3], 0
	s_add_u32 s74, s83, 4096
	buffer_load_dwordx4 a[52:55], v1, s[4:7], s74 offen offset:2048 sc1
	v_mfma_f32_32x32x16_bf16 v[64:79], v[84:87], a[4:7], 0
	s_waitcnt vmcnt(11)
	s_waitcnt lgkmcnt(6)
	v_mfma_f32_32x32x16_bf16 v[16:31], v[88:91], a[8:11], v[16:31]
	ds_read_b64_tr_b16 v[80:81], v12 offset:6144
	ds_read_b64_tr_b16 v[82:83], v12 offset:7168
	ds_read_b64_tr_b16 v[84:85], v13 offset:6144
	ds_read_b64_tr_b16 v[86:87], v13 offset:7168
	s_add_u32 s74, s82, 4096
	buffer_load_dwordx4 a[56:59], v1, s[4:7], s74 offen offset:3072 sc1
	s_waitcnt vmcnt(11)
	v_mfma_f32_32x32x16_bf16 v[32:47], v[88:91], a[12:15], v[32:47]
	s_add_u32 m0, s85, 0
	s_add_u32 s92, s90, 279552
	buffer_load_dwordx4 v5, s[20:23], s92 offen lds
	s_waitcnt lgkmcnt(8)
	v_mfma_f32_32x32x16_bf16 v[48:63], v[92:95], a[8:11], v[48:63]
	s_add_u32 s74, s83, 4096
	buffer_load_dwordx4 a[60:63], v1, s[4:7], s74 offen offset:3072 sc1
	v_mfma_f32_32x32x16_bf16 v[64:79], v[92:95], a[12:15], v[64:79]
	s_add_u32 m0, s85, 1024
	s_add_u32 s92, s90, 286720
	buffer_load_dwordx4 v5, s[20:23], s92 offen lds
	s_waitcnt vmcnt(13)
	s_waitcnt lgkmcnt(6)
	v_mfma_f32_32x32x16_bf16 v[16:31], v[104:107], a[16:19], v[16:31]
	ds_read_b64_tr_b16 v[88:89], v12 offset:8192
	ds_read_b64_tr_b16 v[90:91], v12 offset:9216
	ds_read_b64_tr_b16 v[92:93], v13 offset:8192
	ds_read_b64_tr_b16 v[94:95], v13 offset:9216
	s_add_u32 s74, s82, 8192
	buffer_load_dwordx4 a[64:67], v1, s[4:7], s74 offen offset:0 sc1
	s_waitcnt vmcnt(13)
	v_mfma_f32_32x32x16_bf16 v[32:47], v[104:107], a[20:23], v[32:47]
	s_add_u32 m0, s85, 2048
	s_add_u32 s92, s90, 293888
	buffer_load_dwordx4 v5, s[20:23], s92 offen lds
	s_waitcnt lgkmcnt(8)
	v_mfma_f32_32x32x16_bf16 v[48:63], v[108:111], a[16:19], v[48:63]
	s_add_u32 s74, s83, 8192
	buffer_load_dwordx4 a[68:71], v1, s[4:7], s74 offen offset:0 sc1
	v_mfma_f32_32x32x16_bf16 v[64:79], v[108:111], a[20:23], v[64:79]
	s_add_u32 m0, s85, 3072
	s_add_u32 s92, s90, 301056
	buffer_load_dwordx4 v5, s[20:23], s92 offen lds
	s_waitcnt vmcnt(15)
	s_waitcnt lgkmcnt(6)
	v_mfma_f32_32x32x16_bf16 v[16:31], v[80:83], a[24:27], v[16:31]
	ds_read_b64_tr_b16 v[104:105], v12 offset:10240
	ds_read_b64_tr_b16 v[106:107], v14 offset:0
	ds_read_b64_tr_b16 v[108:109], v13 offset:10240
	ds_read_b64_tr_b16 v[110:111], v15 offset:0
	s_add_u32 s74, s82, 8192
	buffer_load_dwordx4 a[72:75], v1, s[4:7], s74 offen offset:1024 sc1
	s_waitcnt vmcnt(15)
	v_mfma_f32_32x32x16_bf16 v[32:47], v[80:83], a[28:31], v[32:47]
	s_add_u32 m0, s85, 4096
	s_add_u32 s92, s90, 308224
	buffer_load_dwordx4 v5, s[20:23], s92 offen lds
	s_waitcnt lgkmcnt(8)
	v_mfma_f32_32x32x16_bf16 v[48:63], v[84:87], a[24:27], v[48:63]
	s_add_u32 s74, s83, 8192
	buffer_load_dwordx4 a[76:79], v1, s[4:7], s74 offen offset:1024 sc1
	v_mfma_f32_32x32x16_bf16 v[64:79], v[84:87], a[28:31], v[64:79]
	s_add_u32 m0, s85, 5120
	s_add_u32 s92, s90, 315392
	buffer_load_dwordx4 v5, s[20:23], s92 offen lds
	s_waitcnt vmcnt(17)
	s_waitcnt lgkmcnt(6)
	v_mfma_f32_32x32x16_bf16 v[16:31], v[88:91], a[32:35], v[16:31]
	ds_read_b64_tr_b16 v[80:81], v14 offset:1024
	ds_read_b64_tr_b16 v[82:83], v14 offset:2048
	ds_read_b64_tr_b16 v[84:85], v15 offset:1024
	ds_read_b64_tr_b16 v[86:87], v15 offset:2048
	s_add_u32 s74, s82, 8192
	buffer_load_dwordx4 a[80:83], v1, s[4:7], s74 offen offset:2048 sc1
	s_waitcnt vmcnt(17)
	v_mfma_f32_32x32x16_bf16 v[32:47], v[88:91], a[36:39], v[32:47]
	s_add_u32 m0, s85, 6144
	s_add_u32 s92, s90, 322560
	buffer_load_dwordx4 v5, s[20:23], s92 offen lds
	s_waitcnt lgkmcnt(8)
	v_mfma_f32_32x32x16_bf16 v[48:63], v[92:95], a[32:35], v[48:63]
	s_add_u32 s74, s83, 8192
	buffer_load_dwordx4 a[84:87], v1, s[4:7], s74 offen offset:2048 sc1
	v_mfma_f32_32x32x16_bf16 v[64:79], v[92:95], a[36:39], v[64:79]
	s_add_u32 m0, s85, 7168
	s_add_u32 s92, s90, 329728
	buffer_load_dwordx4 v5, s[20:23], s92 offen lds
	s_waitcnt vmcnt(19)
	s_waitcnt lgkmcnt(6)
	v_mfma_f32_32x32x16_bf16 v[16:31], v[104:107], a[40:43], v[16:31]
	ds_read_b64_tr_b16 v[88:89], v14 offset:3072
	ds_read_b64_tr_b16 v[90:91], v14 offset:4096
	ds_read_b64_tr_b16 v[92:93], v15 offset:3072
	ds_read_b64_tr_b16 v[94:95], v15 offset:4096
	s_add_u32 s74, s82, 8192
	buffer_load_dwordx4 a[88:91], v1, s[4:7], s74 offen offset:3072 sc1
	s_waitcnt vmcnt(19)
	v_mfma_f32_32x32x16_bf16 v[32:47], v[104:107], a[44:47], v[32:47]
	s_add_u32 m0, s85, 8192
	s_add_u32 s92, s90, 336896
	buffer_load_dwordx4 v5, s[20:23], s92 offen lds
	s_waitcnt lgkmcnt(8)
	v_mfma_f32_32x32x16_bf16 v[48:63], v[108:111], a[40:43], v[48:63]
	s_add_u32 s74, s83, 8192
	buffer_load_dwordx4 a[92:95], v1, s[4:7], s74 offen offset:3072 sc1
	v_mfma_f32_32x32x16_bf16 v[64:79], v[108:111], a[44:47], v[64:79]
	s_add_u32 m0, s85, 9216
	s_add_u32 s92, s90, 344064
	buffer_load_dwordx4 v5, s[20:23], s92 offen lds
	s_waitcnt vmcnt(21)
	s_waitcnt lgkmcnt(6)
	v_mfma_f32_32x32x16_bf16 v[16:31], v[80:83], a[48:51], v[16:31]
	ds_read_b64_tr_b16 v[104:105], v14 offset:5120
	ds_read_b64_tr_b16 v[106:107], v14 offset:6144
	ds_read_b64_tr_b16 v[108:109], v15 offset:5120
	ds_read_b64_tr_b16 v[110:111], v15 offset:6144
	s_add_u32 s74, s82, 12288
	buffer_load_dwordx4 a[96:99], v1, s[4:7], s74 offen offset:0 sc1
	s_waitcnt vmcnt(21)
	v_mfma_f32_32x32x16_bf16 v[32:47], v[80:83], a[52:55], v[32:47]
	s_add_u32 m0, s85, 10240
	s_add_u32 s92, s90, 351232
	buffer_load_dwordx4 v5, s[20:23], s92 offen lds
	s_waitcnt lgkmcnt(8)
	v_mfma_f32_32x32x16_bf16 v[48:63], v[84:87], a[48:51], v[48:63]
	s_add_u32 s74, s83, 12288
	buffer_load_dwordx4 a[100:103], v1, s[4:7], s74 offen offset:0 sc1
	v_mfma_f32_32x32x16_bf16 v[64:79], v[84:87], a[52:55], v[64:79]
	s_add_u32 m0, s91, 11264
	s_add_u32 s92, s90, 358400
	buffer_load_dwordx4 v5, s[20:23], s92 offen lds
	s_barrier
	s_waitcnt vmcnt(23)
	s_waitcnt lgkmcnt(6)
	v_mfma_f32_32x32x16_bf16 v[16:31], v[88:91], a[56:59], v[16:31]
	ds_read_b64_tr_b16 v[80:81], v14 offset:7168
	ds_read_b64_tr_b16 v[82:83], v14 offset:8192
	ds_read_b64_tr_b16 v[84:85], v15 offset:7168
	ds_read_b64_tr_b16 v[86:87], v15 offset:8192
	s_add_u32 s74, s82, 12288
	buffer_load_dwordx4 a[104:107], v1, s[4:7], s74 offen offset:1024 sc1
	s_waitcnt vmcnt(22)
	v_mfma_f32_32x32x16_bf16 v[32:47], v[88:91], a[60:63], v[32:47]
	s_add_u32 m0, s91, 12288
	s_add_u32 s92, s90, 365568
	buffer_load_dwordx4 v5, s[20:23], s92 offen lds
	s_waitcnt lgkmcnt(8)
	v_mfma_f32_32x32x16_bf16 v[48:63], v[92:95], a[56:59], v[48:63]
	s_add_u32 s74, s83, 12288
	buffer_load_dwordx4 a[108:111], v1, s[4:7], s74 offen offset:1024 sc1
	v_mfma_f32_32x32x16_bf16 v[64:79], v[92:95], a[60:63], v[64:79]
	s_add_u32 m0, s91, 13312
	s_add_u32 s92, s90, 372736
	buffer_load_dwordx4 v5, s[20:23], s92 offen lds
	s_waitcnt vmcnt(23)
	s_waitcnt lgkmcnt(6)
	v_mfma_f32_32x32x16_bf16 v[16:31], v[104:107], a[64:67], v[16:31]
	ds_read_b64_tr_b16 v[88:89], v14 offset:9216
	ds_read_b64_tr_b16 v[90:91], v14 offset:10240
	ds_read_b64_tr_b16 v[92:93], v15 offset:9216
	ds_read_b64_tr_b16 v[94:95], v15 offset:10240
	s_add_u32 s74, s82, 12288
	buffer_load_dwordx4 a[112:115], v1, s[4:7], s74 offen offset:2048 sc1
	s_waitcnt vmcnt(22)
	v_mfma_f32_32x32x16_bf16 v[32:47], v[104:107], a[68:71], v[32:47]
	s_add_u32 m0, s91, 14336
	s_add_u32 s92, s90, 379904
	buffer_load_dwordx4 v5, s[20:23], s92 offen lds
	s_waitcnt lgkmcnt(8)
	v_mfma_f32_32x32x16_bf16 v[48:63], v[108:111], a[64:67], v[48:63]
	s_add_u32 s74, s83, 12288
	buffer_load_dwordx4 a[116:119], v1, s[4:7], s74 offen offset:2048 sc1
	v_mfma_f32_32x32x16_bf16 v[64:79], v[108:111], a[68:71], v[64:79]
	s_add_u32 m0, s91, 15360
	s_add_u32 s92, s90, 387072
	buffer_load_dwordx4 v5, s[20:23], s92 offen lds
	s_waitcnt vmcnt(23)
	s_waitcnt lgkmcnt(6)
	v_mfma_f32_32x32x16_bf16 v[16:31], v[80:83], a[72:75], v[16:31]
	ds_read_b64_tr_b16 v[104:105], v14 offset:11264
	ds_read_b64_tr_b16 v[106:107], v14 offset:12288
	ds_read_b64_tr_b16 v[108:109], v15 offset:11264
	ds_read_b64_tr_b16 v[110:111], v15 offset:12288
	s_add_u32 s74, s82, 12288
	buffer_load_dwordx4 a[120:123], v1, s[4:7], s74 offen offset:3072 sc1
	s_waitcnt vmcnt(22)
	v_mfma_f32_32x32x16_bf16 v[32:47], v[80:83], a[76:79], v[32:47]
	s_add_u32 m0, s91, 16384
	s_add_u32 s92, s90, 394240
	buffer_load_dwordx4 v5, s[20:23], s92 offen lds
	s_waitcnt lgkmcnt(8)
	v_mfma_f32_32x32x16_bf16 v[48:63], v[84:87], a[72:75], v[48:63]
	s_add_u32 s74, s83, 12288
	buffer_load_dwordx4 a[124:127], v1, s[4:7], s74 offen offset:3072 sc1
	v_mfma_f32_32x32x16_bf16 v[64:79], v[84:87], a[76:79], v[64:79]
	s_add_u32 m0, s91, 17408
	s_add_u32 s92, s90, 401408
	buffer_load_dwordx4 v5, s[20:23], s92 offen lds
	s_waitcnt vmcnt(23)
	s_waitcnt lgkmcnt(6)
	v_mfma_f32_32x32x16_bf16 v[16:31], v[88:91], a[80:83], v[16:31]
	ds_read_b64_tr_b16 v[80:81], v14 offset:13312
	ds_read_b64_tr_b16 v[82:83], v14 offset:14336
	ds_read_b64_tr_b16 v[84:85], v15 offset:13312
	ds_read_b64_tr_b16 v[86:87], v15 offset:14336
	s_add_u32 s74, s82, 16384
	buffer_load_dwordx4 a[128:131], v1, s[4:7], s74 offen offset:0 sc1
	s_waitcnt vmcnt(22)
	v_mfma_f32_32x32x16_bf16 v[32:47], v[88:91], a[84:87], v[32:47]
	s_waitcnt lgkmcnt(8)
	v_mfma_f32_32x32x16_bf16 v[48:63], v[92:95], a[80:83], v[48:63]
	s_add_u32 s74, s83, 16384
	buffer_load_dwordx4 a[132:135], v1, s[4:7], s74 offen offset:0 sc1
	v_mfma_f32_32x32x16_bf16 v[64:79], v[92:95], a[84:87], v[64:79]
	s_waitcnt vmcnt(21)
	s_waitcnt lgkmcnt(6)
	v_mfma_f32_32x32x16_bf16 v[16:31], v[104:107], a[88:91], v[16:31]
	ds_read_b64_tr_b16 v[88:89], v14 offset:15360
	ds_read_b64_tr_b16 v[90:91], v14 offset:16384
	ds_read_b64_tr_b16 v[92:93], v15 offset:15360
	ds_read_b64_tr_b16 v[94:95], v15 offset:16384
	s_add_u32 s74, s82, 16384
	buffer_load_dwordx4 a[136:139], v1, s[4:7], s74 offen offset:1024 sc1
	s_waitcnt vmcnt(20)
	v_mfma_f32_32x32x16_bf16 v[32:47], v[104:107], a[92:95], v[32:47]
	s_waitcnt lgkmcnt(8)
	v_mfma_f32_32x32x16_bf16 v[48:63], v[108:111], a[88:91], v[48:63]
	s_add_u32 s74, s83, 16384
	buffer_load_dwordx4 a[140:143], v1, s[4:7], s74 offen offset:1024 sc1
	v_mfma_f32_32x32x16_bf16 v[64:79], v[108:111], a[92:95], v[64:79]
	s_waitcnt vmcnt(19)
	s_waitcnt lgkmcnt(6)
	v_mfma_f32_32x32x16_bf16 v[16:31], v[80:83], a[96:99], v[16:31]
	ds_read_b64_tr_b16 v[104:105], v14 offset:17408
	ds_read_b64_tr_b16 v[106:107], v14 offset:18432
	ds_read_b64_tr_b16 v[108:109], v15 offset:17408
	ds_read_b64_tr_b16 v[110:111], v15 offset:18432
	s_add_u32 s74, s82, 16384
	buffer_load_dwordx4 a[144:147], v1, s[4:7], s74 offen offset:2048 sc1
	s_waitcnt vmcnt(18)
	v_mfma_f32_32x32x16_bf16 v[32:47], v[80:83], a[100:103], v[32:47]
	s_waitcnt lgkmcnt(8)
	v_mfma_f32_32x32x16_bf16 v[48:63], v[84:87], a[96:99], v[48:63]
	s_add_u32 s74, s83, 16384
	buffer_load_dwordx4 a[148:151], v1, s[4:7], s74 offen offset:2048 sc1
	v_mfma_f32_32x32x16_bf16 v[64:79], v[84:87], a[100:103], v[64:79]
	s_waitcnt vmcnt(17)
	s_waitcnt lgkmcnt(6)
	v_mfma_f32_32x32x16_bf16 v[16:31], v[88:91], a[104:107], v[16:31]
	ds_read_b64_tr_b16 v[80:81], v14 offset:19456
	ds_read_b64_tr_b16 v[82:83], v14 offset:20480
	ds_read_b64_tr_b16 v[84:85], v15 offset:19456
	ds_read_b64_tr_b16 v[86:87], v15 offset:20480
	s_add_u32 s74, s82, 16384
	buffer_load_dwordx4 a[152:155], v1, s[4:7], s74 offen offset:3072 sc1
	s_waitcnt vmcnt(16)
	v_mfma_f32_32x32x16_bf16 v[32:47], v[88:91], a[108:111], v[32:47]
	s_waitcnt lgkmcnt(8)
	v_mfma_f32_32x32x16_bf16 v[48:63], v[92:95], a[104:107], v[48:63]
	s_add_u32 s74, s83, 16384
	buffer_load_dwordx4 a[156:159], v1, s[4:7], s74 offen offset:3072 sc1
	v_mfma_f32_32x32x16_bf16 v[64:79], v[92:95], a[108:111], v[64:79]
	s_waitcnt vmcnt(15)
	s_waitcnt lgkmcnt(6)
	v_mfma_f32_32x32x16_bf16 v[16:31], v[104:107], a[112:115], v[16:31]
	ds_read_b64_tr_b16 v[88:89], v14 offset:21504
	ds_read_b64_tr_b16 v[90:91], v14 offset:22528
	ds_read_b64_tr_b16 v[92:93], v15 offset:21504
	ds_read_b64_tr_b16 v[94:95], v15 offset:22528
	s_add_u32 s74, s82, 20480
	buffer_load_dwordx4 a[160:163], v1, s[4:7], s74 offen offset:0 sc1
	s_waitcnt vmcnt(14)
	v_mfma_f32_32x32x16_bf16 v[32:47], v[104:107], a[116:119], v[32:47]
	s_waitcnt lgkmcnt(8)
	v_mfma_f32_32x32x16_bf16 v[48:63], v[108:111], a[112:115], v[48:63]
	s_add_u32 s74, s83, 20480
	buffer_load_dwordx4 a[164:167], v1, s[4:7], s74 offen offset:0 sc1
	v_mfma_f32_32x32x16_bf16 v[64:79], v[108:111], a[116:119], v[64:79]
	s_waitcnt vmcnt(13)
	s_waitcnt lgkmcnt(6)
	v_mfma_f32_32x32x16_bf16 v[16:31], v[80:83], a[120:123], v[16:31]
	ds_read_b64_tr_b16 v[104:105], v14 offset:23552
	ds_read_b64_tr_b16 v[106:107], v14 offset:24576
	ds_read_b64_tr_b16 v[108:109], v15 offset:23552
	ds_read_b64_tr_b16 v[110:111], v15 offset:24576
	s_add_u32 s74, s82, 20480
	buffer_load_dwordx4 a[168:171], v1, s[4:7], s74 offen offset:1024 sc1
	s_waitcnt vmcnt(12)
	v_mfma_f32_32x32x16_bf16 v[32:47], v[80:83], a[124:127], v[32:47]
	s_waitcnt lgkmcnt(8)
	v_mfma_f32_32x32x16_bf16 v[48:63], v[84:87], a[120:123], v[48:63]
	s_add_u32 s74, s83, 20480
	buffer_load_dwordx4 a[172:175], v1, s[4:7], s74 offen offset:1024 sc1
	v_mfma_f32_32x32x16_bf16 v[64:79], v[84:87], a[124:127], v[64:79]
	s_waitcnt vmcnt(11)
	s_waitcnt lgkmcnt(6)
	v_mfma_f32_32x32x16_bf16 v[16:31], v[88:91], a[128:131], v[16:31]
	ds_read_b64_tr_b16 v[80:81], v14 offset:25600
	ds_read_b64_tr_b16 v[82:83], v14 offset:26624
	ds_read_b64_tr_b16 v[84:85], v15 offset:25600
	ds_read_b64_tr_b16 v[86:87], v15 offset:26624
	s_add_u32 s74, s82, 20480
	buffer_load_dwordx4 a[176:179], v1, s[4:7], s74 offen offset:2048 sc1
	s_waitcnt vmcnt(11)
	v_mfma_f32_32x32x16_bf16 v[32:47], v[88:91], a[132:135], v[32:47]
	s_waitcnt lgkmcnt(8)
	v_mfma_f32_32x32x16_bf16 v[48:63], v[92:95], a[128:131], v[48:63]
	s_add_u32 s74, s83, 20480
	buffer_load_dwordx4 a[180:183], v1, s[4:7], s74 offen offset:2048 sc1
	v_mfma_f32_32x32x16_bf16 v[64:79], v[92:95], a[132:135], v[64:79]
	s_waitcnt vmcnt(11)
	s_waitcnt lgkmcnt(6)
	v_mfma_f32_32x32x16_bf16 v[16:31], v[104:107], a[136:139], v[16:31]
	ds_read_b64_tr_b16 v[88:89], v14 offset:27648
	ds_read_b64_tr_b16 v[90:91], v12 offset:0
	ds_read_b64_tr_b16 v[92:93], v15 offset:27648
	ds_read_b64_tr_b16 v[94:95], v13 offset:0
	s_add_u32 s74, s82, 20480
	buffer_load_dwordx4 a[184:187], v1, s[4:7], s74 offen offset:3072 sc1
	s_waitcnt vmcnt(11)
	v_mfma_f32_32x32x16_bf16 v[32:47], v[104:107], a[140:143], v[32:47]
	s_waitcnt lgkmcnt(8)
	v_mfma_f32_32x32x16_bf16 v[48:63], v[108:111], a[136:139], v[48:63]
	s_add_u32 s74, s83, 20480
	buffer_load_dwordx4 a[188:191], v1, s[4:7], s74 offen offset:3072 sc1
	v_mfma_f32_32x32x16_bf16 v[64:79], v[108:111], a[140:143], v[64:79]
	s_waitcnt vmcnt(11)
	s_waitcnt lgkmcnt(6)
	v_mfma_f32_32x32x16_bf16 v[16:31], v[80:83], a[144:147], v[16:31]
	ds_read_b64_tr_b16 v[104:105], v12 offset:1024
	ds_read_b64_tr_b16 v[106:107], v12 offset:2048
	ds_read_b64_tr_b16 v[108:109], v13 offset:1024
	ds_read_b64_tr_b16 v[110:111], v13 offset:2048
	s_add_u32 s74, s82, 24576
	buffer_load_dwordx4 a[192:195], v1, s[4:7], s74 offen offset:0 sc1
	s_waitcnt vmcnt(11)
	v_mfma_f32_32x32x16_bf16 v[32:47], v[80:83], a[148:151], v[32:47]
	s_waitcnt lgkmcnt(8)
	v_mfma_f32_32x32x16_bf16 v[48:63], v[84:87], a[144:147], v[48:63]
	s_add_u32 s74, s83, 24576
	buffer_load_dwordx4 a[196:199], v1, s[4:7], s74 offen offset:0 sc1
	v_mfma_f32_32x32x16_bf16 v[64:79], v[84:87], a[148:151], v[64:79]
	s_waitcnt vmcnt(11)
	s_waitcnt lgkmcnt(6)
	v_mfma_f32_32x32x16_bf16 v[16:31], v[88:91], a[152:155], v[16:31]
	ds_read_b64_tr_b16 v[80:81], v12 offset:3072
	ds_read_b64_tr_b16 v[82:83], v12 offset:4096
	ds_read_b64_tr_b16 v[84:85], v13 offset:3072
	ds_read_b64_tr_b16 v[86:87], v13 offset:4096
	s_add_u32 s74, s82, 24576
	buffer_load_dwordx4 a[200:203], v1, s[4:7], s74 offen offset:1024 sc1
	s_waitcnt vmcnt(11)
	v_mfma_f32_32x32x16_bf16 v[32:47], v[88:91], a[156:159], v[32:47]
	s_waitcnt lgkmcnt(8)
	v_mfma_f32_32x32x16_bf16 v[48:63], v[92:95], a[152:155], v[48:63]
	s_add_u32 s74, s83, 24576
	buffer_load_dwordx4 a[204:207], v1, s[4:7], s74 offen offset:1024 sc1
	v_mfma_f32_32x32x16_bf16 v[64:79], v[92:95], a[156:159], v[64:79]
	s_waitcnt vmcnt(11)
	s_waitcnt lgkmcnt(6)
	v_mfma_f32_32x32x16_bf16 v[16:31], v[104:107], a[160:163], v[16:31]
	ds_read_b64_tr_b16 v[88:89], v12 offset:5120
	ds_read_b64_tr_b16 v[90:91], v12 offset:6144
	ds_read_b64_tr_b16 v[92:93], v13 offset:5120
	ds_read_b64_tr_b16 v[94:95], v13 offset:6144
	s_add_u32 s74, s82, 24576
	buffer_load_dwordx4 a[208:211], v1, s[4:7], s74 offen offset:2048 sc1
	s_waitcnt vmcnt(11)
	v_mfma_f32_32x32x16_bf16 v[32:47], v[104:107], a[164:167], v[32:47]
	s_waitcnt lgkmcnt(8)
	v_mfma_f32_32x32x16_bf16 v[48:63], v[108:111], a[160:163], v[48:63]
	s_add_u32 s74, s83, 24576
	buffer_load_dwordx4 a[212:215], v1, s[4:7], s74 offen offset:2048 sc1
	v_mfma_f32_32x32x16_bf16 v[64:79], v[108:111], a[164:167], v[64:79]
	s_waitcnt vmcnt(11)
	s_waitcnt lgkmcnt(6)
	v_mfma_f32_32x32x16_bf16 v[16:31], v[80:83], a[168:171], v[16:31]
	ds_read_b64_tr_b16 v[104:105], v12 offset:7168
	ds_read_b64_tr_b16 v[106:107], v12 offset:8192
	ds_read_b64_tr_b16 v[108:109], v13 offset:7168
	ds_read_b64_tr_b16 v[110:111], v13 offset:8192
	s_add_u32 s74, s82, 24576
	buffer_load_dwordx4 a[216:219], v1, s[4:7], s74 offen offset:3072 sc1
	s_waitcnt vmcnt(11)
	v_mfma_f32_32x32x16_bf16 v[32:47], v[80:83], a[172:175], v[32:47]
	s_waitcnt lgkmcnt(8)
	v_mfma_f32_32x32x16_bf16 v[48:63], v[84:87], a[168:171], v[48:63]
	s_add_u32 s74, s83, 24576
	buffer_load_dwordx4 a[220:223], v1, s[4:7], s74 offen offset:3072 sc1
	v_mfma_f32_32x32x16_bf16 v[64:79], v[84:87], a[172:175], v[64:79]
	s_waitcnt vmcnt(11)
	s_waitcnt lgkmcnt(6)
	v_mfma_f32_32x32x16_bf16 v[16:31], v[88:91], a[176:179], v[16:31]
	ds_read_b64_tr_b16 v[80:81], v12 offset:9216
	ds_read_b64_tr_b16 v[82:83], v12 offset:10240
	ds_read_b64_tr_b16 v[84:85], v13 offset:9216
	ds_read_b64_tr_b16 v[86:87], v13 offset:10240
	s_waitcnt vmcnt(10)
	v_mfma_f32_32x32x16_bf16 v[32:47], v[88:91], a[180:183], v[32:47]
	s_waitcnt lgkmcnt(8)
	v_mfma_f32_32x32x16_bf16 v[48:63], v[92:95], a[176:179], v[48:63]
	v_mfma_f32_32x32x16_bf16 v[64:79], v[92:95], a[180:183], v[64:79]
	s_waitcnt vmcnt(9)
	s_waitcnt lgkmcnt(6)
	v_mfma_f32_32x32x16_bf16 v[16:31], v[104:107], a[184:187], v[16:31]
	ds_read_b64_tr_b16 v[88:89], v14 offset:0
	ds_read_b64_tr_b16 v[90:91], v14 offset:1024
	ds_read_b64_tr_b16 v[92:93], v15 offset:0
	ds_read_b64_tr_b16 v[94:95], v15 offset:1024
	s_waitcnt vmcnt(8)
	v_mfma_f32_32x32x16_bf16 v[32:47], v[104:107], a[188:191], v[32:47]
	s_waitcnt lgkmcnt(8)
	v_mfma_f32_32x32x16_bf16 v[48:63], v[108:111], a[184:187], v[48:63]
	v_mfma_f32_32x32x16_bf16 v[64:79], v[108:111], a[188:191], v[64:79]
	s_waitcnt vmcnt(7)
	s_waitcnt lgkmcnt(6)
	v_mfma_f32_32x32x16_bf16 v[16:31], v[80:83], a[192:195], v[16:31]
	ds_read_b64_tr_b16 v[104:105], v14 offset:2048
	ds_read_b64_tr_b16 v[106:107], v14 offset:3072
	ds_read_b64_tr_b16 v[108:109], v15 offset:2048
	ds_read_b64_tr_b16 v[110:111], v15 offset:3072
	s_waitcnt vmcnt(6)
	v_mfma_f32_32x32x16_bf16 v[32:47], v[80:83], a[196:199], v[32:47]
	s_waitcnt lgkmcnt(8)
	v_mfma_f32_32x32x16_bf16 v[48:63], v[84:87], a[192:195], v[48:63]
	v_mfma_f32_32x32x16_bf16 v[64:79], v[84:87], a[196:199], v[64:79]
	s_waitcnt vmcnt(5)
	s_waitcnt lgkmcnt(6)
	v_mfma_f32_32x32x16_bf16 v[16:31], v[88:91], a[200:203], v[16:31]
	ds_read_b64_tr_b16 v[80:81], v14 offset:4096
	ds_read_b64_tr_b16 v[82:83], v14 offset:5120
	ds_read_b64_tr_b16 v[84:85], v15 offset:4096
	ds_read_b64_tr_b16 v[86:87], v15 offset:5120
	s_waitcnt vmcnt(4)
	v_mfma_f32_32x32x16_bf16 v[32:47], v[88:91], a[204:207], v[32:47]
	s_waitcnt lgkmcnt(8)
	v_mfma_f32_32x32x16_bf16 v[48:63], v[92:95], a[200:203], v[48:63]
	v_mfma_f32_32x32x16_bf16 v[64:79], v[92:95], a[204:207], v[64:79]
	s_waitcnt vmcnt(3)
	s_waitcnt lgkmcnt(6)
	v_mfma_f32_32x32x16_bf16 v[16:31], v[104:107], a[208:211], v[16:31]
	s_waitcnt vmcnt(2)
	v_mfma_f32_32x32x16_bf16 v[32:47], v[104:107], a[212:215], v[32:47]
	s_waitcnt lgkmcnt(4)
	v_mfma_f32_32x32x16_bf16 v[48:63], v[108:111], a[208:211], v[48:63]
	v_mfma_f32_32x32x16_bf16 v[64:79], v[108:111], a[212:215], v[64:79]
	s_waitcnt vmcnt(1)
	s_waitcnt lgkmcnt(2)
	v_mfma_f32_32x32x16_bf16 v[16:31], v[80:83], a[216:219], v[16:31]
	s_waitcnt vmcnt(0)
	v_mfma_f32_32x32x16_bf16 v[32:47], v[80:83], a[220:223], v[32:47]
	s_waitcnt lgkmcnt(0)
	v_mfma_f32_32x32x16_bf16 v[48:63], v[84:87], a[216:219], v[48:63]
	v_mfma_f32_32x32x16_bf16 v[64:79], v[84:87], a[220:223], v[64:79]
	s_barrier
	s_cmp_lg_u32 s47, 0
	s_nop 9
	s_cbranch_scc1 Lfin_76
	s_mul_i32 s90, s63, 86016
	s_add_u32 s90, s90, 1048576
	s_lshl_b32 s91, s46, 10
	s_add_u32 s90, s90, s91
	ds_write_b128 v112, v[32:35] offset:0
	ds_write_b128 v112, v[36:39] offset:1024
	s_add_u32 m0, s91, 0
	s_add_u32 s92, s90, 0
	buffer_load_dwordx4 v1, s[4:7], s92 offen lds
	ds_write_b128 v112, v[40:43] offset:2048
	ds_write_b128 v112, v[44:47] offset:3072
	s_add_u32 m0, s91, 4096
	s_add_u32 s92, s90, 4096
	buffer_load_dwordx4 v1, s[4:7], s92 offen lds
	ds_write_b128 v113, v[48:51] offset:0
	ds_write_b128 v113, v[52:55] offset:1024
	s_add_u32 m0, s91, 8192
	s_add_u32 s92, s90, 8192
	buffer_load_dwordx4 v1, s[4:7], s92 offen lds
	ds_write_b128 v113, v[56:59] offset:2048
	ds_write_b128 v113, v[60:63] offset:3072
	s_add_u32 m0, s91, 12288
	s_add_u32 s92, s90, 12288
	buffer_load_dwordx4 v1, s[4:7], s92 offen lds
	ds_write_b128 v114, v[64:67] offset:0
	ds_write_b128 v114, v[68:71] offset:1024
	s_add_u32 m0, s91, 16384
	s_add_u32 s92, s90, 16384
	buffer_load_dwordx4 v1, s[4:7], s92 offen lds
	ds_write_b128 v114, v[72:75] offset:2048
	ds_write_b128 v114, v[76:79] offset:3072
	s_add_u32 m0, s91, 20480
	s_add_u32 s92, s90, 20480
	buffer_load_dwordx4 v1, s[4:7], s92 offen lds
	s_waitcnt lgkmcnt(0)
	s_barrier
	ds_read_b128 v[32:35], v116 offset:0
	ds_read_b128 v[36:39], v116 offset:1024
	ds_read_b128 v[40:43], v116 offset:2048
	ds_read_b128 v[44:47], v116 offset:3072
	ds_read_b128 v[48:51], v116 offset:4096
	ds_read_b128 v[52:55], v116 offset:5120
	ds_read_b128 v[56:59], v116 offset:6144
	s_add_u32 m0, s91, 24576
	s_add_u32 s92, s90, 24576
	buffer_load_dwordx4 v1, s[4:7], s92 offen lds
	ds_read_b128 v[60:63], v116 offset:7168
	ds_read_b128 v[64:67], v116 offset:8192
	ds_read_b128 v[68:71], v116 offset:9216
	ds_read_b128 v[72:75], v116 offset:10240
	ds_read_b128 v[76:79], v116 offset:11264
	v_lshlrev_b32 v80, 16, v224
	v_and_b32 v81, 0xffff0000, v224
	s_add_u32 m0, s91, 28672
	s_add_u32 s92, s90, 28672
	buffer_load_dwordx4 v1, s[4:7], s92 offen lds
	v_lshlrev_b32 v82, 16, v225
	v_and_b32 v83, 0xffff0000, v225
	v_lshlrev_b32 v84, 16, v226
	v_and_b32 v85, 0xffff0000, v226
	v_lshlrev_b32 v86, 16, v227
	v_and_b32 v87, 0xffff0000, v227
	v_lshlrev_b32 v88, 16, v228
	s_add_u32 m0, s91, 32768
	s_add_u32 s92, s90, 32768
	buffer_load_dwordx4 v1, s[4:7], s92 offen lds
	v_and_b32 v89, 0xffff0000, v228
	v_lshlrev_b32 v90, 16, v229
	v_and_b32 v91, 0xffff0000, v229
	v_lshlrev_b32 v92, 16, v230
	v_and_b32 v93, 0xffff0000, v230
	v_lshlrev_b32 v94, 16, v231
	v_and_b32 v95, 0xffff0000, v231
	s_add_u32 m0, s91, 36864
	s_add_u32 s92, s90, 36864
	buffer_load_dwordx4 v1, s[4:7], s92 offen lds
	v_pk_add_f32 v[16:17], v[16:17], v[80:81]
	v_pk_add_f32 v[18:19], v[18:19], v[82:83]
	v_pk_add_f32 v[20:21], v[20:21], v[84:85]
	v_pk_add_f32 v[22:23], v[22:23], v[86:87]
	v_pk_add_f32 v[24:25], v[24:25], v[88:89]
	v_pk_add_f32 v[26:27], v[26:27], v[90:91]
	v_pk_add_f32 v[28:29], v[28:29], v[92:93]
	s_add_u32 m0, s91, 40960
	s_add_u32 s92, s90, 40960
	buffer_load_dwordx4 v1, s[4:7], s92 offen lds
	v_pk_add_f32 v[30:31], v[30:31], v[94:95]
	s_waitcnt lgkmcnt(8)
	v_pk_add_f32 v[16:17], v[16:17], v[32:33]
	v_pk_add_f32 v[18:19], v[18:19], v[34:35]
	v_pk_add_f32 v[20:21], v[20:21], v[36:37]
	v_pk_add_f32 v[22:23], v[22:23], v[38:39]
	v_pk_add_f32 v[24:25], v[24:25], v[40:41]
	s_add_u32 m0, s91, 45056
	s_add_u32 s92, s90, 45056
	buffer_load_dwordx4 v1, s[4:7], s92 offen lds
	v_pk_add_f32 v[26:27], v[26:27], v[42:43]
	v_pk_add_f32 v[28:29], v[28:29], v[44:45]
	v_pk_add_f32 v[30:31], v[30:31], v[46:47]
	s_waitcnt lgkmcnt(4)
	v_pk_add_f32 v[16:17], v[16:17], v[48:49]
	v_pk_add_f32 v[18:19], v[18:19], v[50:51]
	v_pk_add_f32 v[20:21], v[20:21], v[52:53]
	s_add_u32 m0, s91, 49152
	s_add_u32 s92, s90, 49152
	buffer_load_dwordx4 v1, s[4:7], s92 offen lds
	v_pk_add_f32 v[22:23], v[22:23], v[54:55]
	v_pk_add_f32 v[24:25], v[24:25], v[56:57]
	v_pk_add_f32 v[26:27], v[26:27], v[58:59]
	v_pk_add_f32 v[28:29], v[28:29], v[60:61]
	v_pk_add_f32 v[30:31], v[30:31], v[62:63]
	s_waitcnt lgkmcnt(0)
	v_pk_add_f32 v[16:17], v[16:17], v[64:65]
	s_add_u32 m0, s91, 53248
	s_add_u32 s92, s90, 53248
	buffer_load_dwordx4 v1, s[4:7], s92 offen lds
	v_pk_add_f32 v[18:19], v[18:19], v[66:67]
	v_pk_add_f32 v[20:21], v[20:21], v[68:69]
	v_pk_add_f32 v[22:23], v[22:23], v[70:71]
	v_pk_add_f32 v[24:25], v[24:25], v[72:73]
	v_pk_add_f32 v[26:27], v[26:27], v[74:75]
	v_pk_add_f32 v[28:29], v[28:29], v[76:77]
	v_pk_add_f32 v[30:31], v[30:31], v[78:79]
	v_cvt_pk_bf16_f32 v64, v16, v17
	v_cvt_pk_bf16_f32 v65, v18, v19
	v_cvt_pk_bf16_f32 v66, v20, v21
	v_cvt_pk_bf16_f32 v67, v22, v23
	v_cvt_pk_bf16_f32 v68, v24, v25
	v_cvt_pk_bf16_f32 v69, v26, v27
	v_cvt_pk_bf16_f32 v70, v28, v29
	v_cvt_pk_bf16_f32 v71, v30, v31
	s_and_b32 s69, s46, 1
	s_lshl_b32 s70, s65, 1
	s_add_u32 s69, s69, s70
	s_lshr_b32 s70, s46, 1
	s_lshl_b32 s71, s66, 1
	s_add_u32 s70, s70, s71
	s_mul_i32 s72, s69, 28672
	s_lshl_b32 s73, s70, 11
	s_add_u32 s72, s72, s73
	s_add_u32 s72, s72, s55
	buffer_store_dwordx4 v[64:67], v1, s[4:7], s72 offen
	buffer_store_dwordx4 v[68:71], v1, s[4:7], s72 offen offset:1024
	v_pk_add_f32 v[12:13], v[16:17], v[18:19]
	v_pk_mul_f32 v[14:15], v[16:17], v[16:17]
	v_pk_fma_f32 v[14:15], v[18:19], v[18:19], v[14:15]
	v_pk_add_f32 v[12:13], v[12:13], v[20:21]
	v_pk_fma_f32 v[14:15], v[20:21], v[20:21], v[14:15]
	v_pk_add_f32 v[12:13], v[12:13], v[22:23]
	v_pk_fma_f32 v[14:15], v[22:23], v[22:23], v[14:15]
	v_pk_add_f32 v[12:13], v[12:13], v[24:25]
	v_pk_fma_f32 v[14:15], v[24:25], v[24:25], v[14:15]
	v_pk_add_f32 v[12:13], v[12:13], v[26:27]
	v_pk_fma_f32 v[14:15], v[26:27], v[26:27], v[14:15]
	v_pk_add_f32 v[12:13], v[12:13], v[28:29]
	v_pk_fma_f32 v[14:15], v[28:29], v[28:29], v[14:15]
	v_pk_add_f32 v[12:13], v[12:13], v[30:31]
	v_pk_fma_f32 v[14:15], v[30:31], v[30:31], v[14:15]
	v_add_f32 v12, v12, v13
	v_add_f32 v14, v14, v15
	v_mov_b32 v13, v12
	v_mov_b32 v15, v14
	s_nop 0
	v_permlane32_swap_b32 v12, v13
	v_permlane32_swap_b32 v14, v15
	v_add_f32 v12, v12, v13
	v_add_f32 v13, v14, v15
	s_mul_i32 s72, s69, 3584
	s_lshl_b32 s73, s66, 9
	s_add_u32 s72, s72, s73
	s_lshr_b32 s73, s46, 1
	s_lshl_b32 s73, s73, 3
	s_add_u32 s72, s72, s73
	s_add_u32 s72, s72, s56
	s_mov_b64 exec, 0xffffffff
	buffer_store_dwordx2 v[12:13], v1, s[4:7], s72 offen
	s_mov_b64 exec, -1
	s_add_u32 s80, s61, 512
	s_waitcnt vmcnt(0) lgkmcnt(0)
	s_barrier
	s_cmp_lg_u32 s46, 0
	s_cbranch_scc1 Lw_78
	s_lshl_b32 s68, s45, 2
	s_add_u32 s68, s68, s80
	v_mov_b32 v10, 1
	s_mov_b64 exec, 1
	s_cmp_lg_u32 s48, 0
	s_cbranch_scc1 Lh_79
	buffer_store_dword v10, off, s[4:7], s68
	s_branch Le_80
Lh_79:
	buffer_wbl2 sc1
	s_waitcnt vmcnt(0)
	buffer_store_dword v10, off, s[4:7], s68 sc1
Le_80:
	s_mov_b64 exec, -1
Lw_78:
	s_add_u32 m0, s91, 57344
	s_add_u32 s92, s90, 57344
	buffer_load_dwordx4 v1, s[4:7], s92 offen lds
	s_add_u32 m0, s91, 61440
	s_add_u32 s92, s90, 61440
	buffer_load_dwordx4 v1, s[4:7], s92 offen lds
	s_add_u32 m0, s91, 65536
	s_add_u32 s92, s90, 65536
	buffer_load_dwordx4 v1, s[4:7], s92 offen lds
	s_add_u32 m0, s91, 69632
	s_add_u32 s92, s90, 69632
	buffer_load_dwordx4 v1, s[4:7], s92 offen lds
	s_add_u32 m0, s91, 73728
	s_add_u32 s92, s90, 73728
	buffer_load_dwordx4 v1, s[4:7], s92 offen lds
	s_add_u32 m0, s91, 77824
	s_add_u32 s92, s90, 77824
	buffer_load_dwordx4 v1, s[4:7], s92 offen lds
	s_add_u32 m0, s91, 81920
	s_add_u32 s92, s90, 81920
	buffer_load_dwordx4 v1, s[4:7], s92 offen lds
	s_branch Lp4e_77
Lfin_76:
	ds_write_b128 v112, v[32:35] offset:0
	ds_write_b128 v112, v[36:39] offset:1024
	ds_write_b128 v112, v[40:43] offset:2048
	ds_write_b128 v112, v[44:47] offset:3072
	ds_write_b128 v113, v[48:51] offset:0
	ds_write_b128 v113, v[52:55] offset:1024
	ds_write_b128 v113, v[56:59] offset:2048
	ds_write_b128 v113, v[60:63] offset:3072
	ds_write_b128 v114, v[64:67] offset:0
	ds_write_b128 v114, v[68:71] offset:1024
	ds_write_b128 v114, v[72:75] offset:2048
	ds_write_b128 v114, v[76:79] offset:3072
	s_waitcnt lgkmcnt(0)
	s_barrier
	ds_read_b128 v[32:35], v116 offset:0
	ds_read_b128 v[36:39], v116 offset:1024
	ds_read_b128 v[40:43], v116 offset:2048
	ds_read_b128 v[44:47], v116 offset:3072
	ds_read_b128 v[48:51], v116 offset:4096
	ds_read_b128 v[52:55], v116 offset:5120
	ds_read_b128 v[56:59], v116 offset:6144
	ds_read_b128 v[60:63], v116 offset:7168
	ds_read_b128 v[64:67], v116 offset:8192
	ds_read_b128 v[68:71], v116 offset:9216
	ds_read_b128 v[72:75], v116 offset:10240
	ds_read_b128 v[76:79], v116 offset:11264
	v_lshlrev_b32 v80, 16, v224
	v_and_b32 v81, 0xffff0000, v224
	v_lshlrev_b32 v82, 16, v225
	v_and_b32 v83, 0xffff0000, v225
	v_lshlrev_b32 v84, 16, v226
	v_and_b32 v85, 0xffff0000, v226
	v_lshlrev_b32 v86, 16, v227
	v_and_b32 v87, 0xffff0000, v227
	v_lshlrev_b32 v88, 16, v228
	v_and_b32 v89, 0xffff0000, v228
	v_lshlrev_b32 v90, 16, v229
	v_and_b32 v91, 0xffff0000, v229
	v_lshlrev_b32 v92, 16, v230
	v_and_b32 v93, 0xffff0000, v230
	v_lshlrev_b32 v94, 16, v231
	v_and_b32 v95, 0xffff0000, v231
	v_pk_add_f32 v[16:17], v[16:17], v[80:81]
	v_pk_add_f32 v[18:19], v[18:19], v[82:83]
	v_pk_add_f32 v[20:21], v[20:21], v[84:85]
	v_pk_add_f32 v[22:23], v[22:23], v[86:87]
	v_pk_add_f32 v[24:25], v[24:25], v[88:89]
	v_pk_add_f32 v[26:27], v[26:27], v[90:91]
	v_pk_add_f32 v[28:29], v[28:29], v[92:93]
	v_pk_add_f32 v[30:31], v[30:31], v[94:95]
	s_waitcnt lgkmcnt(8)
	v_pk_add_f32 v[16:17], v[16:17], v[32:33]
	v_pk_add_f32 v[18:19], v[18:19], v[34:35]
	v_pk_add_f32 v[20:21], v[20:21], v[36:37]
	v_pk_add_f32 v[22:23], v[22:23], v[38:39]
	v_pk_add_f32 v[24:25], v[24:25], v[40:41]
	v_pk_add_f32 v[26:27], v[26:27], v[42:43]
	v_pk_add_f32 v[28:29], v[28:29], v[44:45]
	v_pk_add_f32 v[30:31], v[30:31], v[46:47]
	s_waitcnt lgkmcnt(4)
	v_pk_add_f32 v[16:17], v[16:17], v[48:49]
	v_pk_add_f32 v[18:19], v[18:19], v[50:51]
	v_pk_add_f32 v[20:21], v[20:21], v[52:53]
	v_pk_add_f32 v[22:23], v[22:23], v[54:55]
	v_pk_add_f32 v[24:25], v[24:25], v[56:57]
	v_pk_add_f32 v[26:27], v[26:27], v[58:59]
	v_pk_add_f32 v[28:29], v[28:29], v[60:61]
	v_pk_add_f32 v[30:31], v[30:31], v[62:63]
	s_waitcnt lgkmcnt(0)
	v_pk_add_f32 v[16:17], v[16:17], v[64:65]
	v_pk_add_f32 v[18:19], v[18:19], v[66:67]
	v_pk_add_f32 v[20:21], v[20:21], v[68:69]
	v_pk_add_f32 v[22:23], v[22:23], v[70:71]
	v_pk_add_f32 v[24:25], v[24:25], v[72:73]
	v_pk_add_f32 v[26:27], v[26:27], v[74:75]
	v_pk_add_f32 v[28:29], v[28:29], v[76:77]
	v_pk_add_f32 v[30:31], v[30:31], v[78:79]
	v_cvt_pk_bf16_f32 v64, v16, v17
	v_cvt_pk_bf16_f32 v65, v18, v19
	v_cvt_pk_bf16_f32 v66, v20, v21
	v_cvt_pk_bf16_f32 v67, v22, v23
	v_cvt_pk_bf16_f32 v68, v24, v25
	v_cvt_pk_bf16_f32 v69, v26, v27
	v_cvt_pk_bf16_f32 v70, v28, v29
	v_cvt_pk_bf16_f32 v71, v30, v31
	v_permlane32_swap_b32 v64, v66
	v_permlane32_swap_b32 v65, v67
	v_permlane32_swap_b32 v68, v70
	v_permlane32_swap_b32 v69, v71
	s_and_b32 s69, s46, 1
	s_lshl_b32 s70, s65, 1
	s_add_u32 s69, s69, s70
	s_lshr_b32 s70, s46, 1
	s_lshl_b32 s71, s66, 1
	s_add_u32 s70, s70, s71
	s_lshl_b32 s72, s44, 8
	s_lshl_b32 s73, s69, 5
	s_add_u32 s72, s72, s73
	s_mul_i32 s72, s72, 896
	s_lshl_b32 s73, s70, 6
	s_add_u32 s72, s72, s73
	v_and_b32 v12, 31, v0
	v_mul_u32_u24 v12, 896, v12
	v_lshrrev_b32 v13, 5, v0
	v_lshl_add_u32 v12, v13, 4, v12
	buffer_store_dwordx4 v[64:67], v12, s[24:27], s72 offen
	buffer_store_dwordx4 v[68:71], v12, s[24:27], s72 offen offset:32
	s_nop 1
	s_branch L_fin
Lp4e_77:
	s_branch L_next
L_idle:
	s_sub_u32 s68, s45, 28
	s_lshl_b32 s68, s68, 2
	s_add_u32 s86, s68, s46
	s_mul_i32 s87, s86, 50176
	s_add_u32 s87, s87, 802816
	s_add_u32 s69, s87, 0
	buffer_load_dword v255, v247, s[16:19], s69 offen
	s_add_u32 s69, s87, 8192
	buffer_load_dword v255, v247, s[16:19], s69 offen
	s_add_u32 s69, s87, 16384
	buffer_load_dword v255, v247, s[16:19], s69 offen
	s_add_u32 s69, s87, 24576
	buffer_load_dword v255, v247, s[16:19], s69 offen
	s_add_u32 s69, s87, 32768
	buffer_load_dword v255, v247, s[16:19], s69 offen
	s_add_u32 s69, s87, 40960
	buffer_load_dword v255, v247, s[16:19], s69 offen
	s_add_u32 s69, s87, 49152
	s_mov_b64 exec, 0xff
	buffer_load_dword v255, v247, s[16:19], s69 offen
	s_mov_b64 exec, -1
	s_mul_i32 s87, s86, 28672
	s_add_u32 s87, s87, 1146880
	s_add_u32 s69, s87, 0
	buffer_load_dword v255, v247, s[12:15], s69 offen
	s_add_u32 s69, s87, 8192
	buffer_load_dword v255, v247, s[12:15], s69 offen
	s_add_u32 s69, s87, 16384
	buffer_load_dword v255, v247, s[12:15], s69 offen
	s_add_u32 s69, s87, 24576
	s_mov_b64 exec, 0xffffffff
	buffer_load_dword v255, v247, s[12:15], s69 offen
	s_mov_b64 exec, -1
	s_mul_i32 s87, s86, 57344
	s_add_u32 s87, s87, s58
	s_add_u32 s69, s87, 0
	buffer_load_dword v255, v247, s[4:7], s69 offen
	s_add_u32 s69, s87, 8192
	buffer_load_dword v255, v247, s[4:7], s69 offen
	s_add_u32 s69, s87, 16384
	buffer_load_dword v255, v247, s[4:7], s69 offen
	s_add_u32 s69, s87, 24576
	buffer_load_dword v255, v247, s[4:7], s69 offen
	s_add_u32 s69, s87, 32768
	buffer_load_dword v255, v247, s[4:7], s69 offen
	s_add_u32 s69, s87, 40960
	buffer_load_dword v255, v247, s[4:7], s69 offen
	s_add_u32 s69, s87, 49152
	buffer_load_dword v255, v247, s[4:7], s69 offen
	s_cmp_eq_u32 s47, 0
	s_cbranch_scc1 Lidle0_81
	s_branch L_fin
Lidle0_81:
	s_mul_i32 s87, s86, 14336
	s_add_u32 s87, s87, s55
	s_add_u32 s69, s87, 0
	buffer_load_dword v255, v247, s[4:7], s69 offen
	s_add_u32 s69, s87, 8192
	s_mov_b32 exec_hi, 0xffff
	buffer_load_dword v255, v247, s[4:7], s69 offen
	s_mov_b64 exec, -1
	s_mul_i32 s87, s86, 1792
	s_add_u32 s87, s87, s56
	s_mov_b64 exec, 0x3fff
	buffer_load_dword v255, v247, s[4:7], s87 offen
	s_mov_b64 exec, -1
	s_cmp_lg_u32 s46, 0
	s_cbranch_scc1 Lw_82
	s_cmp_lg_u32 s47, 0
	s_cbranch_scc1 Lx_83
	v_and_b32 v11, 15, v0
	v_lshlrev_b32 v11, 7, v11
	s_mov_b32 s68, 16384
	s_cmp_lg_u32 s50, 0
	s_cbranch_scc1 Ldone_85
	s_mov_b32 s75, 0
Lpoll_84:
	buffer_load_dword v10, v11, s[4:7], s68 offen sc1
	s_waitcnt vmcnt(0)
	v_cmp_ne_u32 vcc, 16, v10
	s_add_u32 s75, s75, 1
	s_cmp_eq_u64 vcc, 0
	s_nop 2
	s_cbranch_scc1 Ldone_85
	s_cmp_lt_u32 s75, 100000
	s_cbranch_scc1 Lpoll_84
	s_mov_b32 s50, 1
Ldone_85:
Lx_83:
Lw_82:
	s_waitcnt vmcnt(0)
	s_barrier
	s_mul_i32 s90, s63, 86016
	s_add_u32 s90, s90, 1048576
	s_lshl_b32 s91, s46, 10
	s_add_u32 s90, s90, s91
	s_add_u32 m0, s91, 0
	s_add_u32 s92, s90, 0
	buffer_load_dwordx4 v1, s[4:7], s92 offen lds
	s_add_u32 m0, s91, 4096
	s_add_u32 s92, s90, 4096
	buffer_load_dwordx4 v1, s[4:7], s92 offen lds
	s_add_u32 m0, s91, 8192
	s_add_u32 s92, s90, 8192
	buffer_load_dwordx4 v1, s[4:7], s92 offen lds
	s_add_u32 m0, s91, 12288
	s_add_u32 s92, s90, 12288
	buffer_load_dwordx4 v1, s[4:7], s92 offen lds
	s_add_u32 m0, s91, 16384
	s_add_u32 s92, s90, 16384
	buffer_load_dwordx4 v1, s[4:7], s92 offen lds
	s_add_u32 m0, s91, 20480
	s_add_u32 s92, s90, 20480
	buffer_load_dwordx4 v1, s[4:7], s92 offen lds
	s_add_u32 m0, s91, 24576
	s_add_u32 s92, s90, 24576
	buffer_load_dwordx4 v1, s[4:7], s92 offen lds
	s_add_u32 m0, s91, 28672
	s_add_u32 s92, s90, 28672
	buffer_load_dwordx4 v1, s[4:7], s92 offen lds
	s_add_u32 m0, s91, 32768
	s_add_u32 s92, s90, 32768
	buffer_load_dwordx4 v1, s[4:7], s92 offen lds
	s_add_u32 m0, s91, 36864
	s_add_u32 s92, s90, 36864
	buffer_load_dwordx4 v1, s[4:7], s92 offen lds
	s_add_u32 m0, s91, 40960
	s_add_u32 s92, s90, 40960
	buffer_load_dwordx4 v1, s[4:7], s92 offen lds
	s_add_u32 m0, s91, 45056
	s_add_u32 s92, s90, 45056
	buffer_load_dwordx4 v1, s[4:7], s92 offen lds
	s_add_u32 m0, s91, 49152
	s_add_u32 s92, s90, 49152
	buffer_load_dwordx4 v1, s[4:7], s92 offen lds
	s_add_u32 m0, s91, 53248
	s_add_u32 s92, s90, 53248
	buffer_load_dwordx4 v1, s[4:7], s92 offen lds
	s_add_u32 m0, s91, 57344
	s_add_u32 s92, s90, 57344
	buffer_load_dwordx4 v1, s[4:7], s92 offen lds
	s_add_u32 m0, s91, 61440
	s_add_u32 s92, s90, 61440
	buffer_load_dwordx4 v1, s[4:7], s92 offen lds
	s_add_u32 m0, s91, 65536
	s_add_u32 s92, s90, 65536
	buffer_load_dwordx4 v1, s[4:7], s92 offen lds
	s_add_u32 m0, s91, 69632
	s_add_u32 s92, s90, 69632
	buffer_load_dwordx4 v1, s[4:7], s92 offen lds
	s_add_u32 m0, s91, 73728
	s_add_u32 s92, s90, 73728
	buffer_load_dwordx4 v1, s[4:7], s92 offen lds
	s_add_u32 m0, s91, 77824
	s_add_u32 s92, s90, 77824
	buffer_load_dwordx4 v1, s[4:7], s92 offen lds
	s_add_u32 m0, s91, 81920
	s_add_u32 s92, s90, 81920
	buffer_load_dwordx4 v1, s[4:7], s92 offen lds
L_next:
	s_mul_i32 s68, s64, 14
	s_lshl_b32 s81, 0x3fff, s68
	s_add_u32 s80, s61, 512
	s_cmp_lg_u32 s46, 0
	s_cbranch_scc1 Lw_87
	s_mov_b32 s76, s81
	s_mov_b32 s77, 0
	v_and_b32 v11, 31, v0
	v_lshlrev_b32 v11, 2, v11
	s_cmp_lg_u32 s50, 0
	s_nop 0
	s_cbranch_scc1 Ldone_89
	s_mov_b32 s75, 0
Lpoll_88:
	buffer_load_dword v10, v11, s[4:7], s80 offen sc1
	s_waitcnt vmcnt(0)
	v_cmp_ne_u32 vcc, 1, v10
	s_add_u32 s75, s75, 1
	s_and_b64 vcc, vcc, s[76:77]
	s_cmp_eq_u64 vcc, 0
	s_nop 1
	s_cbranch_scc1 Ldone_89
	s_cmp_lt_u32 s75, 100000
	s_cbranch_scc1 Lpoll_88
	s_mov_b32 s50, 1
Ldone_89:
	s_cmp_eq_u32 s48, 0
	s_cbranch_scc1 Le_91
	buffer_inv sc1
	s_waitcnt vmcnt(0)
Le_91:
Lw_87:
	s_waitcnt vmcnt(0)
	s_barrier
	s_mov_b32 s47, 1
	s_branch L_layer
L_fin:
	s_waitcnt vmcnt(0) lgkmcnt(0)
L_end:
	s_endpgm
L_code_end:
.set CODE_BYTES, L_code_end-interleave_layers__linear_kernel_hedgehog__geglu_ffn__prompt_kernel
.section .rodata,"a"
.p2align 6
.amdhsa_kernel interleave_layers__linear_kernel_hedgehog__geglu_ffn__prompt_kernel
  .amdhsa_next_free_vgpr 512
  .amdhsa_next_free_sgpr 102
  .amdhsa_accum_offset 256
  .amdhsa_group_segment_fixed_size 0
  .amdhsa_kernarg_size 88
  .amdhsa_user_sgpr_count 2
  .amdhsa_user_sgpr_kernarg_segment_ptr 1
  .amdhsa_system_sgpr_workgroup_id_x 1
.end_amdhsa_kernel
```
